```python
import torch

def _softmax(x, axis=-1):
    return torch.softmax(x, dim=axis)
def _gelu(x):
    return torch.nn.functional.gelu(x, approximate="tanh")
def _silu(x):
    return torch.nn.functional.silu(x)
def _sigmoid(x):
    return torch.sigmoid(x)
def _layernorm(x, axis=-1, eps=1e-5):
    m = x.mean(dim=axis, keepdim=True)
    v = x.var(dim=axis, keepdim=True, unbiased=False)
    return (x - m) / torch.sqrt(v + eps)
def _scatter_add(tgt, idx, src, axis=0):
    return tgt.clone().index_add_(axis, idx, src)
def _segment_sum(src, seg, n):
    out = torch.zeros((n,) + src.shape[1:], dtype=src.dtype)
    return out.index_add_(0, seg, src)
def _pad(x, pw):
    flat = tuple(v for pair in reversed(pw) for v in pair)
    return torch.nn.functional.pad(x, flat)

kernel_name = 'recurrent_scan__ssm_conv_s4__geglu_ffn__prompt'

def setup_inputs():

    _w = (lambda a: (lambda t: t.to(torch.bfloat16) if t.is_floating_point() else t)(torch.as_tensor(a)))
    def _A_setup():
        B, L, D, N = 1, 2048, 640, 192
        A_re = -(lambda _x: torch.exp(torch.as_tensor(_x)))((lambda *s: torch.randn(*s, dtype=torch.bfloat16) * 6.4)(D, N))
        A_im = torch.pi * (lambda *s: torch.randn(*s, dtype=torch.bfloat16) * 0.05)(D, N)
        B_re = (lambda *s: torch.randn(*s, dtype=torch.bfloat16) * 0.05)(D, N)
        B_im = (lambda *s: torch.randn(*s, dtype=torch.bfloat16) * 0.05)(D, N)
        C_re = (lambda *s: torch.randn(*s, dtype=torch.bfloat16) * 0.05)(D, N)
        C_im = (lambda *s: torch.randn(*s, dtype=torch.bfloat16) * 0.05)(D, N)
        log_dt = (lambda *s: torch.randn(*s, dtype=torch.bfloat16) * 0.05)(D) * 0.5 - 4.0
        Dskip = (lambda *s: torch.randn(*s, dtype=torch.bfloat16) * 0.05)(D)
        return {
            "u": _w((lambda *s: torch.randn(*s, dtype=torch.bfloat16) * 0.05)(B, L, D)),
            "A_re": _w(A_re),
            "A_im": _w(A_im),
            "B_re": _w(B_re),
            "B_im": _w(B_im),
            "C_re": _w(C_re),
            "C_im": _w(C_im),
            "log_dt": _w(log_dt),
            "Dskip": _w(Dskip),
        }
    _A_in = _A_setup()

    def _B_setup():
        B, S, D, F = 1, 2048, 640, 1536
        return {
            "x": _w((lambda *s: torch.randn(*s, dtype=torch.bfloat16) * 0.05)(B, S, D)),
            "w_gate": _w((lambda *s: torch.randn(*s, dtype=torch.bfloat16) * 0.05)(D, F)),
            "w_up": _w((lambda *s: torch.randn(*s, dtype=torch.bfloat16) * 0.05)(D, F)),
            "w_down": _w((lambda *s: torch.randn(*s, dtype=torch.bfloat16) * 0.05)(F, D)),
        }
    _B_in = _B_setup()

    return {
        "A_u": _A_in["u"],
        "A_A_re": _A_in["A_re"],
        "A_A_im": _A_in["A_im"],
        "A_B_re": _A_in["B_re"],
        "A_B_im": _A_in["B_im"],
        "A_C_re": _A_in["C_re"],
        "A_C_im": _A_in["C_im"],
        "A_log_dt": _A_in["log_dt"],
        "A_Dskip": _A_in["Dskip"],
        "B_x": _B_in["x"],
        "B_w_gate": _B_in["w_gate"],
        "B_w_up": _B_in["w_up"],
        "B_w_down": _B_in["w_down"],
    }

def reference(A_u, A_A_re, A_A_im, A_B_re, A_B_im, A_C_re, A_C_im, A_log_dt, A_Dskip, B_x, B_w_gate, B_w_up, B_w_down):
    def _A_ref(u, A_re, A_im, B_re, B_im, C_re, C_im, log_dt, Dskip):
        Bsz, L, D = u.shape
        dt = torch.exp(log_dt)[:, None]
        A = A_re + 1j * A_im
        Bc = B_re + 1j * B_im
        Cc = C_re + 1j * C_im
        logdA = dt * A
        dB = dt * Bc
        l = (lambda x, dt: x.to(dt))(torch.arange(L), A_re.dtype)
        P = torch.exp(logdA[:, :, None] * l[None, None, :])
        K = torch.einsum("dn,dnl,dn->dl", Cc, P, dB).real
        L2 = 2 * L
        Kp = _pad(K, ((0, 0), (0, L)))
        up = (lambda x, *d: x.permute(*d))(u, 0, 2, 1)
        up = _pad(up, ((0, 0), (0, 0), (0, L)))
        Kf = (lambda x, axes=(-2,-1): torch.fft.rfft2(x.float(), dim=axes))(Kp[:, None, :], axes=(-2, -1))
        Uf = (lambda x, axes=(-2,-1): torch.fft.rfft2(x.float(), dim=axes))(up[:, :, None, :], axes=(-2, -1))
        Yf = Uf * Kf[None, :, :, :]
        y = (lambda x, s, axes=(-2,-1): torch.fft.irfft2(x, s=s, dim=axes).to(torch.bfloat16))(Yf, (1, L2), axes=(-2, -1))[:, :, 0, :L]
        y = (lambda x, *d: x.permute(*d))(y, 0, 2, 1) + u * Dskip[None, None, :]
        return y

    def _B_ref(x, w_gate, w_up, w_down):
        return (_gelu(x @ w_gate) * (x @ w_up)) @ w_down

    x = A_u
    xn = _layernorm(x, axis=-1)
    s = _A_ref(xn, A_A_re, A_A_im, A_B_re, A_B_im, A_C_re, A_C_im, A_log_dt, A_Dskip)
    g = _silu(_B_ref(xn, B_w_gate, B_w_up, B_w_down))
    return x + s * g
```

```asm
; @launch grid=(256,1,1) block=(512,1,1) lds=163840
.amdgcn_target "amdgcn-amd-amdhsa--gfx950"
.text
.globl recurrent_scan__ssm_conv_s4__geglu_ffn__prompt_kernel
.p2align 8
.type recurrent_scan__ssm_conv_s4__geglu_ffn__prompt_kernel,@function
recurrent_scan__ssm_conv_s4__geglu_ffn__prompt_kernel:
    s_load_dwordx16 s[16:31], s[0:1], 0
    s_load_dwordx16 s[32:47], s[0:1], 64
    s_setprio 3
    s_getpc_b64 s[4:5]
L_PC:
    s_and_b32 s6, s2, 0xf8
    s_lshl_b32 s6, s6, 1
    v_lshrrev_b32 v3, 3, v0
    v_cmp_le_u32 vcc, 48, v3
    v_add_u32 v4, s6, v3
    s_min_u32 s7, s2, 239
    s_lshl_b32 s7, s7, 9
    v_cndmask_b32 v3, v3, v4, vcc
    v_lshlrev_b32 v3, 7, v3
    v_min_u32 v3, L_END-L_PC, v3
    global_load_dword v2, v3, s[4:5]
    v_add_lshl_u32 v108, s7, v0, 1
    s_cmp_ge_u32 s2, 256
    s_cbranch_scc1 L_END
    v_lshrrev_b32 v109, 7, v108
    v_mul_u32_u24 v109, 43691, v109
    v_lshrrev_b32 v109, 17, v109
    v_lshlrev_b32 v109, 1, v109
    v_mov_b64 v[96:97], 0
    v_mov_b64 v[98:99], 0
    v_mov_b64 v[100:101], 0
    v_mov_b64 v[102:103], 0
    v_lshrrev_b32 v3, 6, v0
    v_and_b32 v1, 63, v0
    s_lshr_b32 s73, s2, 3
    s_and_b32 s72, s2, 7
    v_readfirstlane_b32 s3, v3
    s_and_b32 s4, s72, 1
    s_lshr_b32 s5, s72, 1
    s_lshl_b32 s8, s4, 2
    s_add_u32 s8, s8, s5
    s_lshl_b32 s8, s8, 5
    s_add_u32 s8, s8, s73
    s_lshl_b32 s76, s8, 3
    s_and_b32 s83, s3, 3
    s_mul_i32 s6, s73, 52
    s_lshr_b32 s6, s6, 8
    s_mul_i32 s7, s6, 5
    s_sub_u32 s7, s73, s7
    s_lshl_b32 s8, s5, 2
    s_lshr_b32 s8, 0x2204, s8
    s_and_b32 s8, s8, 7
    s_add_u32 s6, s6, s8
    s_cmp_ge_u32 s6, 6
    s_cselect_b32 s8, 6, 0
    s_sub_u32 s6, s6, s8
    s_mul_i32 s8, s4, 5
    s_add_u32 s8, s8, s7
    s_lshl_b32 s9, s4, 1
    s_add_u32 s9, s9, s73
    s_sub_u32 s9, s9, 30
    s_lshl_b32 s10, s6, 6
    s_mul_i32 s11, s9, 96
    s_cmp_ge_u32 s73, 30
    s_cselect_b32 s8, 10, s8
    s_cselect_b32 s6, s9, s6
    s_cselect_b32 s10, s11, s10
    s_mul_i32 s74, s8, 192
    s_mul_i32 s9, s5, 384
    s_add_u32 s75, s9, s10
    s_mul_i32 s8, s8, 24
    s_mul_i32 s9, s5, 6
    s_add_u32 s8, s8, s9
    s_add_u32 s81, s8, s6
    s_sub_u32 s9, 31, s73
    s_and_b32 s10, s9, 7
    s_lshr_b32 s9, s9, 3
    s_add_u32 s9, s9, s10
    s_and_b32 s9, s9, 3
    s_and_b32 s8, s72, 3
    s_lshl_b32 s8, s8, 3
    s_add_u32 s79, s8, s10
    s_and_b32 s8, s72, 4
    s_add_u32 s80, s8, s9
    s_mov_b32 s50, 2621440
    s_mov_b32 s51, 0x20000
    s_mov_b32 s54, 1966080
    s_mov_b32 s55, 0x20000
    s_cmp_ge_u32 s73, 30
    s_cbranch_scc1 L_EAB
    v_lshrrev_b32 v3, 3, v1
    v_mul_u32_u24 v7, 1280, v3
    v_and_b32 v4, 7, v1
    v_lshrrev_b32 v5, 4, v1
    v_xor_b32 v5, v4, v5
    v_lshl_add_u32 v7, v5, 4, v7
    v_xor_b32 v8, 64, v7
    v_and_b32 v5, 2, v3
    v_xor_b32 v4, v4, v5
    v_mul_u32_u24 v3, 3072, v3
    v_lshl_add_u32 v9, v4, 4, v3
    v_xor_b32 v10, 64, v9
    v_mov_b32 v11, 0
    s_mul_i32 s5, s83, 48
    s_add_u32 s4, s74, s5
    s_mul_i32 s60, s4, 1280
    s_lshl_b32 s62, s5, 7
    s_and_b32 s4, s83, 1
    s_mul_i32 s61, s4, 98304
    s_lshl_b32 s5, s75, 1
    s_add_u32 s61, s61, s5
    s_mul_i32 s63, s83, 4096
    s_lshr_b32 s6, s74, 6
    s_and_b32 s6, s6, 0
    s_lshl_b32 s7, s6, 7
    s_sub_u32 s90, s60, s7
    s_add_u32 s60, s60, s7
    s_mul_i32 s7, s6, 196608
    s_sub_u32 s91, s61, s7
    s_add_u32 s61, s61, s7
    s_waitcnt lgkmcnt(0)
    global_load_short_d16_hi v96, v108, s[18:19]
    global_load_short_d16_hi v97, v108, s[20:21]
    global_load_short_d16_hi v98, v108, s[22:23]
    global_load_short_d16_hi v99, v108, s[24:25]
    global_load_short_d16_hi v100, v108, s[26:27]
    global_load_short_d16_hi v101, v108, s[28:29]
    global_load_short_d16_hi v102, v109, s[30:31]
    s_setprio 0
    s_mov_b64 s[48:49], s[16:17]
    s_cmp_ge_u32 s83, 2
    s_cselect_b64 s[52:53], s[38:39], s[36:37]
L_EAJ:
    s_and_b32 s4, s72, 1
    s_lshr_b32 s5, s72, 1
    s_cmp_ge_u32 s3, 4
    s_cbranch_scc0 L_M0
    s_branch L_H0
L_M0:
    s_lshl_b32 s9, s83, 1
    s_add_u32 s9, s9, s76
    s_mul_i32 s10, s9, 1280
    v_lshrrev_b32 v5, 5, v1
    v_mul_u32_u24 v5, 1280, v5
    v_and_b32 v6, 31, v1
    v_lshl_add_u32 v22, v6, 4, v5
    v_lshl_add_u32 v23, v6, 3, v5
    buffer_load_dwordx4 v[12:15], v22, s[48:51], s10 offen
    buffer_load_dwordx4 v[16:19], v22, s[48:51], s10 offen offset:512
    buffer_load_dwordx2 v[20:21], v23, s[48:51], s10 offen offset:1024
    s_mul_i32 s6, s4, 30
    s_add_u32 s6, s6, s73
    s_mul_i32 s7, s6, 43
    s_lshr_b32 s7, s7, 8
    s_mul_i32 s8, s7, 6
    s_sub_u32 s6, s6, s8
    s_lshl_b32 s7, s7, 2
    s_add_u32 s7, s7, s83
    s_mul_i32 s7, s7, 49152
    s_mul_i32 s8, s5, 768
    s_add_u32 s7, s7, s8
    s_cmp_ge_u32 s6, 3
    s_cselect_b64 s[84:85], s[38:39], s[36:37]
    s_cselect_b32 s8, 3, 0
    s_sub_u32 s6, s6, s8
    s_lshl_b32 s6, s6, 8
    s_add_u32 s7, s7, s6
    s_cmp_ge_u32 s2, 240
    s_cselect_b32 s7, 2130706432, s7
    s_mov_b32 s86, 1966080
    s_mov_b32 s87, 0x20000
    v_lshrrev_b32 v3, 4, v1
    v_mul_u32_u24 v3, 3072, v3
    v_and_b32 v4, 15, v1
    v_lshl_add_u32 v3, v4, 4, v3
    buffer_load_dwordx4 v[24:27], v3, s[84:87], s7 offen
    s_add_u32 s7, s7, 12288
    buffer_load_dwordx4 v[28:31], v3, s[84:87], s7 offen
    s_add_u32 s7, s7, 12288
    buffer_load_dwordx4 v[32:35], v3, s[84:87], s7 offen
    s_add_u32 s7, s7, 12288
    buffer_load_dwordx4 v[36:39], v3, s[84:87], s7 offen
    s_mov_b64 s[84:85], s[40:41]
    s_min_u32 s8, s2, 239
    s_mul_i32 s9, s8, 52429
    s_lshr_b32 s9, s9, 18
    s_mul_i32 s10, s9, 5
    s_sub_u32 s10, s8, s10
    s_lshl_b32 s10, s10, 2
    s_add_u32 s10, s10, s83
    s_lshl_b32 s10, s10, 1
    s_mul_i32 s11, s9, 40960
    s_lshl_b32 s12, s10, 5
    s_add_u32 s11, s11, s12
    v_lshrrev_b32 v3, 2, v1
    v_mul_u32_u24 v3, 1280, v3
    v_and_b32 v4, 3, v1
    v_lshl_add_u32 v3, v4, 4, v3
    s_lshl_b32 s15, s83, 11
    s_add_u32 s15, s15, 28800
    s_mov_b32 m0, s15
    s_nop 0
    buffer_load_dwordx4 v3, s[84:87], s11 offen lds
    s_add_u32 m0, s15, 1024
    s_add_u32 s11, s11, 20480
    buffer_load_dwordx4 v3, s[84:87], s11 offen lds
    s_add_u32 s14, s10, 0
    s_mul_i32 s12, s14, 52429
    s_lshr_b32 s12, s12, 18
    s_mul_i32 s13, s12, 5
    s_sub_u32 s13, s14, s13
    s_and_b32 s14, s12, 1
    s_sub_u32 s13, s13, s14
    s_cselect_b32 s13, 4, s13
    s_mul_i32 s12, s12, 240
    s_add_u32 s13, s13, s12
    s_mul_i32 s12, s9, 5
    s_add_u32 s12, s12, s13
    s_lshl_b32 s12, s12, 10
    s_add_u32 s12, s12, 10485760
    s_cmp_ge_u32 s2, 240
    s_cselect_b32 s56, 2130706432, s12
    s_add_u32 s14, s10, 1
    s_mul_i32 s12, s14, 52429
    s_lshr_b32 s12, s12, 18
    s_mul_i32 s13, s12, 5
    s_sub_u32 s13, s14, s13
    s_and_b32 s14, s12, 1
    s_sub_u32 s13, s13, s14
    s_cselect_b32 s13, 4, s13
    s_mul_i32 s12, s12, 240
    s_add_u32 s13, s13, s12
    s_mul_i32 s12, s9, 5
    s_add_u32 s12, s12, s13
    s_lshl_b32 s12, s12, 10
    s_add_u32 s12, s12, 10485760
    s_cmp_ge_u32 s2, 240
    s_cselect_b32 s57, 2130706432, s12
    v_lshrrev_b32 v3, 4, v1
    v_lshlrev_b32 v3, 9, v3
    v_bfe_u32 v4, v1, 2, 2
    v_lshl_add_u32 v3, v4, 6, v3
    v_and_b32 v4, 3, v1
    v_lshl_add_u32 v3, v4, 3, v3
    v_add_u32 v40, s15, v3
    s_lshl_b32 s58, s83, 1
    s_add_u32 s58, s58, s76
    s_lshl_b32 s58, s58, 3
    s_add_u32 s58, s58, 196608
    v_lshrrev_b32 v3, 5, v1
    v_lshlrev_b32 v3, 4, v3
    s_mul_i32 s4, s83, 2592
    s_add_u32 s4, s4, 18432
    v_add3_u32 v22, v22, v3, s4
    v_add3_u32 v23, v23, v3, s4
    v_lshlrev_b32 v6, 4, v1
    s_mov_b64 s[64:65], s[46:47]
    s_mov_b32 s66, 23068672
    s_mov_b32 s67, 0x20000
    v_and_b32 v3, 1, v1
    v_lshlrev_b32 v3, 4, v3
    v_mov_b32 v4, 0x3f80
    v_lshlrev_b32 v3, v3, v4
    v_bfe_u32 v4, v1, 1, 3
    v_cmp_eq_u32 vcc, 0, v4
    s_nop 1
    v_cndmask_b32 v42, 0, v3, vcc
    v_cmp_eq_u32 vcc, 1, v4
    s_nop 1
    v_cndmask_b32 v43, 0, v3, vcc
    v_cmp_eq_u32 vcc, 2, v4
    s_nop 1
    v_cndmask_b32 v44, 0, v3, vcc
    v_cmp_eq_u32 vcc, 3, v4
    s_nop 1
    v_cndmask_b32 v45, 0, v3, vcc
    s_lshr_b32 s84, s83, 1
    s_and_b32 s83, s83, 1
    s_cmp_ge_u32 s73, 30
    s_cbranch_scc1 L_MAB
    v_and_b32 v3, 15, v1
    v_lshrrev_b32 v5, 4, v1
    v_bfe_u32 v4, v1, 1, 3
    v_xor_b32 v4, v4, v5
    v_lshlrev_b32 v3, 7, v3
    v_lshl_add_u32 v3, v4, 4, v3
    v_xor_b32 v4, 64, v3
    s_mul_i32 s4, s83, 12288
    s_add_u32 s5, s4, 40960
    v_add_u32 v46, s5, v3
    v_add_u32 v47, s5, v4
    s_add_u32 s5, s4, 81920
    v_add_u32 v48, s5, v3
    v_add_u32 v49, s5, v4
    s_add_u32 s5, s4, 122880
    v_add_u32 v50, s5, v3
    v_add_u32 v51, s5, v4
    v_bfe_u32 v3, v1, 2, 2
    v_lshl_add_u32 v3, v5, 3, v3
    v_mul_u32_u24 v3, 128, v3
    v_and_b32 v4, 3, v1
    v_lshl_add_u32 v3, v4, 3, v3
    v_bfe_u32 v5, v1, 3, 2
    s_mul_i32 s4, s84, 2
    s_add_u32 s5, s4, 1
    v_xor_b32 v4, s4, v5
    v_lshl_add_u32 v4, v4, 5, v3
    v_xor_b32 v5, s5, v5
    v_lshl_add_u32 v5, v5, 5, v3
    v_add_u32 v52, 65536, v4
    v_add_u32 v53, 65536, v5
    v_add_u32 v54, 106496, v4
    v_add_u32 v55, 106496, v5
    v_add_u32 v56, 147456, v4
    v_add_u32 v57, 147456, v5
    v_add_u32 v58, 8192, v4
    v_add_u32 v59, 8192, v5
L_MAJ:
    s_and_b32 s89, s3, 3
    s_mul_i32 s89, s89, 4608
    s_add_u32 s89, s89, 0
    s_mov_b32 m0, s89
    s_lshl_b32 s88, s2, 3
    s_add_u32 s88, s88, s3
    s_mul_i32 s88, s88, 1536
    s_add_u32 s88, s88, 4194304
    s_cmp_ge_u32 s2, 240
    s_cselect_b32 s88, 2130706432, s88
    v_and_b32 v3, 15, v1
    v_lshrrev_b32 v4, 4, v1
    v_mul_u32_u24 v103, 288, v3
    v_lshl_add_u32 v103, v4, 4, v103
    v_add_u32 v103, s89, v103
    v_mov_b32 v158, 1.0
    v_mov_b32 v159, 0
    s_waitcnt vmcnt(9)
    s_branch L_KGIN
L_H0:
    s_min_u32 s6, s73, 19
    s_mul_i32 s96, s72, 20
    s_add_u32 s96, s96, s6
    s_lshl_b32 s97, s96, 2
    s_add_u32 s97, s97, s83
    s_lshl_b32 s6, s97, 1
    v_mov_b32 v12, s6
    global_load_ushort v12, v12, s[32:33]
    s_add_u32 s6, s2, s83
    s_cmp_lg_u32 s6, 0
    s_cbranch_scc1 L_NONONCE
    s_memrealtime s[8:9]
    s_waitcnt lgkmcnt(0)
    s_or_b32 s8, s8, 1
    v_mov_b32 v4, s8
    v_mov_b32 v3, 0
    global_store_dword v3, v4, s[44:45] sc1
L_NONONCE:
    s_mul_i32 s6, s4, 30
    s_add_u32 s6, s6, s73
    s_mul_i32 s7, s6, 43
    s_lshr_b32 s7, s7, 8
    s_mul_i32 s8, s7, 6
    s_sub_u32 s6, s6, s8
    s_mul_i32 s7, s7, 6144
    s_mul_i32 s8, s5, 768
    s_add_u32 s7, s7, s8
    s_lshl_b32 s8, s6, 8
    s_add_u32 s7, s7, s8
    s_cmp_ge_u32 s6, 3
    s_cselect_b32 s8, 97536, 0
    s_add_u32 s7, s7, s8
    s_add_u32 s7, s7, 786432
    s_cmp_ge_u32 s2, 240
    s_cselect_b32 s7, 2130706432, s7
    s_cmp_lg_u32 s83, 3
    s_cselect_b32 s58, 2130706432, s7
    s_mov_b64 s[64:65], s[46:47]
    s_mov_b32 s66, 23068672
    s_mov_b32 s67, 0x20000
    v_lshlrev_b32 v6, 4, v1
    s_and_b32 s4, s83, 1
    s_lshl_b32 s5, s75, 1
    s_mul_i32 s6, s4, 12288
    s_add_u32 s6, s6, s5
    s_lshr_b32 s7, s83, 1
    s_mul_i32 s7, s7, 98304
    s_add_u32 s6, s6, s7
    s_add_u32 s82, s6, 786432
    s_lshr_b32 s59, s63, 1
    s_add_u32 s59, s59, 8192
    s_and_b32 s89, s3, 3
    s_mul_i32 s89, s89, 4608
    s_add_u32 s89, s89, 40960
    s_mov_b32 m0, s89
    s_lshl_b32 s88, s2, 3
    s_add_u32 s88, s88, s3
    s_mul_i32 s88, s88, 1536
    s_add_u32 s88, s88, 4194304
    s_cmp_ge_u32 s2, 240
    s_cselect_b32 s88, 2130706432, s88
    v_and_b32 v3, 15, v1
    v_lshrrev_b32 v4, 4, v1
    v_mul_u32_u24 v103, 288, v3
    v_lshl_add_u32 v103, v4, 4, v103
    v_add_u32 v103, s89, v103
    v_mov_b32 v158, 1.0
    v_mov_b32 v159, 0
    s_cmp_ge_u32 s2, 240
    s_cbranch_scc1 L_H1
    s_waitcnt vmcnt(1)
L_KGIN:
    s_nop 1
    s_cmp_ge_u32 s2, 240
    s_cbranch_scc1 L_KGOUT
    v_mul_f32 v102, 0x3fb8aa3b, v102
    v_exp_f32 v102, v102
    s_nop 0
    v_cvt_pk_bf16_f32 v102, v102, v102
    v_lshlrev_b32 v102, 16, v102
    v_mul_f32 v96, v102, v96
    v_mul_f32 v97, v102, v97
    v_mul_f32 v98, v102, v98
    v_mul_f32 v99, v102, v99
    v_mul_f32 v96, 0x3fb8aa3b, v96
    v_mul_f32 v97, 0.15915494, v97
    v_exp_f32 v108, v96
    v_fract_f32 v109, v97
    v_mul_f32 v111, 0x43800000, v96
    v_mul_f32 v112, 0x43800000, v97
    v_cos_f32 v110, v109
    v_sin_f32 v109, v109
    v_exp_f32 v111, v111
    v_fract_f32 v112, v112
    v_mul_f32 v160, v108, v110
    v_mul_f32 v161, v108, v109
    v_cos_f32 v113, v112
    v_sin_f32 v112, v112
    v_mul_f32 v126, v100, v98
    v_mul_f32 v127, v100, v99
    v_fma_f32 v126, -v101, v99, v126
    v_fma_f32 v127, v101, v98, v127
    v_mul_f32 v194, v111, v113
    v_mul_f32 v195, v111, v112
.p2align 3
    v_pk_mul_f32 v[162:163], v[160:161], v[160:161] op_sel:[0,0] op_sel_hi:[1,0]
    v_pk_fma_f32 v[162:163], v[160:161], v[160:161], v[162:163] op_sel:[1,1,0] op_sel_hi:[0,1,1] neg_lo:[1,0,0]
    v_pk_mul_f32 v[164:165], v[160:161], v[162:163] op_sel:[0,0] op_sel_hi:[1,0]
    v_pk_fma_f32 v[164:165], v[160:161], v[162:163], v[164:165] op_sel:[1,1,0] op_sel_hi:[0,1,1] neg_lo:[1,0,0]
    v_pk_mul_f32 v[166:167], v[162:163], v[162:163] op_sel:[0,0] op_sel_hi:[1,0]
    v_pk_fma_f32 v[166:167], v[162:163], v[162:163], v[166:167] op_sel:[1,1,0] op_sel_hi:[0,1,1] neg_lo:[1,0,0]
    v_pk_mul_f32 v[168:169], v[162:163], v[164:165] op_sel:[0,0] op_sel_hi:[1,0]
    v_pk_fma_f32 v[168:169], v[162:163], v[164:165], v[168:169] op_sel:[1,1,0] op_sel_hi:[0,1,1] neg_lo:[1,0,0]
    v_pk_mul_f32 v[170:171], v[164:165], v[164:165] op_sel:[0,0] op_sel_hi:[1,0]
    v_pk_fma_f32 v[170:171], v[164:165], v[164:165], v[170:171] op_sel:[1,1,0] op_sel_hi:[0,1,1] neg_lo:[1,0,0]
    v_pk_mul_f32 v[172:173], v[164:165], v[166:167] op_sel:[0,0] op_sel_hi:[1,0]
    v_pk_fma_f32 v[172:173], v[164:165], v[166:167], v[172:173] op_sel:[1,1,0] op_sel_hi:[0,1,1] neg_lo:[1,0,0]
    v_pk_mul_f32 v[174:175], v[166:167], v[166:167] op_sel:[0,0] op_sel_hi:[1,0]
    v_pk_fma_f32 v[174:175], v[166:167], v[166:167], v[174:175] op_sel:[1,1,0] op_sel_hi:[0,1,1] neg_lo:[1,0,0]
    v_cvt_pk_bf16_f32 v210, v158, v159
    v_cvt_pk_bf16_f32 v211, v160, v161
    v_cvt_pk_bf16_f32 v212, v162, v163
    v_cvt_pk_bf16_f32 v213, v164, v165
    v_cvt_pk_bf16_f32 v214, v166, v167
    v_cvt_pk_bf16_f32 v215, v168, v169
    v_cvt_pk_bf16_f32 v216, v170, v171
    v_cvt_pk_bf16_f32 v217, v172, v173
    ds_write_addtid_b32 v210 offset:0
    ds_write_addtid_b32 v211 offset:288
    ds_write_addtid_b32 v212 offset:576
    ds_write_addtid_b32 v213 offset:864
    ds_write_addtid_b32 v214 offset:1152
    ds_write_addtid_b32 v215 offset:1440
    ds_write_addtid_b32 v216 offset:1728
    ds_write_addtid_b32 v217 offset:2016
    v_pk_mul_f32 v[176:177], v[166:167], v[168:169] op_sel:[0,0] op_sel_hi:[1,0]
    v_pk_fma_f32 v[176:177], v[166:167], v[168:169], v[176:177] op_sel:[1,1,0] op_sel_hi:[0,1,1] neg_lo:[1,0,0]
    v_pk_mul_f32 v[178:179], v[168:169], v[168:169] op_sel:[0,0] op_sel_hi:[1,0]
    v_pk_fma_f32 v[178:179], v[168:169], v[168:169], v[178:179] op_sel:[1,1,0] op_sel_hi:[0,1,1] neg_lo:[1,0,0]
    v_pk_mul_f32 v[180:181], v[168:169], v[170:171] op_sel:[0,0] op_sel_hi:[1,0]
    v_pk_fma_f32 v[180:181], v[168:169], v[170:171], v[180:181] op_sel:[1,1,0] op_sel_hi:[0,1,1] neg_lo:[1,0,0]
    v_pk_mul_f32 v[182:183], v[170:171], v[170:171] op_sel:[0,0] op_sel_hi:[1,0]
    v_pk_fma_f32 v[182:183], v[170:171], v[170:171], v[182:183] op_sel:[1,1,0] op_sel_hi:[0,1,1] neg_lo:[1,0,0]
    v_pk_mul_f32 v[184:185], v[170:171], v[172:173] op_sel:[0,0] op_sel_hi:[1,0]
    v_pk_fma_f32 v[184:185], v[170:171], v[172:173], v[184:185] op_sel:[1,1,0] op_sel_hi:[0,1,1] neg_lo:[1,0,0]
    v_pk_mul_f32 v[186:187], v[172:173], v[172:173] op_sel:[0,0] op_sel_hi:[1,0]
    v_pk_fma_f32 v[186:187], v[172:173], v[172:173], v[186:187] op_sel:[1,1,0] op_sel_hi:[0,1,1] neg_lo:[1,0,0]
    v_pk_mul_f32 v[188:189], v[172:173], v[174:175] op_sel:[0,0] op_sel_hi:[1,0]
    v_pk_fma_f32 v[188:189], v[172:173], v[174:175], v[188:189] op_sel:[1,1,0] op_sel_hi:[0,1,1] neg_lo:[1,0,0]
    v_pk_mul_f32 v[190:191], v[174:175], v[174:175] op_sel:[0,0] op_sel_hi:[1,0]
    v_pk_fma_f32 v[190:191], v[174:175], v[174:175], v[190:191] op_sel:[1,1,0] op_sel_hi:[0,1,1] neg_lo:[1,0,0]
    v_cvt_pk_bf16_f32 v210, v174, v175
    v_cvt_pk_bf16_f32 v211, v176, v177
    v_cvt_pk_bf16_f32 v212, v178, v179
    v_cvt_pk_bf16_f32 v213, v180, v181
    v_cvt_pk_bf16_f32 v214, v182, v183
    v_cvt_pk_bf16_f32 v215, v184, v185
    v_cvt_pk_bf16_f32 v216, v186, v187
    v_cvt_pk_bf16_f32 v217, v188, v189
    ds_write_addtid_b32 v210 offset:2304
    ds_write_addtid_b32 v211 offset:2592
    ds_write_addtid_b32 v212 offset:2880
    ds_write_addtid_b32 v213 offset:3168
    ds_write_addtid_b32 v214 offset:3456
    ds_write_addtid_b32 v215 offset:3744
    ds_write_addtid_b32 v216 offset:4032
    ds_write_addtid_b32 v217 offset:4320
    ds_read_b128 v[236:239], v103 offset:0
    ds_read_b128 v[240:243], v103 offset:64
    ds_read_b128 v[244:247], v103 offset:128
    ds_read_b128 v[248:251], v103 offset:192
    v_pk_mul_f32 v[128:129], v[126:127], v[190:191] op_sel:[0,0] op_sel_hi:[1,0]
    v_pk_fma_f32 v[128:129], v[126:127], v[190:191], v[128:129] op_sel:[1,1,0] op_sel_hi:[0,1,1] neg_lo:[1,0,0]
    v_pk_mul_f32 v[130:131], v[128:129], v[190:191] op_sel:[0,0] op_sel_hi:[1,0]
    v_pk_fma_f32 v[130:131], v[128:129], v[190:191], v[130:131] op_sel:[1,1,0] op_sel_hi:[0,1,1] neg_lo:[1,0,0]
    v_pk_mul_f32 v[132:133], v[130:131], v[190:191] op_sel:[0,0] op_sel_hi:[1,0]
    v_pk_fma_f32 v[132:133], v[130:131], v[190:191], v[132:133] op_sel:[1,1,0] op_sel_hi:[0,1,1] neg_lo:[1,0,0]
    v_pk_mul_f32 v[134:135], v[132:133], v[190:191] op_sel:[0,0] op_sel_hi:[1,0]
    v_pk_fma_f32 v[134:135], v[132:133], v[190:191], v[134:135] op_sel:[1,1,0] op_sel_hi:[0,1,1] neg_lo:[1,0,0]
    v_pk_mul_f32 v[136:137], v[134:135], v[190:191] op_sel:[0,0] op_sel_hi:[1,0]
    v_pk_fma_f32 v[136:137], v[134:135], v[190:191], v[136:137] op_sel:[1,1,0] op_sel_hi:[0,1,1] neg_lo:[1,0,0]
    v_pk_mul_f32 v[138:139], v[136:137], v[190:191] op_sel:[0,0] op_sel_hi:[1,0]
    v_pk_fma_f32 v[138:139], v[136:137], v[190:191], v[138:139] op_sel:[1,1,0] op_sel_hi:[0,1,1] neg_lo:[1,0,0]
    v_pk_mul_f32 v[140:141], v[138:139], v[190:191] op_sel:[0,0] op_sel_hi:[1,0]
    v_pk_fma_f32 v[140:141], v[138:139], v[190:191], v[140:141] op_sel:[1,1,0] op_sel_hi:[0,1,1] neg_lo:[1,0,0]
    v_cvt_pk_bf16_f32 v210, v126, -v127
    v_cvt_pk_bf16_f32 v211, v128, -v129
    v_cvt_pk_bf16_f32 v212, v130, -v131
    v_cvt_pk_bf16_f32 v213, v132, -v133
    v_cvt_pk_bf16_f32 v214, v134, -v135
    v_cvt_pk_bf16_f32 v215, v136, -v137
    v_cvt_pk_bf16_f32 v216, v138, -v139
    v_cvt_pk_bf16_f32 v217, v140, -v141
    ds_write_addtid_b32 v210 offset:0
    ds_write_addtid_b32 v211 offset:288
    ds_write_addtid_b32 v212 offset:576
    ds_write_addtid_b32 v213 offset:864
    ds_write_addtid_b32 v214 offset:1152
    ds_write_addtid_b32 v215 offset:1440
    ds_write_addtid_b32 v216 offset:1728
    ds_write_addtid_b32 v217 offset:2016
    v_pk_mul_f32 v[142:143], v[140:141], v[190:191] op_sel:[0,0] op_sel_hi:[1,0]
    v_pk_fma_f32 v[142:143], v[140:141], v[190:191], v[142:143] op_sel:[1,1,0] op_sel_hi:[0,1,1] neg_lo:[1,0,0]
    v_pk_mul_f32 v[144:145], v[142:143], v[190:191] op_sel:[0,0] op_sel_hi:[1,0]
    v_pk_fma_f32 v[144:145], v[142:143], v[190:191], v[144:145] op_sel:[1,1,0] op_sel_hi:[0,1,1] neg_lo:[1,0,0]
    v_pk_mul_f32 v[146:147], v[144:145], v[190:191] op_sel:[0,0] op_sel_hi:[1,0]
    v_pk_fma_f32 v[146:147], v[144:145], v[190:191], v[146:147] op_sel:[1,1,0] op_sel_hi:[0,1,1] neg_lo:[1,0,0]
    v_pk_mul_f32 v[148:149], v[146:147], v[190:191] op_sel:[0,0] op_sel_hi:[1,0]
    v_pk_fma_f32 v[148:149], v[146:147], v[190:191], v[148:149] op_sel:[1,1,0] op_sel_hi:[0,1,1] neg_lo:[1,0,0]
    v_pk_mul_f32 v[150:151], v[148:149], v[190:191] op_sel:[0,0] op_sel_hi:[1,0]
    v_pk_fma_f32 v[150:151], v[148:149], v[190:191], v[150:151] op_sel:[1,1,0] op_sel_hi:[0,1,1] neg_lo:[1,0,0]
    v_pk_mul_f32 v[152:153], v[150:151], v[190:191] op_sel:[0,0] op_sel_hi:[1,0]
    v_pk_fma_f32 v[152:153], v[150:151], v[190:191], v[152:153] op_sel:[1,1,0] op_sel_hi:[0,1,1] neg_lo:[1,0,0]
    v_pk_mul_f32 v[154:155], v[152:153], v[190:191] op_sel:[0,0] op_sel_hi:[1,0]
    v_pk_fma_f32 v[154:155], v[152:153], v[190:191], v[154:155] op_sel:[1,1,0] op_sel_hi:[0,1,1] neg_lo:[1,0,0]
    v_pk_mul_f32 v[156:157], v[154:155], v[190:191] op_sel:[0,0] op_sel_hi:[1,0]
    v_pk_fma_f32 v[156:157], v[154:155], v[190:191], v[156:157] op_sel:[1,1,0] op_sel_hi:[0,1,1] neg_lo:[1,0,0]
    v_cvt_pk_bf16_f32 v210, v142, -v143
    v_cvt_pk_bf16_f32 v211, v144, -v145
    v_cvt_pk_bf16_f32 v212, v146, -v147
    v_cvt_pk_bf16_f32 v213, v148, -v149
    v_cvt_pk_bf16_f32 v214, v150, -v151
    v_cvt_pk_bf16_f32 v215, v152, -v153
    v_cvt_pk_bf16_f32 v216, v154, -v155
    v_cvt_pk_bf16_f32 v217, v156, -v157
    ds_write_addtid_b32 v210 offset:2304
    ds_write_addtid_b32 v211 offset:2592
    ds_write_addtid_b32 v212 offset:2880
    ds_write_addtid_b32 v213 offset:3168
    ds_write_addtid_b32 v214 offset:3456
    ds_write_addtid_b32 v215 offset:3744
    ds_write_addtid_b32 v216 offset:4032
    ds_write_addtid_b32 v217 offset:4320
    ds_read_b128 v[220:223], v103 offset:0
    ds_read_b128 v[224:227], v103 offset:64
    ds_read_b128 v[228:231], v103 offset:128
    ds_read_b128 v[232:235], v103 offset:192
    s_cmp_lt_u32 s3, 4
    s_cbranch_scc1 HK_1
    s_add_u32 m0, s62, 81920
    s_add_u32 s4, s60, 0
    buffer_load_dwordx4 v7, s[48:51], s4 offen lds
    s_add_u32 m0, s63, 106496
    s_add_u32 s4, s61, 0
    buffer_load_dwordx4 v9, s[52:55], s4 offen lds
    s_add_u32 m0, s62, 82944
    s_add_u32 s4, s60, 10240
    buffer_load_dwordx4 v8, s[48:51], s4 offen lds
    s_add_u32 m0, s63, 107520
    s_add_u32 s4, s61, 24576
    buffer_load_dwordx4 v10, s[52:55], s4 offen lds
    s_add_u32 m0, s62, 83968
    s_add_u32 s4, s60, 20480
    buffer_load_dwordx4 v7, s[48:51], s4 offen lds
    s_add_u32 m0, s62, 84992
    s_add_u32 s4, s60, 30720
    buffer_load_dwordx4 v8, s[48:51], s4 offen lds
    s_mov_b32 m0, s89
    s_setprio 1
HK_1:
.p2align 3
    v_pk_mul_f32 v[144:145], v[194:195], v[162:163] op_sel:[0,0] op_sel_hi:[1,0]
    v_pk_fma_f32 v[144:145], v[194:195], v[162:163], v[144:145] op_sel:[1,1,0] op_sel_hi:[0,1,1] neg_lo:[1,0,0]
    v_pk_mul_f32 v[146:147], v[194:195], v[166:167] op_sel:[0,0] op_sel_hi:[1,0]
    v_pk_fma_f32 v[146:147], v[194:195], v[166:167], v[146:147] op_sel:[1,1,0] op_sel_hi:[0,1,1] neg_lo:[1,0,0]
    v_pk_mul_f32 v[148:149], v[194:195], v[170:171] op_sel:[0,0] op_sel_hi:[1,0]
    v_pk_fma_f32 v[148:149], v[194:195], v[170:171], v[148:149] op_sel:[1,1,0] op_sel_hi:[0,1,1] neg_lo:[1,0,0]
    v_pk_mul_f32 v[150:151], v[194:195], v[174:175] op_sel:[0,0] op_sel_hi:[1,0]
    v_pk_fma_f32 v[150:151], v[194:195], v[174:175], v[150:151] op_sel:[1,1,0] op_sel_hi:[0,1,1] neg_lo:[1,0,0]
    v_pk_mul_f32 v[152:153], v[194:195], v[178:179] op_sel:[0,0] op_sel_hi:[1,0]
    v_pk_fma_f32 v[152:153], v[194:195], v[178:179], v[152:153] op_sel:[1,1,0] op_sel_hi:[0,1,1] neg_lo:[1,0,0]
    v_pk_mul_f32 v[154:155], v[194:195], v[182:183] op_sel:[0,0] op_sel_hi:[1,0]
    v_pk_fma_f32 v[154:155], v[194:195], v[182:183], v[154:155] op_sel:[1,1,0] op_sel_hi:[0,1,1] neg_lo:[1,0,0]
    v_pk_mul_f32 v[156:157], v[194:195], v[186:187] op_sel:[0,0] op_sel_hi:[1,0]
    v_pk_fma_f32 v[156:157], v[194:195], v[186:187], v[156:157] op_sel:[1,1,0] op_sel_hi:[0,1,1] neg_lo:[1,0,0]
    v_pk_mul_f32 v[196:197], v[194:195], v[194:195] op_sel:[0,0] op_sel_hi:[1,0]
    v_pk_fma_f32 v[196:197], v[194:195], v[194:195], v[196:197] op_sel:[1,1,0] op_sel_hi:[0,1,1] neg_lo:[1,0,0]
    v_pk_mul_f32 v[198:199], v[196:197], v[194:195] op_sel:[0,0] op_sel_hi:[1,0]
    v_pk_fma_f32 v[198:199], v[196:197], v[194:195], v[198:199] op_sel:[1,1,0] op_sel_hi:[0,1,1] neg_lo:[1,0,0]
    s_waitcnt lgkmcnt(0)
.p2align 3
    v_mfma_f32_16x16x32_bf16 v[114:117], v[236:239], v[220:223], 0
    v_mfma_f32_16x16x32_bf16 v[114:117], v[240:243], v[224:227], v[114:117]
    v_mfma_f32_16x16x32_bf16 v[114:117], v[244:247], v[228:231], v[114:117]
    v_mfma_f32_16x16x32_bf16 v[114:117], v[248:251], v[232:235], v[114:117]
    v_cvt_pk_bf16_f32 v210, v194, v195
    v_cvt_pk_bf16_f32 v211, v144, v145
    v_cvt_pk_bf16_f32 v212, v146, v147
    v_cvt_pk_bf16_f32 v213, v148, v149
    v_cvt_pk_bf16_f32 v214, v150, v151
    v_cvt_pk_bf16_f32 v215, v152, v153
    v_cvt_pk_bf16_f32 v216, v154, v155
    v_cvt_pk_bf16_f32 v217, v156, v157
    ds_write_addtid_b32 v210 offset:0
    ds_write_addtid_b32 v211 offset:288
    ds_write_addtid_b32 v212 offset:576
    ds_write_addtid_b32 v213 offset:864
    ds_write_addtid_b32 v214 offset:1152
    ds_write_addtid_b32 v215 offset:1440
    ds_write_addtid_b32 v216 offset:1728
    ds_write_addtid_b32 v217 offset:2016
    s_cmp_lt_u32 s3, 4
    s_cbranch_scc1 HK_2
    s_add_u32 m0, s63, 108544
    s_add_u32 s4, s61, 49152
    buffer_load_dwordx4 v9, s[52:55], s4 offen lds
    s_add_u32 m0, s62, 86016
    s_add_u32 s4, s60, 40960
    buffer_load_dwordx4 v7, s[48:51], s4 offen lds
    s_add_u32 m0, s63, 109568
    s_add_u32 s4, s61, 73728
    buffer_load_dwordx4 v10, s[52:55], s4 offen lds
    s_add_u32 m0, s62, 87040
    s_add_u32 s4, s60, 51200
    buffer_load_dwordx4 v8, s[48:51], s4 offen lds
    s_add_u32 m0, s62, 122880
    s_add_u32 s4, s90, 128
    buffer_load_dwordx4 v7, s[48:51], s4 offen lds
    s_add_u32 m0, s63, 147456
    s_add_u32 s4, s91, 196608
    buffer_load_dwordx4 v9, s[52:55], s4 offen lds
    s_mov_b32 m0, s89
HK_2:
.p2align 3
    v_pk_mul_f32 v[144:145], v[196:197], v[166:167] op_sel:[0,0] op_sel_hi:[1,0]
    v_pk_fma_f32 v[144:145], v[196:197], v[166:167], v[144:145] op_sel:[1,1,0] op_sel_hi:[0,1,1] neg_lo:[1,0,0]
    v_pk_mul_f32 v[152:153], v[198:199], v[166:167] op_sel:[0,0] op_sel_hi:[1,0]
    v_pk_fma_f32 v[152:153], v[198:199], v[166:167], v[152:153] op_sel:[1,1,0] op_sel_hi:[0,1,1] neg_lo:[1,0,0]
    v_pk_mul_f32 v[146:147], v[196:197], v[174:175] op_sel:[0,0] op_sel_hi:[1,0]
    v_pk_fma_f32 v[146:147], v[196:197], v[174:175], v[146:147] op_sel:[1,1,0] op_sel_hi:[0,1,1] neg_lo:[1,0,0]
    v_pk_mul_f32 v[154:155], v[198:199], v[174:175] op_sel:[0,0] op_sel_hi:[1,0]
    v_pk_fma_f32 v[154:155], v[198:199], v[174:175], v[154:155] op_sel:[1,1,0] op_sel_hi:[0,1,1] neg_lo:[1,0,0]
    v_pk_mul_f32 v[148:149], v[196:197], v[182:183] op_sel:[0,0] op_sel_hi:[1,0]
    v_pk_fma_f32 v[148:149], v[196:197], v[182:183], v[148:149] op_sel:[1,1,0] op_sel_hi:[0,1,1] neg_lo:[1,0,0]
    v_pk_mul_f32 v[156:157], v[198:199], v[182:183] op_sel:[0,0] op_sel_hi:[1,0]
    v_pk_fma_f32 v[156:157], v[198:199], v[182:183], v[156:157] op_sel:[1,1,0] op_sel_hi:[0,1,1] neg_lo:[1,0,0]
    v_cvt_pk_bf16_f32 v210, v196, v197
    v_cvt_pk_bf16_f32 v211, v144, v145
    v_cvt_pk_bf16_f32 v212, v146, v147
    v_cvt_pk_bf16_f32 v213, v148, v149
    v_cvt_pk_bf16_f32 v214, v198, v199
    v_cvt_pk_bf16_f32 v215, v152, v153
    v_cvt_pk_bf16_f32 v216, v154, v155
    v_cvt_pk_bf16_f32 v217, v156, v157
    ds_write_addtid_b32 v210 offset:2304
    ds_write_addtid_b32 v211 offset:2592
    ds_write_addtid_b32 v212 offset:2880
    ds_write_addtid_b32 v213 offset:3168
    ds_write_addtid_b32 v214 offset:3456
    ds_write_addtid_b32 v215 offset:3744
    ds_write_addtid_b32 v216 offset:4032
    ds_write_addtid_b32 v217 offset:4320
    ds_read_b128 v[126:129], v103 offset:0
    ds_read_b128 v[130:133], v103 offset:64
    ds_read_b128 v[134:137], v103 offset:128
    ds_read_b128 v[138:141], v103 offset:192
    s_cmp_lt_u32 s3, 4
    s_cbranch_scc1 HK_3
    s_add_u32 m0, s62, 123904
    s_add_u32 s4, s90, 10368
    buffer_load_dwordx4 v8, s[48:51], s4 offen lds
    s_add_u32 m0, s63, 148480
    s_add_u32 s4, s91, 221184
    buffer_load_dwordx4 v10, s[52:55], s4 offen lds
    s_add_u32 m0, s62, 124928
    s_add_u32 s4, s90, 20608
    buffer_load_dwordx4 v7, s[48:51], s4 offen lds
    s_add_u32 m0, s62, 125952
    s_add_u32 s4, s90, 30848
    buffer_load_dwordx4 v8, s[48:51], s4 offen lds
    s_add_u32 m0, s63, 149504
    s_add_u32 s4, s91, 245760
    buffer_load_dwordx4 v9, s[52:55], s4 offen lds
    s_add_u32 m0, s62, 126976
    s_add_u32 s4, s90, 41088
    buffer_load_dwordx4 v7, s[48:51], s4 offen lds
    s_mov_b32 m0, s89
HK_3:
.p2align 3
    v_pk_mul_f32 v[200:201], v[196:197], v[196:197] op_sel:[0,0] op_sel_hi:[1,0]
    v_pk_fma_f32 v[200:201], v[196:197], v[196:197], v[200:201] op_sel:[1,1,0] op_sel_hi:[0,1,1] neg_lo:[1,0,0]
    v_pk_mul_f32 v[202:203], v[196:197], v[198:199] op_sel:[0,0] op_sel_hi:[1,0]
    v_pk_fma_f32 v[202:203], v[196:197], v[198:199], v[202:203] op_sel:[1,1,0] op_sel_hi:[0,1,1] neg_lo:[1,0,0]
    v_pk_mul_f32 v[204:205], v[198:199], v[198:199] op_sel:[0,0] op_sel_hi:[1,0]
    v_pk_fma_f32 v[204:205], v[198:199], v[198:199], v[204:205] op_sel:[1,1,0] op_sel_hi:[0,1,1] neg_lo:[1,0,0]
    v_pk_mul_f32 v[206:207], v[198:199], v[200:201] op_sel:[0,0] op_sel_hi:[1,0]
    v_pk_fma_f32 v[206:207], v[198:199], v[200:201], v[206:207] op_sel:[1,1,0] op_sel_hi:[0,1,1] neg_lo:[1,0,0]
    v_pk_mul_f32 v[208:209], v[200:201], v[200:201] op_sel:[0,0] op_sel_hi:[1,0]
    v_pk_fma_f32 v[208:209], v[200:201], v[200:201], v[208:209] op_sel:[1,1,0] op_sel_hi:[0,1,1] neg_lo:[1,0,0]
    v_pk_mul_f32 v[142:143], v[200:201], v[174:175] op_sel:[0,0] op_sel_hi:[1,0]
    v_pk_fma_f32 v[142:143], v[200:201], v[174:175], v[142:143] op_sel:[1,1,0] op_sel_hi:[0,1,1] neg_lo:[1,0,0]
    v_pk_mul_f32 v[144:145], v[202:203], v[174:175] op_sel:[0,0] op_sel_hi:[1,0]
    v_pk_fma_f32 v[144:145], v[202:203], v[174:175], v[144:145] op_sel:[1,1,0] op_sel_hi:[0,1,1] neg_lo:[1,0,0]
    v_pk_mul_f32 v[146:147], v[204:205], v[174:175] op_sel:[0,0] op_sel_hi:[1,0]
    v_pk_fma_f32 v[146:147], v[204:205], v[174:175], v[146:147] op_sel:[1,1,0] op_sel_hi:[0,1,1] neg_lo:[1,0,0]
    v_pk_mul_f32 v[148:149], v[206:207], v[174:175] op_sel:[0,0] op_sel_hi:[1,0]
    v_pk_fma_f32 v[148:149], v[206:207], v[174:175], v[148:149] op_sel:[1,1,0] op_sel_hi:[0,1,1] neg_lo:[1,0,0]
    s_waitcnt lgkmcnt(0)
.p2align 3
    v_mfma_f32_16x16x32_bf16 v[118:121], v[126:129], v[220:223], 0
    v_mfma_f32_16x16x32_bf16 v[118:121], v[130:133], v[224:227], v[118:121]
    v_mfma_f32_16x16x32_bf16 v[118:121], v[134:137], v[228:231], v[118:121]
    v_mfma_f32_16x16x32_bf16 v[118:121], v[138:141], v[232:235], v[118:121]
    v_cvt_pk_bf16_f32 v210, v200, v201
    v_cvt_pk_bf16_f32 v211, v142, v143
    v_cvt_pk_bf16_f32 v212, v202, v203
    v_cvt_pk_bf16_f32 v213, v144, v145
    v_cvt_pk_bf16_f32 v214, v204, v205
    v_cvt_pk_bf16_f32 v215, v146, v147
    v_cvt_pk_bf16_f32 v216, v206, v207
    v_cvt_pk_bf16_f32 v217, v148, v149
    v_cvt_pk_bf16_f32 v218, v208, v209
    ds_write_addtid_b32 v210 offset:0
    ds_write_addtid_b32 v211 offset:288
    ds_write_addtid_b32 v212 offset:576
    ds_write_addtid_b32 v213 offset:864
    ds_write_addtid_b32 v214 offset:1152
    ds_write_addtid_b32 v215 offset:1440
    ds_write_addtid_b32 v216 offset:1728
    ds_write_addtid_b32 v217 offset:2016
    ds_write_addtid_b32 v218 offset:2304
    ds_read_b128 v[236:239], v103 offset:0
    ds_read_b128 v[240:243], v103 offset:64
    ds_read_b128 v[244:247], v103 offset:128
    ds_read_b128 v[248:251], v103 offset:192
    s_cmp_lt_u32 s3, 4
    s_cbranch_scc1 HK_4
    s_add_u32 m0, s63, 150528
    s_add_u32 s4, s91, 270336
    buffer_load_dwordx4 v10, s[52:55], s4 offen lds
    s_add_u32 m0, s62, 128000
    s_add_u32 s4, s90, 51328
    buffer_load_dwordx4 v8, s[48:51], s4 offen lds
    s_add_u32 m0, s63, 65536
    s_add_u32 s4, s61, 393216
    buffer_load_dwordx4 v9, s[52:55], s4 offen lds
    s_add_u32 m0, s63, 66560
    s_add_u32 s4, s61, 417792
    buffer_load_dwordx4 v10, s[52:55], s4 offen lds
    s_add_u32 m0, s63, 67584
    s_add_u32 s4, s61, 442368
    buffer_load_dwordx4 v9, s[52:55], s4 offen lds
    s_add_u32 m0, s63, 68608
    s_add_u32 s4, s61, 466944
    buffer_load_dwordx4 v10, s[52:55], s4 offen lds
    s_mov_b32 m0, s89
HK_4:
.p2align 3
    s_waitcnt lgkmcnt(0)
.p2align 3
    v_mfma_f32_16x16x32_bf16 v[122:125], v[236:239], v[220:223], 0
    v_mfma_f32_16x16x32_bf16 v[122:125], v[240:243], v[224:227], v[122:125]
    v_mfma_f32_16x16x32_bf16 v[122:125], v[244:247], v[228:231], v[122:125]
    v_mfma_f32_16x16x32_bf16 v[122:125], v[248:251], v[232:235], v[122:125]
    v_cvt_pk_bf16_f32 v210, v114, v115
    v_cvt_pk_bf16_f32 v211, v116, v117
    v_cvt_pk_bf16_f32 v212, v118, v119
    v_cvt_pk_bf16_f32 v213, v120, v121
    s_nop 3
    v_cvt_pk_bf16_f32 v214, v122, v123
    v_cvt_pk_bf16_f32 v215, v124, v125
L_KGOUT:
    s_cmp_ge_u32 s3, 4
    s_cbranch_scc1 L_H1
    s_waitcnt vmcnt(6)
    v_lshlrev_b32 v60, 16, v12
    v_and_b32 v61, 0xffff0000, v12
    v_lshlrev_b32 v62, 16, v13
    v_and_b32 v63, 0xffff0000, v13
    v_lshlrev_b32 v64, 16, v14
    v_and_b32 v65, 0xffff0000, v14
    v_lshlrev_b32 v66, 16, v15
    v_and_b32 v67, 0xffff0000, v15
    v_lshlrev_b32 v68, 16, v16
    v_and_b32 v69, 0xffff0000, v16
    v_lshlrev_b32 v70, 16, v17
    v_and_b32 v71, 0xffff0000, v17
    v_lshlrev_b32 v72, 16, v18
    v_and_b32 v73, 0xffff0000, v18
    v_lshlrev_b32 v74, 16, v19
    v_and_b32 v75, 0xffff0000, v19
    v_lshlrev_b32 v76, 16, v20
    v_and_b32 v77, 0xffff0000, v20
    v_lshlrev_b32 v78, 16, v21
    v_and_b32 v79, 0xffff0000, v21
    v_pk_add_f32 v[80:81], v[60:61], v[62:63]
    v_pk_add_f32 v[80:81], v[80:81], v[64:65]
    v_pk_add_f32 v[80:81], v[80:81], v[66:67]
    v_pk_add_f32 v[80:81], v[80:81], v[68:69]
    v_pk_add_f32 v[80:81], v[80:81], v[70:71]
    v_pk_add_f32 v[80:81], v[80:81], v[72:73]
    v_pk_add_f32 v[80:81], v[80:81], v[74:75]
    v_pk_add_f32 v[80:81], v[80:81], v[76:77]
    v_pk_add_f32 v[80:81], v[80:81], v[78:79]
    v_add_f32 v84, v80, v81
    s_nop 1
    v_add_f32_dpp v84, v84, v84 quad_perm:[1,0,3,2] row_mask:0xf bank_mask:0xf
    s_nop 1
    v_add_f32_dpp v84, v84, v84 quad_perm:[2,3,0,1] row_mask:0xf bank_mask:0xf
    s_nop 1
    v_add_f32_dpp v84, v84, v84 row_half_mirror row_mask:0xf bank_mask:0xf
    s_nop 1
    v_add_f32_dpp v84, v84, v84 row_mirror row_mask:0xf bank_mask:0xf
    v_mov_b32 v82, v84
    s_nop 1
    v_permlane16_swap_b32 v84, v82
    v_add_f32 v84, v84, v82
    v_mul_f32 v84, 0x3acccccd, v84
    v_pk_add_f32 v[82:83], v[60:61], v[84:85] op_sel_hi:[1,0] neg_lo:[0,1] neg_hi:[0,1]
    v_pk_mul_f32 v[80:81], v[82:83], v[82:83]
    v_pk_add_f32 v[82:83], v[62:63], v[84:85] op_sel_hi:[1,0] neg_lo:[0,1] neg_hi:[0,1]
    v_pk_fma_f32 v[80:81], v[82:83], v[82:83], v[80:81]
    v_pk_add_f32 v[82:83], v[64:65], v[84:85] op_sel_hi:[1,0] neg_lo:[0,1] neg_hi:[0,1]
    v_pk_fma_f32 v[80:81], v[82:83], v[82:83], v[80:81]
    v_pk_add_f32 v[82:83], v[66:67], v[84:85] op_sel_hi:[1,0] neg_lo:[0,1] neg_hi:[0,1]
    v_pk_fma_f32 v[80:81], v[82:83], v[82:83], v[80:81]
    v_pk_add_f32 v[82:83], v[68:69], v[84:85] op_sel_hi:[1,0] neg_lo:[0,1] neg_hi:[0,1]
    v_pk_fma_f32 v[80:81], v[82:83], v[82:83], v[80:81]
    v_pk_add_f32 v[82:83], v[70:71], v[84:85] op_sel_hi:[1,0] neg_lo:[0,1] neg_hi:[0,1]
    v_pk_fma_f32 v[80:81], v[82:83], v[82:83], v[80:81]
    v_pk_add_f32 v[82:83], v[72:73], v[84:85] op_sel_hi:[1,0] neg_lo:[0,1] neg_hi:[0,1]
    v_pk_fma_f32 v[80:81], v[82:83], v[82:83], v[80:81]
    v_pk_add_f32 v[82:83], v[74:75], v[84:85] op_sel_hi:[1,0] neg_lo:[0,1] neg_hi:[0,1]
    v_pk_fma_f32 v[80:81], v[82:83], v[82:83], v[80:81]
    v_pk_add_f32 v[82:83], v[76:77], v[84:85] op_sel_hi:[1,0] neg_lo:[0,1] neg_hi:[0,1]
    v_pk_fma_f32 v[80:81], v[82:83], v[82:83], v[80:81]
    v_pk_add_f32 v[82:83], v[78:79], v[84:85] op_sel_hi:[1,0] neg_lo:[0,1] neg_hi:[0,1]
    v_pk_fma_f32 v[80:81], v[82:83], v[82:83], v[80:81]
    v_add_f32 v86, v80, v81
    v_cvt_pk_bf16_f32 v84, v84, v84
    v_lshlrev_b32 v84, 16, v84
    v_add_f32_dpp v86, v86, v86 quad_perm:[1,0,3,2] row_mask:0xf bank_mask:0xf
    s_nop 1
    v_add_f32_dpp v86, v86, v86 quad_perm:[2,3,0,1] row_mask:0xf bank_mask:0xf
    s_nop 1
    v_add_f32_dpp v86, v86, v86 row_half_mirror row_mask:0xf bank_mask:0xf
    s_nop 1
    v_add_f32_dpp v86, v86, v86 row_mirror row_mask:0xf bank_mask:0xf
    v_mov_b32 v82, v86
    s_nop 1
    v_permlane16_swap_b32 v86, v82
    v_add_f32 v86, v86, v82
    v_mul_f32 v86, 0x3acccccd, v86
    v_cvt_pk_bf16_f32 v86, v86, v86
    v_lshlrev_b32 v86, 16, v86
    v_add_f32 v86, 0x3727c5ac, v86
    v_cvt_pk_bf16_f32 v86, v86, v86
    v_lshlrev_b32 v86, 16, v86
    v_sqrt_f32 v86, v86
    v_cvt_pk_bf16_f32 v88, -v84, -v84
    v_cvt_pk_bf16_f32 v86, v86, v86
    v_lshlrev_b32 v89, 16, v86
    v_rcp_f32 v86, v89
    v_pk_add_f32 v[60:61], v[60:61], v[84:85] op_sel_hi:[1,0] neg_lo:[0,1] neg_hi:[0,1]
    v_pk_add_f32 v[62:63], v[62:63], v[84:85] op_sel_hi:[1,0] neg_lo:[0,1] neg_hi:[0,1]
    v_pk_add_f32 v[64:65], v[64:65], v[84:85] op_sel_hi:[1,0] neg_lo:[0,1] neg_hi:[0,1]
    v_pk_add_f32 v[66:67], v[66:67], v[84:85] op_sel_hi:[1,0] neg_lo:[0,1] neg_hi:[0,1]
    v_pk_add_f32 v[68:69], v[68:69], v[84:85] op_sel_hi:[1,0] neg_lo:[0,1] neg_hi:[0,1]
    v_pk_add_f32 v[70:71], v[70:71], v[84:85] op_sel_hi:[1,0] neg_lo:[0,1] neg_hi:[0,1]
    v_pk_add_f32 v[72:73], v[72:73], v[84:85] op_sel_hi:[1,0] neg_lo:[0,1] neg_hi:[0,1]
    v_pk_add_f32 v[74:75], v[74:75], v[84:85] op_sel_hi:[1,0] neg_lo:[0,1] neg_hi:[0,1]
    v_pk_add_f32 v[76:77], v[76:77], v[84:85] op_sel_hi:[1,0] neg_lo:[0,1] neg_hi:[0,1]
    v_pk_add_f32 v[78:79], v[78:79], v[84:85] op_sel_hi:[1,0] neg_lo:[0,1] neg_hi:[0,1]
    v_pk_mul_f32 v[60:61], v[60:61], v[86:87] op_sel_hi:[1,0]
    v_pk_mul_f32 v[62:63], v[62:63], v[86:87] op_sel_hi:[1,0]
    v_pk_mul_f32 v[64:65], v[64:65], v[86:87] op_sel_hi:[1,0]
    v_pk_mul_f32 v[66:67], v[66:67], v[86:87] op_sel_hi:[1,0]
    v_pk_mul_f32 v[68:69], v[68:69], v[86:87] op_sel_hi:[1,0]
    v_pk_mul_f32 v[70:71], v[70:71], v[86:87] op_sel_hi:[1,0]
    v_pk_mul_f32 v[72:73], v[72:73], v[86:87] op_sel_hi:[1,0]
    v_pk_mul_f32 v[74:75], v[74:75], v[86:87] op_sel_hi:[1,0]
    v_pk_mul_f32 v[76:77], v[76:77], v[86:87] op_sel_hi:[1,0]
    v_pk_mul_f32 v[78:79], v[78:79], v[86:87] op_sel_hi:[1,0]
    v_cvt_pk_bf16_f32 v12, v60, v61
    v_cvt_pk_bf16_f32 v13, v62, v63
    v_cvt_pk_bf16_f32 v14, v64, v65
    v_cvt_pk_bf16_f32 v15, v66, v67
    v_cvt_pk_bf16_f32 v16, v68, v69
    v_cvt_pk_bf16_f32 v17, v70, v71
    v_cvt_pk_bf16_f32 v18, v72, v73
    v_cvt_pk_bf16_f32 v19, v74, v75
    v_cvt_pk_bf16_f32 v20, v76, v77
    v_cvt_pk_bf16_f32 v21, v78, v79
    ds_write_b128 v22, v[12:15]
    ds_write_b128 v22, v[16:19] offset:512
    ds_write_b64 v23, v[20:21] offset:1024
    s_waitcnt vmcnt(0)
    ds_read_b64_tr_b16 v[12:13], v40 offset:0
    ds_read_b64_tr_b16 v[14:15], v40 offset:256
    ds_read_b64_tr_b16 v[16:17], v40 offset:32
    ds_read_b64_tr_b16 v[18:19], v40 offset:288
    v_lshrrev_b32 v41, 2, v1
    s_mov_b32 exec_lo, 1
    s_mov_b32 exec_hi, 1
    buffer_store_dwordx2 v[88:89], v41, s[64:67], s58 offen sc1
    s_mov_b64 exec, -1
    v_mfma_f32_16x16x32_bf16 v[20:23], v[42:45], v[24:27], 0
    v_mfma_f32_16x16x32_bf16 v[20:23], v[42:45], v[28:31], v[20:23]
    v_mfma_f32_16x16x32_bf16 v[20:23], v[42:45], v[32:35], v[20:23]
    v_mfma_f32_16x16x32_bf16 v[20:23], v[42:45], v[36:39], v[20:23]
    v_add_u32 v3, s89, v6
    s_nop 6
    ds_write_b128 v3, v[20:23]
    v_lshlrev_b32 v3, 3, v1
    buffer_store_dwordx4 v[210:213], v6, s[64:67], s88 offen sc1
    buffer_store_dwordx2 v[214:215], v3, s[64:67], s88 offen offset:1024 sc1
    s_mov_b64 s[96:97], s[56:57]
    s_waitcnt lgkmcnt(0)
    s_setprio 2
    s_cmp_ge_u32 s73, 30
    s_cbranch_scc1 L_G1B
    s_barrier
    ds_read_b128 v[156:159], v48 offset:0
    ds_read_b64_tr_b16 v[180:181], v54 offset:0
    ds_read_b64_tr_b16 v[182:183], v54 offset:512
    ds_read_b64_tr_b16 v[188:189], v54 offset:8192
    ds_read_b64_tr_b16 v[190:191], v54 offset:8704
    ds_read_b64_tr_b16 v[184:185], v55 offset:0
    ds_read_b64_tr_b16 v[186:187], v55 offset:512
    ds_read_b64_tr_b16 v[192:193], v55 offset:8192
    ds_read_b64_tr_b16 v[194:195], v55 offset:8704
    ds_read_b128 v[160:163], v48 offset:2048
    ds_read_b128 v[164:167], v48 offset:4096
    ds_read_b128 v[168:171], v48 offset:6144
    ds_read_b128 v[172:175], v48 offset:8192
    ds_read_b128 v[176:179], v48 offset:10240
    s_waitcnt lgkmcnt(11)
    v_mfma_f32_16x16x32_bf16 v[60:63], v[180:183], v[156:159], 0
    ds_read_b128 v[196:199], v49 offset:0
    s_waitcnt lgkmcnt(10)
    v_mfma_f32_16x16x32_bf16 v[68:71], v[188:191], v[156:159], 0
    ds_read_b64_tr_b16 v[220:221], v54 offset:4096
    s_waitcnt lgkmcnt(9)
    v_mfma_f32_16x16x32_bf16 v[64:67], v[184:187], v[156:159], 0
    ds_read_b64_tr_b16 v[222:223], v54 offset:4608
    s_waitcnt lgkmcnt(8)
    v_mfma_f32_16x16x32_bf16 v[72:75], v[192:195], v[156:159], 0
    ds_read_b64_tr_b16 v[228:229], v54 offset:12288
    s_waitcnt lgkmcnt(8)
    v_mfma_f32_16x16x32_bf16 v[88:91], v[192:195], v[160:163], 0
    ds_read_b64_tr_b16 v[230:231], v54 offset:12800
    v_mfma_f32_16x16x32_bf16 v[80:83], v[184:187], v[160:163], 0
    ds_read_b64_tr_b16 v[224:225], v55 offset:4096
    v_mfma_f32_16x16x32_bf16 v[84:87], v[188:191], v[160:163], 0
    ds_read_b64_tr_b16 v[226:227], v55 offset:4608
    v_mfma_f32_16x16x32_bf16 v[76:79], v[180:183], v[160:163], 0
    ds_read_b64_tr_b16 v[232:233], v55 offset:12288
    s_waitcnt lgkmcnt(11)
    v_mfma_f32_16x16x32_bf16 v[92:95], v[180:183], v[164:167], 0
    ds_read_b64_tr_b16 v[234:235], v55 offset:12800
    v_mfma_f32_16x16x32_bf16 v[100:103], v[188:191], v[164:167], 0
    ds_read_b128 v[200:203], v49 offset:2048
    v_mfma_f32_16x16x32_bf16 v[96:99], v[184:187], v[164:167], 0
    ds_read_b128 v[204:207], v49 offset:4096
    v_mfma_f32_16x16x32_bf16 v[104:107], v[192:195], v[164:167], 0
    ds_read_b128 v[208:211], v49 offset:6144
    s_waitcnt lgkmcnt(14)
    v_mfma_f32_16x16x32_bf16 v[120:123], v[192:195], v[168:171], 0
    ds_read_b128 v[212:215], v49 offset:8192
    v_mfma_f32_16x16x32_bf16 v[112:115], v[184:187], v[168:171], 0
    ds_read_b128 v[216:219], v49 offset:10240
    v_mfma_f32_16x16x32_bf16 v[116:119], v[188:191], v[168:171], 0
    v_mov_b32 v8, 0
    global_load_dword v7, v8, s[44:45] sc1
    v_mfma_f32_16x16x32_bf16 v[108:111], v[180:183], v[168:171], 0
    s_mov_b64 s[68:69], s[42:43]
    s_mov_b32 s70, 2621440
    s_waitcnt lgkmcnt(15)
    v_mfma_f32_16x16x32_bf16 v[124:127], v[180:183], v[172:175], 0
    s_mov_b32 s71, 0x20000
    v_and_b32 v3, 15, v1
    v_mfma_f32_16x16x32_bf16 v[132:135], v[188:191], v[172:175], 0
    v_lshlrev_b32 v0, 4, v3
    v_lshlrev_b32 v5, 3, v3
    v_mfma_f32_16x16x32_bf16 v[128:131], v[184:187], v[172:175], 0
    v_lshrrev_b32 v3, 5, v1
    v_lshl_add_u32 v0, v3, 8, v0
    v_mfma_f32_16x16x32_bf16 v[136:139], v[192:195], v[172:175], 0
    v_bfe_u32 v3, v1, 4, 1
    v_lshl_add_u32 v0, v3, 10, v0
    s_waitcnt lgkmcnt(14)
    v_mfma_f32_16x16x32_bf16 v[152:155], v[192:195], v[176:179], 0
    s_lshr_b32 s6, s74, 4
    s_mul_i32 s4, s83, 6
    v_mfma_f32_16x16x32_bf16 v[144:147], v[184:187], v[176:179], 0
    s_add_u32 s6, s6, s4
    s_lshr_b32 s7, s75, 4
    v_mfma_f32_16x16x32_bf16 v[148:151], v[188:191], v[176:179], 0
    s_mul_i32 s4, s84, 2
    s_add_u32 s7, s7, s4
    v_mfma_f32_16x16x32_bf16 v[140:143], v[180:183], v[176:179], 0
    s_lshl_b32 s4, s6, 7
    s_add_u32 s12, s4, 196608
    s_waitcnt lgkmcnt(0)
    s_barrier
    v_mfma_f32_16x16x32_bf16 v[60:63], v[220:223], v[196:199], v[60:63]
    ds_read_b128 v[156:159], v50 offset:0
    v_mfma_f32_16x16x32_bf16 v[68:71], v[228:231], v[196:199], v[68:71]
    ds_read_b64_tr_b16 v[180:181], v56 offset:0
    v_mfma_f32_16x16x32_bf16 v[64:67], v[224:227], v[196:199], v[64:67]
    ds_read_b64_tr_b16 v[182:183], v56 offset:512
    v_mfma_f32_16x16x32_bf16 v[72:75], v[232:235], v[196:199], v[72:75]
    ds_read_b64_tr_b16 v[188:189], v56 offset:8192
    v_mfma_f32_16x16x32_bf16 v[88:91], v[232:235], v[200:203], v[88:91]
    ds_read_b64_tr_b16 v[190:191], v56 offset:8704
    v_mfma_f32_16x16x32_bf16 v[80:83], v[224:227], v[200:203], v[80:83]
    ds_read_b64_tr_b16 v[184:185], v57 offset:0
    v_mfma_f32_16x16x32_bf16 v[84:87], v[228:231], v[200:203], v[84:87]
    ds_read_b64_tr_b16 v[186:187], v57 offset:512
    v_mfma_f32_16x16x32_bf16 v[76:79], v[220:223], v[200:203], v[76:79]
    ds_read_b64_tr_b16 v[192:193], v57 offset:8192
    v_mfma_f32_16x16x32_bf16 v[92:95], v[220:223], v[204:207], v[92:95]
    ds_read_b64_tr_b16 v[194:195], v57 offset:8704
    v_mfma_f32_16x16x32_bf16 v[100:103], v[228:231], v[204:207], v[100:103]
    ds_read_b128 v[160:163], v50 offset:2048
    v_mfma_f32_16x16x32_bf16 v[96:99], v[224:227], v[204:207], v[96:99]
    ds_read_b128 v[164:167], v50 offset:4096
    v_mfma_f32_16x16x32_bf16 v[104:107], v[232:235], v[204:207], v[104:107]
    ds_read_b128 v[168:171], v50 offset:6144
    v_mfma_f32_16x16x32_bf16 v[120:123], v[232:235], v[208:211], v[120:123]
    ds_read_b128 v[172:175], v50 offset:8192
    v_mfma_f32_16x16x32_bf16 v[112:115], v[224:227], v[208:211], v[112:115]
    ds_read_b128 v[176:179], v50 offset:10240
    v_mfma_f32_16x16x32_bf16 v[116:119], v[228:231], v[208:211], v[116:119]
    s_add_u32 s4, s7, 0
    s_lshr_b32 s5, s4, 1
    v_mfma_f32_16x16x32_bf16 v[108:111], v[220:223], v[208:211], v[108:111]
    s_lshl_b32 s5, s5, 12
    s_and_b32 s4, s4, 1
    v_mfma_f32_16x16x32_bf16 v[124:127], v[220:223], v[212:215], v[124:127]
    s_lshl_b32 s4, s4, 9
    s_add_u32 s8, s4, s5
    v_mfma_f32_16x16x32_bf16 v[132:135], v[228:231], v[212:215], v[132:135]
    s_add_u32 s4, s7, 1
    s_lshr_b32 s5, s4, 1
    v_mfma_f32_16x16x32_bf16 v[128:131], v[224:227], v[212:215], v[128:131]
    s_lshl_b32 s5, s5, 12
    s_and_b32 s4, s4, 1
    v_mfma_f32_16x16x32_bf16 v[136:139], v[232:235], v[212:215], v[136:139]
    s_lshl_b32 s4, s4, 9
    s_add_u32 s9, s4, s5
    v_mfma_f32_16x16x32_bf16 v[152:155], v[232:235], v[216:219], v[152:155]
    buffer_store_dwordx4 v[12:15], v6, s[64:67], s96 offen sc1
    v_mfma_f32_16x16x32_bf16 v[144:147], v[224:227], v[216:219], v[144:147]
    s_add_u32 s4, s6, 0
    s_lshr_b32 s5, s4, 2
    v_mfma_f32_16x16x32_bf16 v[148:151], v[228:231], v[216:219], v[148:151]
    s_mul_i32 s5, s5, 196608
    s_and_b32 s4, s4, 3
    v_mfma_f32_16x16x32_bf16 v[140:143], v[220:223], v[216:219], v[140:143]
    s_lshl_b32 s4, s4, 10
    s_add_u32 s4, s4, s5
    s_waitcnt lgkmcnt(11)
    v_mfma_f32_16x16x32_bf16 v[60:63], v[180:183], v[156:159], v[60:63]
    ds_read_b128 v[196:199], v51 offset:0
    s_waitcnt lgkmcnt(10)
    v_mfma_f32_16x16x32_bf16 v[68:71], v[188:191], v[156:159], v[68:71]
    ds_read_b64_tr_b16 v[220:221], v56 offset:4096
    s_waitcnt lgkmcnt(9)
    v_mfma_f32_16x16x32_bf16 v[64:67], v[184:187], v[156:159], v[64:67]
    ds_read_b64_tr_b16 v[222:223], v56 offset:4608
    s_waitcnt lgkmcnt(8)
    v_mfma_f32_16x16x32_bf16 v[72:75], v[192:195], v[156:159], v[72:75]
    ds_read_b64_tr_b16 v[228:229], v56 offset:12288
    s_waitcnt lgkmcnt(8)
    v_mfma_f32_16x16x32_bf16 v[88:91], v[192:195], v[160:163], v[88:91]
    ds_read_b64_tr_b16 v[230:231], v56 offset:12800
    v_mfma_f32_16x16x32_bf16 v[80:83], v[184:187], v[160:163], v[80:83]
    ds_read_b64_tr_b16 v[224:225], v57 offset:4096
    v_mfma_f32_16x16x32_bf16 v[84:87], v[188:191], v[160:163], v[84:87]
    ds_read_b64_tr_b16 v[226:227], v57 offset:4608
    v_mfma_f32_16x16x32_bf16 v[76:79], v[180:183], v[160:163], v[76:79]
    ds_read_b64_tr_b16 v[232:233], v57 offset:12288
    s_waitcnt lgkmcnt(11)
    v_mfma_f32_16x16x32_bf16 v[92:95], v[180:183], v[164:167], v[92:95]
    ds_read_b64_tr_b16 v[234:235], v57 offset:12800
    v_mfma_f32_16x16x32_bf16 v[100:103], v[188:191], v[164:167], v[100:103]
    ds_read_b128 v[200:203], v51 offset:2048
    v_mfma_f32_16x16x32_bf16 v[96:99], v[184:187], v[164:167], v[96:99]
    ds_read_b128 v[204:207], v51 offset:4096
    v_mfma_f32_16x16x32_bf16 v[104:107], v[192:195], v[164:167], v[104:107]
    ds_read_b128 v[208:211], v51 offset:6144
    s_waitcnt lgkmcnt(14)
    v_mfma_f32_16x16x32_bf16 v[120:123], v[192:195], v[168:171], v[120:123]
    ds_read_b128 v[212:215], v51 offset:8192
    v_mfma_f32_16x16x32_bf16 v[112:115], v[184:187], v[168:171], v[112:115]
    ds_read_b128 v[216:219], v51 offset:10240
    v_mfma_f32_16x16x32_bf16 v[116:119], v[188:191], v[168:171], v[116:119]
    s_add_u32 s4, s4, 12582912
    s_add_u32 s52, s4, s8
    v_mfma_f32_16x16x32_bf16 v[108:111], v[180:183], v[168:171], v[108:111]
    s_add_u32 s53, s4, s9
    s_add_u32 s4, s6, 2
    s_waitcnt lgkmcnt(15)
    v_mfma_f32_16x16x32_bf16 v[124:127], v[180:183], v[172:175], v[124:127]
    s_lshr_b32 s5, s4, 2
    s_mul_i32 s5, s5, 196608
    v_mfma_f32_16x16x32_bf16 v[132:135], v[188:191], v[172:175], v[132:135]
    s_and_b32 s4, s4, 3
    s_lshl_b32 s4, s4, 10
    v_mfma_f32_16x16x32_bf16 v[128:131], v[184:187], v[172:175], v[128:131]
    s_add_u32 s4, s4, s5
    s_add_u32 s4, s4, 12582912
    v_mfma_f32_16x16x32_bf16 v[136:139], v[192:195], v[172:175], v[136:139]
    s_add_u32 s54, s4, s8
    s_add_u32 s55, s4, s9
    s_waitcnt lgkmcnt(14)
    v_mfma_f32_16x16x32_bf16 v[152:155], v[192:195], v[176:179], v[152:155]
    s_add_u32 s4, s6, 4
    s_lshr_b32 s5, s4, 2
    v_mfma_f32_16x16x32_bf16 v[144:147], v[184:187], v[176:179], v[144:147]
    s_mul_i32 s5, s5, 196608
    s_and_b32 s4, s4, 3
    v_mfma_f32_16x16x32_bf16 v[148:151], v[188:191], v[176:179], v[148:151]
    s_lshl_b32 s4, s4, 10
    s_add_u32 s4, s4, s5
    v_mfma_f32_16x16x32_bf16 v[140:143], v[180:183], v[176:179], v[140:143]
    s_add_u32 s4, s4, 12582912
    s_add_u32 s56, s4, s8
    s_waitcnt vmcnt(2)
    s_waitcnt lgkmcnt(0)
    s_barrier
    v_mfma_f32_16x16x32_bf16 v[60:63], v[220:223], v[196:199], v[60:63]
    ds_read_b128 v[156:159], v46 offset:0
    v_mfma_f32_16x16x32_bf16 v[68:71], v[228:231], v[196:199], v[68:71]
    ds_read_b64_tr_b16 v[180:181], v52 offset:0
    v_mfma_f32_16x16x32_bf16 v[64:67], v[224:227], v[196:199], v[64:67]
    ds_read_b64_tr_b16 v[182:183], v52 offset:512
    v_mfma_f32_16x16x32_bf16 v[72:75], v[232:235], v[196:199], v[72:75]
    ds_read_b64_tr_b16 v[188:189], v52 offset:8192
    v_mfma_f32_16x16x32_bf16 v[88:91], v[232:235], v[200:203], v[88:91]
    ds_read_b64_tr_b16 v[190:191], v52 offset:8704
    v_mfma_f32_16x16x32_bf16 v[80:83], v[224:227], v[200:203], v[80:83]
    ds_read_b64_tr_b16 v[184:185], v53 offset:0
    v_mfma_f32_16x16x32_bf16 v[84:87], v[228:231], v[200:203], v[84:87]
    ds_read_b64_tr_b16 v[186:187], v53 offset:512
    v_mfma_f32_16x16x32_bf16 v[76:79], v[220:223], v[200:203], v[76:79]
    ds_read_b64_tr_b16 v[192:193], v53 offset:8192
    v_mfma_f32_16x16x32_bf16 v[92:95], v[220:223], v[204:207], v[92:95]
    ds_read_b64_tr_b16 v[194:195], v53 offset:8704
    v_mfma_f32_16x16x32_bf16 v[100:103], v[228:231], v[204:207], v[100:103]
    ds_read_b128 v[160:163], v46 offset:2048
    v_mfma_f32_16x16x32_bf16 v[96:99], v[224:227], v[204:207], v[96:99]
    ds_read_b128 v[164:167], v46 offset:4096
    v_mfma_f32_16x16x32_bf16 v[104:107], v[232:235], v[204:207], v[104:107]
    ds_read_b128 v[168:171], v46 offset:6144
    v_mfma_f32_16x16x32_bf16 v[120:123], v[232:235], v[208:211], v[120:123]
    ds_read_b128 v[172:175], v46 offset:8192
    v_mfma_f32_16x16x32_bf16 v[112:115], v[224:227], v[208:211], v[112:115]
    ds_read_b128 v[176:179], v46 offset:10240
    v_mfma_f32_16x16x32_bf16 v[116:119], v[228:231], v[208:211], v[116:119]
    s_add_u32 s57, s4, s9
    s_and_b32 s4, s79, 1
    v_mfma_f32_16x16x32_bf16 v[108:111], v[220:223], v[208:211], v[108:111]
    s_lshl_b32 s4, s4, 2
    s_bitcmp1_b32 s79, 2
    s_cselect_b32 s4, 8, s4
    v_mfma_f32_16x16x32_bf16 v[124:127], v[220:223], v[212:215], v[124:127]
    s_cmp_ge_u32 s4, 12
    s_cselect_b32 s5, 12, 0
    s_sub_u32 s85, s4, s5
    v_mfma_f32_16x16x32_bf16 v[132:135], v[228:231], v[212:215], v[132:135]
    s_mul_i32 s4, s80, 48
    s_mul_i32 s5, s3, 12
    v_mfma_f32_16x16x32_bf16 v[128:131], v[224:227], v[212:215], v[128:131]
    s_add_u32 s4, s4, s5
    s_mul_i32 s4, s4, 5120
    v_mfma_f32_16x16x32_bf16 v[136:139], v[232:235], v[212:215], v[136:139]
    s_add_u32 s86, s4, 10485760
    s_mul_i32 s4, s79, 196608
    v_mfma_f32_16x16x32_bf16 v[152:155], v[232:235], v[216:219], v[152:155]
    buffer_store_dwordx4 v[16:19], v6, s[64:67], s97 offen sc1
    v_mfma_f32_16x16x32_bf16 v[144:147], v[224:227], v[216:219], v[144:147]
    s_lshl_b32 s5, s5, 12
    s_add_u32 s4, s4, s5
    v_mfma_f32_16x16x32_bf16 v[148:151], v[228:231], v[216:219], v[148:151]
    s_add_u32 s87, s4, 12582912
    s_lshl_b32 s4, s85, 12
    v_mfma_f32_16x16x32_bf16 v[140:143], v[220:223], v[216:219], v[140:143]
    s_add_u32 s16, s4, s87
    s_mul_i32 s4, s85, 5120
    s_waitcnt lgkmcnt(11)
    v_mfma_f32_16x16x32_bf16 v[60:63], v[180:183], v[156:159], v[60:63]
    ds_read_b128 v[196:199], v47 offset:0
    s_waitcnt lgkmcnt(10)
    v_mfma_f32_16x16x32_bf16 v[68:71], v[188:191], v[156:159], v[68:71]
    ds_read_b64_tr_b16 v[220:221], v52 offset:4096
    s_waitcnt lgkmcnt(9)
    v_mfma_f32_16x16x32_bf16 v[64:67], v[184:187], v[156:159], v[64:67]
    ds_read_b64_tr_b16 v[222:223], v52 offset:4608
    s_waitcnt lgkmcnt(8)
    v_mfma_f32_16x16x32_bf16 v[72:75], v[192:195], v[156:159], v[72:75]
    ds_read_b64_tr_b16 v[228:229], v52 offset:12288
    s_waitcnt lgkmcnt(8)
    v_mfma_f32_16x16x32_bf16 v[88:91], v[192:195], v[160:163], v[88:91]
    ds_read_b64_tr_b16 v[230:231], v52 offset:12800
    v_mfma_f32_16x16x32_bf16 v[80:83], v[184:187], v[160:163], v[80:83]
    ds_read_b64_tr_b16 v[224:225], v53 offset:4096
    v_mfma_f32_16x16x32_bf16 v[84:87], v[188:191], v[160:163], v[84:87]
    ds_read_b64_tr_b16 v[226:227], v53 offset:4608
    v_mfma_f32_16x16x32_bf16 v[76:79], v[180:183], v[160:163], v[76:79]
    ds_read_b64_tr_b16 v[232:233], v53 offset:12288
    s_waitcnt lgkmcnt(11)
    v_mfma_f32_16x16x32_bf16 v[92:95], v[180:183], v[164:167], v[92:95]
    ds_read_b64_tr_b16 v[234:235], v53 offset:12800
    v_mfma_f32_16x16x32_bf16 v[100:103], v[188:191], v[164:167], v[100:103]
    ds_read_b128 v[200:203], v47 offset:2048
    v_mfma_f32_16x16x32_bf16 v[96:99], v[184:187], v[164:167], v[96:99]
    ds_read_b128 v[204:207], v47 offset:4096
    v_mfma_f32_16x16x32_bf16 v[104:107], v[192:195], v[164:167], v[104:107]
    ds_read_b128 v[208:211], v47 offset:6144
    s_waitcnt lgkmcnt(14)
    v_mfma_f32_16x16x32_bf16 v[120:123], v[192:195], v[168:171], v[120:123]
    ds_read_b128 v[212:215], v47 offset:8192
    v_mfma_f32_16x16x32_bf16 v[112:115], v[184:187], v[168:171], v[112:115]
    ds_read_b128 v[216:219], v47 offset:10240
    v_mfma_f32_16x16x32_bf16 v[116:119], v[188:191], v[168:171], v[116:119]
    s_add_u32 s28, s4, s86
    s_add_u32 s85, s85, 1
    v_mfma_f32_16x16x32_bf16 v[108:111], v[180:183], v[168:171], v[108:111]
    s_cmp_eq_u32 s85, 12
    s_cselect_b32 s85, 0, s85
    s_lshl_b32 s4, s85, 12
    s_waitcnt lgkmcnt(15)
    v_mfma_f32_16x16x32_bf16 v[124:127], v[180:183], v[172:175], v[124:127]
    s_add_u32 s17, s4, s87
    s_mul_i32 s4, s85, 5120
    v_mfma_f32_16x16x32_bf16 v[132:135], v[188:191], v[172:175], v[132:135]
    s_add_u32 s29, s4, s86
    s_add_u32 s85, s85, 1
    v_mfma_f32_16x16x32_bf16 v[128:131], v[184:187], v[172:175], v[128:131]
    s_cmp_eq_u32 s85, 12
    s_cselect_b32 s85, 0, s85
    s_lshl_b32 s4, s85, 12
    v_mfma_f32_16x16x32_bf16 v[136:139], v[192:195], v[172:175], v[136:139]
    s_add_u32 s18, s4, s87
    s_mul_i32 s4, s85, 5120
    s_waitcnt lgkmcnt(14)
    v_mfma_f32_16x16x32_bf16 v[152:155], v[192:195], v[176:179], v[152:155]
    s_add_u32 s30, s4, s86
    s_add_u32 s85, s85, 1
    v_mfma_f32_16x16x32_bf16 v[144:147], v[184:187], v[176:179], v[144:147]
    s_cmp_eq_u32 s85, 12
    s_cselect_b32 s85, 0, s85
    s_lshl_b32 s4, s85, 12
    v_mfma_f32_16x16x32_bf16 v[148:151], v[188:191], v[176:179], v[148:151]
    s_add_u32 s19, s4, s87
    s_mul_i32 s4, s85, 5120
    v_mfma_f32_16x16x32_bf16 v[140:143], v[180:183], v[176:179], v[140:143]
    s_add_u32 s31, s4, s86
    s_add_u32 s85, s85, 1
    s_waitcnt lgkmcnt(0)
    s_barrier
    v_mfma_f32_16x16x32_bf16 v[60:63], v[220:223], v[196:199], v[60:63]
    ds_read_b128 v[156:159], v48 offset:0
    v_mfma_f32_16x16x32_bf16 v[68:71], v[228:231], v[196:199], v[68:71]
    ds_read_b64_tr_b16 v[180:181], v54 offset:0
    v_mfma_f32_16x16x32_bf16 v[64:67], v[224:227], v[196:199], v[64:67]
    ds_read_b64_tr_b16 v[182:183], v54 offset:512
    v_mfma_f32_16x16x32_bf16 v[72:75], v[232:235], v[196:199], v[72:75]
    ds_read_b64_tr_b16 v[188:189], v54 offset:8192
    v_mfma_f32_16x16x32_bf16 v[88:91], v[232:235], v[200:203], v[88:91]
    ds_read_b64_tr_b16 v[190:191], v54 offset:8704
    v_mfma_f32_16x16x32_bf16 v[80:83], v[224:227], v[200:203], v[80:83]
    ds_read_b64_tr_b16 v[184:185], v55 offset:0
    v_mfma_f32_16x16x32_bf16 v[84:87], v[228:231], v[200:203], v[84:87]
    ds_read_b64_tr_b16 v[186:187], v55 offset:512
    v_mfma_f32_16x16x32_bf16 v[76:79], v[220:223], v[200:203], v[76:79]
    ds_read_b64_tr_b16 v[192:193], v55 offset:8192
    v_mfma_f32_16x16x32_bf16 v[92:95], v[220:223], v[204:207], v[92:95]
    ds_read_b64_tr_b16 v[194:195], v55 offset:8704
    v_mfma_f32_16x16x32_bf16 v[100:103], v[228:231], v[204:207], v[100:103]
    ds_read_b128 v[160:163], v48 offset:2048
    v_mfma_f32_16x16x32_bf16 v[96:99], v[224:227], v[204:207], v[96:99]
    ds_read_b128 v[164:167], v48 offset:4096
    v_mfma_f32_16x16x32_bf16 v[104:107], v[232:235], v[204:207], v[104:107]
    ds_read_b128 v[168:171], v48 offset:6144
    v_mfma_f32_16x16x32_bf16 v[120:123], v[232:235], v[208:211], v[120:123]
    ds_read_b128 v[172:175], v48 offset:8192
    v_mfma_f32_16x16x32_bf16 v[112:115], v[224:227], v[208:211], v[112:115]
    ds_read_b128 v[176:179], v48 offset:10240
    v_mfma_f32_16x16x32_bf16 v[116:119], v[228:231], v[208:211], v[116:119]
    s_cmp_eq_u32 s85, 12
    s_cselect_b32 s85, 0, s85
    s_lshl_b32 s4, s85, 12
    v_mfma_f32_16x16x32_bf16 v[108:111], v[220:223], v[208:211], v[108:111]
    s_add_u32 s20, s4, s87
    s_mul_i32 s4, s85, 5120
    v_mfma_f32_16x16x32_bf16 v[124:127], v[220:223], v[212:215], v[124:127]
    s_add_u32 s32, s4, s86
    s_add_u32 s85, s85, 1
    v_mfma_f32_16x16x32_bf16 v[132:135], v[228:231], v[212:215], v[132:135]
    s_cmp_eq_u32 s85, 12
    s_cselect_b32 s85, 0, s85
    s_lshl_b32 s4, s85, 12
    v_mfma_f32_16x16x32_bf16 v[128:131], v[224:227], v[212:215], v[128:131]
    s_add_u32 s21, s4, s87
    s_mul_i32 s4, s85, 5120
    v_mfma_f32_16x16x32_bf16 v[136:139], v[232:235], v[212:215], v[136:139]
    s_add_u32 s33, s4, s86
    s_add_u32 s85, s85, 1
    v_mfma_f32_16x16x32_bf16 v[152:155], v[232:235], v[216:219], v[152:155]
    s_cmp_eq_u32 s85, 12
    s_cselect_b32 s85, 0, s85
    s_lshl_b32 s4, s85, 12
    v_mfma_f32_16x16x32_bf16 v[144:147], v[224:227], v[216:219], v[144:147]
    s_add_u32 s22, s4, s87
    s_mul_i32 s4, s85, 5120
    v_mfma_f32_16x16x32_bf16 v[148:151], v[228:231], v[216:219], v[148:151]
    s_add_u32 s34, s4, s86
    s_add_u32 s85, s85, 1
    v_mfma_f32_16x16x32_bf16 v[140:143], v[220:223], v[216:219], v[140:143]
    s_cmp_eq_u32 s85, 12
    s_cselect_b32 s85, 0, s85
    s_lshl_b32 s4, s85, 12
    s_waitcnt lgkmcnt(11)
    v_mfma_f32_16x16x32_bf16 v[60:63], v[180:183], v[156:159], v[60:63]
    ds_read_b128 v[196:199], v49 offset:0
    s_waitcnt lgkmcnt(10)
    v_mfma_f32_16x16x32_bf16 v[68:71], v[188:191], v[156:159], v[68:71]
    ds_read_b64_tr_b16 v[220:221], v54 offset:4096
    s_waitcnt lgkmcnt(9)
    v_mfma_f32_16x16x32_bf16 v[64:67], v[184:187], v[156:159], v[64:67]
    ds_read_b64_tr_b16 v[222:223], v54 offset:4608
    s_waitcnt lgkmcnt(8)
    v_mfma_f32_16x16x32_bf16 v[72:75], v[192:195], v[156:159], v[72:75]
    ds_read_b64_tr_b16 v[228:229], v54 offset:12288
    s_waitcnt lgkmcnt(8)
    v_mfma_f32_16x16x32_bf16 v[88:91], v[192:195], v[160:163], v[88:91]
    ds_read_b64_tr_b16 v[230:231], v54 offset:12800
    v_mfma_f32_16x16x32_bf16 v[80:83], v[184:187], v[160:163], v[80:83]
    ds_read_b64_tr_b16 v[224:225], v55 offset:4096
    v_mfma_f32_16x16x32_bf16 v[84:87], v[188:191], v[160:163], v[84:87]
    ds_read_b64_tr_b16 v[226:227], v55 offset:4608
    v_mfma_f32_16x16x32_bf16 v[76:79], v[180:183], v[160:163], v[76:79]
    ds_read_b64_tr_b16 v[232:233], v55 offset:12288
    s_waitcnt lgkmcnt(11)
    v_mfma_f32_16x16x32_bf16 v[92:95], v[180:183], v[164:167], v[92:95]
    ds_read_b64_tr_b16 v[234:235], v55 offset:12800
    v_mfma_f32_16x16x32_bf16 v[100:103], v[188:191], v[164:167], v[100:103]
    ds_read_b128 v[200:203], v49 offset:2048
    v_mfma_f32_16x16x32_bf16 v[96:99], v[184:187], v[164:167], v[96:99]
    ds_read_b128 v[204:207], v49 offset:4096
    v_mfma_f32_16x16x32_bf16 v[104:107], v[192:195], v[164:167], v[104:107]
    ds_read_b128 v[208:211], v49 offset:6144
    s_waitcnt lgkmcnt(14)
    v_mfma_f32_16x16x32_bf16 v[120:123], v[192:195], v[168:171], v[120:123]
    ds_read_b128 v[212:215], v49 offset:8192
    v_mfma_f32_16x16x32_bf16 v[112:115], v[184:187], v[168:171], v[112:115]
    ds_read_b128 v[216:219], v49 offset:10240
    v_mfma_f32_16x16x32_bf16 v[116:119], v[188:191], v[168:171], v[116:119]
    s_add_u32 s23, s4, s87
    s_mul_i32 s4, s85, 5120
    v_mfma_f32_16x16x32_bf16 v[108:111], v[180:183], v[168:171], v[108:111]
    s_add_u32 s35, s4, s86
    s_add_u32 s85, s85, 1
    s_waitcnt lgkmcnt(15)
    v_mfma_f32_16x16x32_bf16 v[124:127], v[180:183], v[172:175], v[124:127]
    s_cmp_eq_u32 s85, 12
    s_cselect_b32 s85, 0, s85
    s_lshl_b32 s4, s85, 12
    v_mfma_f32_16x16x32_bf16 v[132:135], v[188:191], v[172:175], v[132:135]
    s_add_u32 s24, s4, s87
    s_mul_i32 s4, s85, 5120
    v_mfma_f32_16x16x32_bf16 v[128:131], v[184:187], v[172:175], v[128:131]
    s_add_u32 s36, s4, s86
    s_add_u32 s85, s85, 1
    v_mfma_f32_16x16x32_bf16 v[136:139], v[192:195], v[172:175], v[136:139]
    s_cmp_eq_u32 s85, 12
    s_cselect_b32 s85, 0, s85
    s_lshl_b32 s4, s85, 12
    s_waitcnt lgkmcnt(14)
    v_mfma_f32_16x16x32_bf16 v[152:155], v[192:195], v[176:179], v[152:155]
    s_add_u32 s25, s4, s87
    s_mul_i32 s4, s85, 5120
    v_mfma_f32_16x16x32_bf16 v[144:147], v[184:187], v[176:179], v[144:147]
    s_add_u32 s37, s4, s86
    s_add_u32 s85, s85, 1
    v_mfma_f32_16x16x32_bf16 v[148:151], v[188:191], v[176:179], v[148:151]
    s_cmp_eq_u32 s85, 12
    s_cselect_b32 s85, 0, s85
    s_lshl_b32 s4, s85, 12
    v_mfma_f32_16x16x32_bf16 v[140:143], v[180:183], v[176:179], v[140:143]
    s_add_u32 s26, s4, s87
    s_mul_i32 s4, s85, 5120
    s_waitcnt vmcnt(0)
    s_waitcnt lgkmcnt(0)
    s_barrier
    v_mfma_f32_16x16x32_bf16 v[60:63], v[220:223], v[196:199], v[60:63]
    ds_read_b128 v[156:159], v50 offset:0
    v_mfma_f32_16x16x32_bf16 v[68:71], v[228:231], v[196:199], v[68:71]
    ds_read_b64_tr_b16 v[180:181], v56 offset:0
    v_mfma_f32_16x16x32_bf16 v[64:67], v[224:227], v[196:199], v[64:67]
    ds_read_b64_tr_b16 v[182:183], v56 offset:512
    v_mfma_f32_16x16x32_bf16 v[72:75], v[232:235], v[196:199], v[72:75]
    ds_read_b64_tr_b16 v[188:189], v56 offset:8192
    v_mfma_f32_16x16x32_bf16 v[88:91], v[232:235], v[200:203], v[88:91]
    ds_read_b64_tr_b16 v[190:191], v56 offset:8704
    v_mfma_f32_16x16x32_bf16 v[80:83], v[224:227], v[200:203], v[80:83]
    ds_read_b64_tr_b16 v[184:185], v57 offset:0
    v_mfma_f32_16x16x32_bf16 v[84:87], v[228:231], v[200:203], v[84:87]
    ds_read_b64_tr_b16 v[186:187], v57 offset:512
    v_mfma_f32_16x16x32_bf16 v[76:79], v[220:223], v[200:203], v[76:79]
    ds_read_b64_tr_b16 v[192:193], v57 offset:8192
    v_mfma_f32_16x16x32_bf16 v[92:95], v[220:223], v[204:207], v[92:95]
    ds_read_b64_tr_b16 v[194:195], v57 offset:8704
    v_mfma_f32_16x16x32_bf16 v[100:103], v[228:231], v[204:207], v[100:103]
    ds_read_b128 v[160:163], v50 offset:2048
    v_mfma_f32_16x16x32_bf16 v[96:99], v[224:227], v[204:207], v[96:99]
    ds_read_b128 v[164:167], v50 offset:4096
    v_mfma_f32_16x16x32_bf16 v[104:107], v[232:235], v[204:207], v[104:107]
    ds_read_b128 v[168:171], v50 offset:6144
    v_mfma_f32_16x16x32_bf16 v[120:123], v[232:235], v[208:211], v[120:123]
    ds_read_b128 v[172:175], v50 offset:8192
    v_mfma_f32_16x16x32_bf16 v[112:115], v[224:227], v[208:211], v[112:115]
    ds_read_b128 v[176:179], v50 offset:10240
    v_mfma_f32_16x16x32_bf16 v[116:119], v[228:231], v[208:211], v[116:119]
    s_add_u32 s38, s4, s86
    s_add_u32 s85, s85, 1
    v_mfma_f32_16x16x32_bf16 v[108:111], v[220:223], v[208:211], v[108:111]
    s_cmp_eq_u32 s85, 12
    s_cselect_b32 s85, 0, s85
    s_lshl_b32 s4, s85, 12
    v_mfma_f32_16x16x32_bf16 v[124:127], v[220:223], v[212:215], v[124:127]
    s_add_u32 s27, s4, s87
    s_mul_i32 s4, s85, 5120
    v_mfma_f32_16x16x32_bf16 v[132:135], v[228:231], v[212:215], v[132:135]
    s_add_u32 s39, s4, s86
    v_add_u32 v9, 4096, v6
    v_mfma_f32_16x16x32_bf16 v[128:131], v[224:227], v[212:215], v[128:131]
    s_lshl_b32 s5, s3, 2
    s_add_u32 s4, s5, 145024
    v_mfma_f32_16x16x32_bf16 v[136:139], v[232:235], v[212:215], v[136:139]
    v_mov_b32 v10, s4
    s_lshl_b32 s4, s81, 7
    v_mfma_f32_16x16x32_bf16 v[152:155], v[232:235], v[216:219], v[152:155]
    s_add_u32 s59, s4, 65536
    s_lshl_b32 s4, s79, 2
    v_mfma_f32_16x16x32_bf16 v[144:147], v[224:227], v[216:219], v[144:147]
    s_add_u32 s4, s4, s3
    s_mul_i32 s4, s4, 20480
    v_mfma_f32_16x16x32_bf16 v[148:151], v[228:231], v[216:219], v[148:151]
    s_mul_i32 s5, s80, 160
    s_add_u32 s88, s4, s5
    v_mfma_f32_16x16x32_bf16 v[140:143], v[220:223], v[216:219], v[140:143]
    s_mul_i32 s13, s3, 10240
    s_mul_i32 s4, s79, 43
    s_waitcnt lgkmcnt(11)
    v_mfma_f32_16x16x32_bf16 v[60:63], v[180:183], v[156:159], v[60:63]
    ds_read_b128 v[196:199], v51 offset:0
    s_waitcnt lgkmcnt(10)
    v_mfma_f32_16x16x32_bf16 v[68:71], v[188:191], v[156:159], v[68:71]
    ds_read_b64_tr_b16 v[220:221], v56 offset:4096
    s_waitcnt lgkmcnt(9)
    v_mfma_f32_16x16x32_bf16 v[64:67], v[184:187], v[156:159], v[64:67]
    ds_read_b64_tr_b16 v[222:223], v56 offset:4608
    s_waitcnt lgkmcnt(8)
    v_mfma_f32_16x16x32_bf16 v[72:75], v[192:195], v[156:159], v[72:75]
    ds_read_b64_tr_b16 v[228:229], v56 offset:12288
    s_waitcnt lgkmcnt(8)
    v_mfma_f32_16x16x32_bf16 v[88:91], v[192:195], v[160:163], v[88:91]
    ds_read_b64_tr_b16 v[230:231], v56 offset:12800
    v_mfma_f32_16x16x32_bf16 v[80:83], v[184:187], v[160:163], v[80:83]
    ds_read_b64_tr_b16 v[224:225], v57 offset:4096
    v_mfma_f32_16x16x32_bf16 v[84:87], v[188:191], v[160:163], v[84:87]
    ds_read_b64_tr_b16 v[226:227], v57 offset:4608
    v_mfma_f32_16x16x32_bf16 v[76:79], v[180:183], v[160:163], v[76:79]
    ds_read_b64_tr_b16 v[232:233], v57 offset:12288
    s_waitcnt lgkmcnt(11)
    v_mfma_f32_16x16x32_bf16 v[92:95], v[180:183], v[164:167], v[92:95]
    ds_read_b64_tr_b16 v[234:235], v57 offset:12800
    v_mfma_f32_16x16x32_bf16 v[100:103], v[188:191], v[164:167], v[100:103]
    ds_read_b128 v[200:203], v51 offset:2048
    v_mfma_f32_16x16x32_bf16 v[96:99], v[184:187], v[164:167], v[96:99]
    ds_read_b128 v[204:207], v51 offset:4096
    v_mfma_f32_16x16x32_bf16 v[104:107], v[192:195], v[164:167], v[104:107]
    ds_read_b128 v[208:211], v51 offset:6144
    s_waitcnt lgkmcnt(14)
    v_mfma_f32_16x16x32_bf16 v[120:123], v[192:195], v[168:171], v[120:123]
    ds_read_b128 v[212:215], v51 offset:8192
    v_mfma_f32_16x16x32_bf16 v[112:115], v[184:187], v[168:171], v[112:115]
    ds_read_b128 v[216:219], v51 offset:10240
    v_mfma_f32_16x16x32_bf16 v[116:119], v[188:191], v[168:171], v[116:119]
    s_lshr_b32 s4, s4, 7
    s_mul_i32 s5, s4, 3
    v_mfma_f32_16x16x32_bf16 v[108:111], v[180:183], v[168:171], v[108:111]
    s_sub_u32 s5, s79, s5
    s_lshl_b32 s6, s5, 1
    s_waitcnt lgkmcnt(15)
    v_mfma_f32_16x16x32_bf16 v[124:127], v[180:183], v[172:175], v[124:127]
    s_cmp_ge_u32 s79, 30
    s_cselect_b32 s5, s6, s5
    s_cselect_b32 s7, 3, 5
    s_mul_i32 s4, s4, 24
    v_mfma_f32_16x16x32_bf16 v[132:135], v[188:191], v[172:175], v[132:135]
    s_mul_i32 s6, s3, 6
    s_add_u32 s4, s4, s6
    v_mfma_f32_16x16x32_bf16 v[128:131], v[184:187], v[172:175], v[128:131]
    s_lshl_b32 s4, s4, 7
    s_add_u32 s14, s4, 65536
    v_mfma_f32_16x16x32_bf16 v[136:139], v[192:195], v[172:175], v[136:139]
    v_and_b32 v3, 7, v1
    v_min_u32 v3, s7, v3
    s_waitcnt lgkmcnt(14)
    v_mfma_f32_16x16x32_bf16 v[152:155], v[192:195], v[176:179], v[152:155]
    v_lshlrev_b32 v11, 7, v3
    v_mfma_f32_16x16x32_bf16 v[144:147], v[184:187], v[176:179], v[144:147]
    v_mfma_f32_16x16x32_bf16 v[148:151], v[188:191], v[176:179], v[148:151]
    v_mfma_f32_16x16x32_bf16 v[140:143], v[180:183], v[176:179], v[140:143]
    s_waitcnt lgkmcnt(0)
    s_barrier
    v_mfma_f32_16x16x32_bf16 v[60:63], v[220:223], v[196:199], v[60:63]
    ds_read_b128 v[156:159], v46 offset:0
    v_mfma_f32_16x16x32_bf16 v[68:71], v[228:231], v[196:199], v[68:71]
    ds_read_b64_tr_b16 v[180:181], v52 offset:0
    v_mfma_f32_16x16x32_bf16 v[64:67], v[224:227], v[196:199], v[64:67]
    ds_read_b64_tr_b16 v[182:183], v52 offset:512
    v_mfma_f32_16x16x32_bf16 v[72:75], v[232:235], v[196:199], v[72:75]
    ds_read_b64_tr_b16 v[188:189], v52 offset:8192
    v_mfma_f32_16x16x32_bf16 v[88:91], v[232:235], v[200:203], v[88:91]
    ds_read_b64_tr_b16 v[190:191], v52 offset:8704
    v_mfma_f32_16x16x32_bf16 v[80:83], v[224:227], v[200:203], v[80:83]
    ds_read_b64_tr_b16 v[184:185], v53 offset:0
    v_mfma_f32_16x16x32_bf16 v[84:87], v[228:231], v[200:203], v[84:87]
    ds_read_b64_tr_b16 v[186:187], v53 offset:512
    v_mfma_f32_16x16x32_bf16 v[76:79], v[220:223], v[200:203], v[76:79]
    ds_read_b64_tr_b16 v[192:193], v53 offset:8192
    v_mfma_f32_16x16x32_bf16 v[92:95], v[220:223], v[204:207], v[92:95]
    ds_read_b64_tr_b16 v[194:195], v53 offset:8704
    v_mfma_f32_16x16x32_bf16 v[100:103], v[228:231], v[204:207], v[100:103]
    ds_read_b128 v[160:163], v46 offset:2048
    v_mfma_f32_16x16x32_bf16 v[96:99], v[224:227], v[204:207], v[96:99]
    ds_read_b128 v[164:167], v46 offset:4096
    v_mfma_f32_16x16x32_bf16 v[104:107], v[232:235], v[204:207], v[104:107]
    ds_read_b128 v[168:171], v46 offset:6144
    v_mfma_f32_16x16x32_bf16 v[120:123], v[232:235], v[208:211], v[120:123]
    ds_read_b128 v[172:175], v46 offset:8192
    v_mfma_f32_16x16x32_bf16 v[112:115], v[224:227], v[208:211], v[112:115]
    ds_read_b128 v[176:179], v46 offset:10240
    v_mfma_f32_16x16x32_bf16 v[116:119], v[228:231], v[208:211], v[116:119]
    v_mfma_f32_16x16x32_bf16 v[108:111], v[220:223], v[208:211], v[108:111]
    v_mfma_f32_16x16x32_bf16 v[124:127], v[220:223], v[212:215], v[124:127]
    v_mfma_f32_16x16x32_bf16 v[132:135], v[228:231], v[212:215], v[132:135]
    v_mfma_f32_16x16x32_bf16 v[128:131], v[224:227], v[212:215], v[128:131]
    v_mfma_f32_16x16x32_bf16 v[136:139], v[232:235], v[212:215], v[136:139]
    v_mfma_f32_16x16x32_bf16 v[152:155], v[232:235], v[216:219], v[152:155]
    v_mfma_f32_16x16x32_bf16 v[144:147], v[224:227], v[216:219], v[144:147]
    v_mfma_f32_16x16x32_bf16 v[148:151], v[228:231], v[216:219], v[148:151]
    v_mfma_f32_16x16x32_bf16 v[140:143], v[220:223], v[216:219], v[140:143]
    s_waitcnt lgkmcnt(11)
    v_mfma_f32_16x16x32_bf16 v[60:63], v[180:183], v[156:159], v[60:63]
    ds_read_b128 v[196:199], v47 offset:0
    s_waitcnt lgkmcnt(10)
    v_mfma_f32_16x16x32_bf16 v[68:71], v[188:191], v[156:159], v[68:71]
    ds_read_b64_tr_b16 v[220:221], v52 offset:4096
    s_waitcnt lgkmcnt(9)
    v_mfma_f32_16x16x32_bf16 v[64:67], v[184:187], v[156:159], v[64:67]
    ds_read_b64_tr_b16 v[222:223], v52 offset:4608
    s_waitcnt lgkmcnt(8)
    v_mfma_f32_16x16x32_bf16 v[72:75], v[192:195], v[156:159], v[72:75]
    ds_read_b64_tr_b16 v[228:229], v52 offset:12288
    s_waitcnt lgkmcnt(8)
    v_mfma_f32_16x16x32_bf16 v[88:91], v[192:195], v[160:163], v[88:91]
    ds_read_b64_tr_b16 v[230:231], v52 offset:12800
    v_mfma_f32_16x16x32_bf16 v[80:83], v[184:187], v[160:163], v[80:83]
    ds_read_b64_tr_b16 v[224:225], v53 offset:4096
    v_mfma_f32_16x16x32_bf16 v[84:87], v[188:191], v[160:163], v[84:87]
    ds_read_b64_tr_b16 v[226:227], v53 offset:4608
    v_mfma_f32_16x16x32_bf16 v[76:79], v[180:183], v[160:163], v[76:79]
    ds_read_b64_tr_b16 v[232:233], v53 offset:12288
    s_waitcnt lgkmcnt(11)
    v_mfma_f32_16x16x32_bf16 v[92:95], v[180:183], v[164:167], v[92:95]
    ds_read_b64_tr_b16 v[234:235], v53 offset:12800
    v_mfma_f32_16x16x32_bf16 v[100:103], v[188:191], v[164:167], v[100:103]
    ds_read_b128 v[200:203], v47 offset:2048
    v_mfma_f32_16x16x32_bf16 v[96:99], v[184:187], v[164:167], v[96:99]
    ds_read_b128 v[204:207], v47 offset:4096
    v_mfma_f32_16x16x32_bf16 v[104:107], v[192:195], v[164:167], v[104:107]
    ds_read_b128 v[208:211], v47 offset:6144
    s_waitcnt lgkmcnt(14)
    v_mfma_f32_16x16x32_bf16 v[120:123], v[192:195], v[168:171], v[120:123]
    ds_read_b128 v[212:215], v47 offset:8192
    v_mfma_f32_16x16x32_bf16 v[112:115], v[184:187], v[168:171], v[112:115]
    ds_read_b128 v[216:219], v47 offset:10240
    v_mfma_f32_16x16x32_bf16 v[116:119], v[188:191], v[168:171], v[116:119]
    v_mfma_f32_16x16x32_bf16 v[108:111], v[180:183], v[168:171], v[108:111]
    s_waitcnt lgkmcnt(15)
    v_mfma_f32_16x16x32_bf16 v[124:127], v[180:183], v[172:175], v[124:127]
    v_mfma_f32_16x16x32_bf16 v[132:135], v[188:191], v[172:175], v[132:135]
    v_mfma_f32_16x16x32_bf16 v[128:131], v[184:187], v[172:175], v[128:131]
    v_mfma_f32_16x16x32_bf16 v[136:139], v[192:195], v[172:175], v[136:139]
    s_waitcnt lgkmcnt(14)
    v_mfma_f32_16x16x32_bf16 v[152:155], v[192:195], v[176:179], v[152:155]
    v_mfma_f32_16x16x32_bf16 v[144:147], v[184:187], v[176:179], v[144:147]
    v_mfma_f32_16x16x32_bf16 v[148:151], v[188:191], v[176:179], v[148:151]
    v_mfma_f32_16x16x32_bf16 v[140:143], v[180:183], v[176:179], v[140:143]
    s_waitcnt lgkmcnt(0)
    s_barrier
    v_mfma_f32_16x16x32_bf16 v[60:63], v[220:223], v[196:199], v[60:63]
    ds_read_b128 v[156:159], v48 offset:0
    v_mfma_f32_16x16x32_bf16 v[68:71], v[228:231], v[196:199], v[68:71]
    ds_read_b64_tr_b16 v[180:181], v54 offset:0
    v_mfma_f32_16x16x32_bf16 v[64:67], v[224:227], v[196:199], v[64:67]
    ds_read_b64_tr_b16 v[182:183], v54 offset:512
    v_mfma_f32_16x16x32_bf16 v[72:75], v[232:235], v[196:199], v[72:75]
    ds_read_b64_tr_b16 v[188:189], v54 offset:8192
    v_mfma_f32_16x16x32_bf16 v[88:91], v[232:235], v[200:203], v[88:91]
    ds_read_b64_tr_b16 v[190:191], v54 offset:8704
    v_mfma_f32_16x16x32_bf16 v[80:83], v[224:227], v[200:203], v[80:83]
    ds_read_b64_tr_b16 v[184:185], v55 offset:0
    v_mfma_f32_16x16x32_bf16 v[84:87], v[228:231], v[200:203], v[84:87]
    ds_read_b64_tr_b16 v[186:187], v55 offset:512
    v_mfma_f32_16x16x32_bf16 v[76:79], v[220:223], v[200:203], v[76:79]
    ds_read_b64_tr_b16 v[192:193], v55 offset:8192
    v_mfma_f32_16x16x32_bf16 v[92:95], v[220:223], v[204:207], v[92:95]
    ds_read_b64_tr_b16 v[194:195], v55 offset:8704
    v_mfma_f32_16x16x32_bf16 v[100:103], v[228:231], v[204:207], v[100:103]
    ds_read_b128 v[160:163], v48 offset:2048
    v_mfma_f32_16x16x32_bf16 v[96:99], v[224:227], v[204:207], v[96:99]
    ds_read_b128 v[164:167], v48 offset:4096
    v_mfma_f32_16x16x32_bf16 v[104:107], v[232:235], v[204:207], v[104:107]
    ds_read_b128 v[168:171], v48 offset:6144
    v_mfma_f32_16x16x32_bf16 v[120:123], v[232:235], v[208:211], v[120:123]
    ds_read_b128 v[172:175], v48 offset:8192
    v_mfma_f32_16x16x32_bf16 v[112:115], v[224:227], v[208:211], v[112:115]
    ds_read_b128 v[176:179], v48 offset:10240
    v_mfma_f32_16x16x32_bf16 v[116:119], v[228:231], v[208:211], v[116:119]
    v_mfma_f32_16x16x32_bf16 v[108:111], v[220:223], v[208:211], v[108:111]
    v_mfma_f32_16x16x32_bf16 v[124:127], v[220:223], v[212:215], v[124:127]
    v_mfma_f32_16x16x32_bf16 v[132:135], v[228:231], v[212:215], v[132:135]
    v_mfma_f32_16x16x32_bf16 v[128:131], v[224:227], v[212:215], v[128:131]
    v_mfma_f32_16x16x32_bf16 v[136:139], v[232:235], v[212:215], v[136:139]
    v_mfma_f32_16x16x32_bf16 v[152:155], v[232:235], v[216:219], v[152:155]
    v_mfma_f32_16x16x32_bf16 v[144:147], v[224:227], v[216:219], v[144:147]
    v_mfma_f32_16x16x32_bf16 v[148:151], v[228:231], v[216:219], v[148:151]
    v_mfma_f32_16x16x32_bf16 v[140:143], v[220:223], v[216:219], v[140:143]
    s_waitcnt lgkmcnt(11)
    v_mfma_f32_16x16x32_bf16 v[60:63], v[180:183], v[156:159], v[60:63]
    ds_read_b128 v[196:199], v49 offset:0
    s_waitcnt lgkmcnt(10)
    v_mfma_f32_16x16x32_bf16 v[68:71], v[188:191], v[156:159], v[68:71]
    ds_read_b64_tr_b16 v[220:221], v54 offset:4096
    s_waitcnt lgkmcnt(9)
    v_mfma_f32_16x16x32_bf16 v[64:67], v[184:187], v[156:159], v[64:67]
    ds_read_b64_tr_b16 v[222:223], v54 offset:4608
    s_waitcnt lgkmcnt(8)
    v_mfma_f32_16x16x32_bf16 v[72:75], v[192:195], v[156:159], v[72:75]
    ds_read_b64_tr_b16 v[228:229], v54 offset:12288
    s_waitcnt lgkmcnt(8)
    v_mfma_f32_16x16x32_bf16 v[88:91], v[192:195], v[160:163], v[88:91]
    ds_read_b64_tr_b16 v[230:231], v54 offset:12800
    v_mfma_f32_16x16x32_bf16 v[80:83], v[184:187], v[160:163], v[80:83]
    ds_read_b64_tr_b16 v[224:225], v55 offset:4096
    v_mfma_f32_16x16x32_bf16 v[84:87], v[188:191], v[160:163], v[84:87]
    ds_read_b64_tr_b16 v[226:227], v55 offset:4608
    v_mfma_f32_16x16x32_bf16 v[76:79], v[180:183], v[160:163], v[76:79]
    ds_read_b64_tr_b16 v[232:233], v55 offset:12288
    s_waitcnt lgkmcnt(11)
    v_mfma_f32_16x16x32_bf16 v[92:95], v[180:183], v[164:167], v[92:95]
    ds_read_b64_tr_b16 v[234:235], v55 offset:12800
    v_mfma_f32_16x16x32_bf16 v[100:103], v[188:191], v[164:167], v[100:103]
    ds_read_b128 v[200:203], v49 offset:2048
    v_mfma_f32_16x16x32_bf16 v[96:99], v[184:187], v[164:167], v[96:99]
    ds_read_b128 v[204:207], v49 offset:4096
    v_mfma_f32_16x16x32_bf16 v[104:107], v[192:195], v[164:167], v[104:107]
    ds_read_b128 v[208:211], v49 offset:6144
    s_waitcnt lgkmcnt(14)
    v_mfma_f32_16x16x32_bf16 v[120:123], v[192:195], v[168:171], v[120:123]
    ds_read_b128 v[212:215], v49 offset:8192
    v_mfma_f32_16x16x32_bf16 v[112:115], v[184:187], v[168:171], v[112:115]
    ds_read_b128 v[216:219], v49 offset:10240
    v_mfma_f32_16x16x32_bf16 v[116:119], v[188:191], v[168:171], v[116:119]
    v_mfma_f32_16x16x32_bf16 v[108:111], v[180:183], v[168:171], v[108:111]
    s_waitcnt lgkmcnt(15)
    v_mfma_f32_16x16x32_bf16 v[124:127], v[180:183], v[172:175], v[124:127]
    v_mfma_f32_16x16x32_bf16 v[132:135], v[188:191], v[172:175], v[132:135]
    v_mfma_f32_16x16x32_bf16 v[128:131], v[184:187], v[172:175], v[128:131]
    v_mfma_f32_16x16x32_bf16 v[136:139], v[192:195], v[172:175], v[136:139]
    s_waitcnt lgkmcnt(14)
    v_mfma_f32_16x16x32_bf16 v[152:155], v[192:195], v[176:179], v[152:155]
    v_mfma_f32_16x16x32_bf16 v[144:147], v[184:187], v[176:179], v[144:147]
    v_mfma_f32_16x16x32_bf16 v[148:151], v[188:191], v[176:179], v[148:151]
    v_mfma_f32_16x16x32_bf16 v[140:143], v[180:183], v[176:179], v[140:143]
    s_waitcnt lgkmcnt(0)
    s_barrier
    v_mfma_f32_16x16x32_bf16 v[60:63], v[220:223], v[196:199], v[60:63]
    ds_read_b128 v[156:159], v50 offset:0
    v_mfma_f32_16x16x32_bf16 v[68:71], v[228:231], v[196:199], v[68:71]
    ds_read_b64_tr_b16 v[180:181], v56 offset:0
    v_mfma_f32_16x16x32_bf16 v[64:67], v[224:227], v[196:199], v[64:67]
    ds_read_b64_tr_b16 v[182:183], v56 offset:512
    v_mfma_f32_16x16x32_bf16 v[72:75], v[232:235], v[196:199], v[72:75]
    ds_read_b64_tr_b16 v[188:189], v56 offset:8192
    v_mfma_f32_16x16x32_bf16 v[88:91], v[232:235], v[200:203], v[88:91]
    ds_read_b64_tr_b16 v[190:191], v56 offset:8704
    v_mfma_f32_16x16x32_bf16 v[80:83], v[224:227], v[200:203], v[80:83]
    ds_read_b64_tr_b16 v[184:185], v57 offset:0
    v_mfma_f32_16x16x32_bf16 v[84:87], v[228:231], v[200:203], v[84:87]
    ds_read_b64_tr_b16 v[186:187], v57 offset:512
    v_mfma_f32_16x16x32_bf16 v[76:79], v[220:223], v[200:203], v[76:79]
    ds_read_b64_tr_b16 v[192:193], v57 offset:8192
    v_mfma_f32_16x16x32_bf16 v[92:95], v[220:223], v[204:207], v[92:95]
    ds_read_b64_tr_b16 v[194:195], v57 offset:8704
    v_mfma_f32_16x16x32_bf16 v[100:103], v[228:231], v[204:207], v[100:103]
    ds_read_b128 v[160:163], v50 offset:2048
    v_mfma_f32_16x16x32_bf16 v[96:99], v[224:227], v[204:207], v[96:99]
    ds_read_b128 v[164:167], v50 offset:4096
    v_mfma_f32_16x16x32_bf16 v[104:107], v[232:235], v[204:207], v[104:107]
    ds_read_b128 v[168:171], v50 offset:6144
    v_mfma_f32_16x16x32_bf16 v[120:123], v[232:235], v[208:211], v[120:123]
    ds_read_b128 v[172:175], v50 offset:8192
    v_mfma_f32_16x16x32_bf16 v[112:115], v[224:227], v[208:211], v[112:115]
    ds_read_b128 v[176:179], v50 offset:10240
    v_mfma_f32_16x16x32_bf16 v[116:119], v[228:231], v[208:211], v[116:119]
    v_mfma_f32_16x16x32_bf16 v[108:111], v[220:223], v[208:211], v[108:111]
    v_mfma_f32_16x16x32_bf16 v[124:127], v[220:223], v[212:215], v[124:127]
    v_mfma_f32_16x16x32_bf16 v[132:135], v[228:231], v[212:215], v[132:135]
    v_mfma_f32_16x16x32_bf16 v[128:131], v[224:227], v[212:215], v[128:131]
    v_mfma_f32_16x16x32_bf16 v[136:139], v[232:235], v[212:215], v[136:139]
    v_mfma_f32_16x16x32_bf16 v[152:155], v[232:235], v[216:219], v[152:155]
    v_mfma_f32_16x16x32_bf16 v[144:147], v[224:227], v[216:219], v[144:147]
    v_mfma_f32_16x16x32_bf16 v[148:151], v[228:231], v[216:219], v[148:151]
    v_mfma_f32_16x16x32_bf16 v[140:143], v[220:223], v[216:219], v[140:143]
    s_waitcnt lgkmcnt(11)
    v_mfma_f32_16x16x32_bf16 v[60:63], v[180:183], v[156:159], v[60:63]
    ds_read_b128 v[196:199], v51 offset:0
    s_waitcnt lgkmcnt(10)
    v_mfma_f32_16x16x32_bf16 v[68:71], v[188:191], v[156:159], v[68:71]
    ds_read_b64_tr_b16 v[220:221], v56 offset:4096
    s_waitcnt lgkmcnt(9)
    v_mfma_f32_16x16x32_bf16 v[64:67], v[184:187], v[156:159], v[64:67]
    ds_read_b64_tr_b16 v[222:223], v56 offset:4608
    s_waitcnt lgkmcnt(8)
    v_mfma_f32_16x16x32_bf16 v[72:75], v[192:195], v[156:159], v[72:75]
    ds_read_b64_tr_b16 v[228:229], v56 offset:12288
    s_waitcnt lgkmcnt(8)
    v_mfma_f32_16x16x32_bf16 v[88:91], v[192:195], v[160:163], v[88:91]
    ds_read_b64_tr_b16 v[230:231], v56 offset:12800
    v_mfma_f32_16x16x32_bf16 v[80:83], v[184:187], v[160:163], v[80:83]
    ds_read_b64_tr_b16 v[224:225], v57 offset:4096
    v_mfma_f32_16x16x32_bf16 v[84:87], v[188:191], v[160:163], v[84:87]
    ds_read_b64_tr_b16 v[226:227], v57 offset:4608
    v_mfma_f32_16x16x32_bf16 v[76:79], v[180:183], v[160:163], v[76:79]
    ds_read_b64_tr_b16 v[232:233], v57 offset:12288
    s_waitcnt lgkmcnt(11)
    v_mfma_f32_16x16x32_bf16 v[92:95], v[180:183], v[164:167], v[92:95]
    ds_read_b64_tr_b16 v[234:235], v57 offset:12800
    v_mfma_f32_16x16x32_bf16 v[100:103], v[188:191], v[164:167], v[100:103]
    ds_read_b128 v[200:203], v51 offset:2048
    v_mfma_f32_16x16x32_bf16 v[96:99], v[184:187], v[164:167], v[96:99]
    ds_read_b128 v[204:207], v51 offset:4096
    v_mfma_f32_16x16x32_bf16 v[104:107], v[192:195], v[164:167], v[104:107]
    ds_read_b128 v[208:211], v51 offset:6144
    s_waitcnt lgkmcnt(14)
    v_mfma_f32_16x16x32_bf16 v[120:123], v[192:195], v[168:171], v[120:123]
    ds_read_b128 v[212:215], v51 offset:8192
    v_mfma_f32_16x16x32_bf16 v[112:115], v[184:187], v[168:171], v[112:115]
    ds_read_b128 v[216:219], v51 offset:10240
    v_mfma_f32_16x16x32_bf16 v[116:119], v[188:191], v[168:171], v[116:119]
    v_mfma_f32_16x16x32_bf16 v[108:111], v[180:183], v[168:171], v[108:111]
    s_waitcnt lgkmcnt(15)
    v_mfma_f32_16x16x32_bf16 v[124:127], v[180:183], v[172:175], v[124:127]
    v_mfma_f32_16x16x32_bf16 v[132:135], v[188:191], v[172:175], v[132:135]
    v_mfma_f32_16x16x32_bf16 v[128:131], v[184:187], v[172:175], v[128:131]
    v_mfma_f32_16x16x32_bf16 v[136:139], v[192:195], v[172:175], v[136:139]
    s_waitcnt lgkmcnt(14)
    v_mfma_f32_16x16x32_bf16 v[152:155], v[192:195], v[176:179], v[152:155]
    v_mfma_f32_16x16x32_bf16 v[144:147], v[184:187], v[176:179], v[144:147]
    v_mfma_f32_16x16x32_bf16 v[148:151], v[188:191], v[176:179], v[148:151]
    v_mfma_f32_16x16x32_bf16 v[140:143], v[180:183], v[176:179], v[140:143]
    v_readfirstlane_b32 s78, v7
    s_nop 1
    s_cmp_lg_u32 s78, 0
    s_cbranch_scc1 NOND_6
    s_mov_b32 s4, 0
NON_5:
    global_load_dword v7, v8, s[44:45] sc1
    s_waitcnt vmcnt(0)
    v_readfirstlane_b32 s78, v7
    s_add_u32 s4, s4, 1
    s_cmp_ge_u32 s4, 0x20000
    s_cbranch_scc1 NOND_6
    s_cmp_eq_u32 s78, 0
    s_cbranch_scc1 NON_5
NOND_6:
    s_waitcnt lgkmcnt(0)
    s_barrier
    v_mfma_f32_16x16x32_bf16 v[60:63], v[220:223], v[196:199], v[60:63]
    ds_read_b128 v[156:159], v46 offset:0
    v_mfma_f32_16x16x32_bf16 v[68:71], v[228:231], v[196:199], v[68:71]
    ds_read_b64_tr_b16 v[180:181], v52 offset:0
    v_mfma_f32_16x16x32_bf16 v[64:67], v[224:227], v[196:199], v[64:67]
    ds_read_b64_tr_b16 v[182:183], v52 offset:512
    v_mfma_f32_16x16x32_bf16 v[72:75], v[232:235], v[196:199], v[72:75]
    ds_read_b64_tr_b16 v[188:189], v52 offset:8192
    v_mfma_f32_16x16x32_bf16 v[88:91], v[232:235], v[200:203], v[88:91]
    ds_read_b64_tr_b16 v[190:191], v52 offset:8704
    v_mfma_f32_16x16x32_bf16 v[80:83], v[224:227], v[200:203], v[80:83]
    ds_read_b64_tr_b16 v[184:185], v53 offset:0
    v_mfma_f32_16x16x32_bf16 v[84:87], v[228:231], v[200:203], v[84:87]
    ds_read_b64_tr_b16 v[186:187], v53 offset:512
    v_mfma_f32_16x16x32_bf16 v[76:79], v[220:223], v[200:203], v[76:79]
    ds_read_b64_tr_b16 v[192:193], v53 offset:8192
    v_mfma_f32_16x16x32_bf16 v[92:95], v[220:223], v[204:207], v[92:95]
    ds_read_b64_tr_b16 v[194:195], v53 offset:8704
    v_mfma_f32_16x16x32_bf16 v[100:103], v[228:231], v[204:207], v[100:103]
    ds_read_b128 v[160:163], v46 offset:2048
    v_mfma_f32_16x16x32_bf16 v[96:99], v[224:227], v[204:207], v[96:99]
    ds_read_b128 v[164:167], v46 offset:4096
    v_mfma_f32_16x16x32_bf16 v[104:107], v[232:235], v[204:207], v[104:107]
    ds_read_b128 v[168:171], v46 offset:6144
    v_mfma_f32_16x16x32_bf16 v[120:123], v[232:235], v[208:211], v[120:123]
    ds_read_b128 v[172:175], v46 offset:8192
    v_mfma_f32_16x16x32_bf16 v[112:115], v[224:227], v[208:211], v[112:115]
    ds_read_b128 v[176:179], v46 offset:10240
    v_mfma_f32_16x16x32_bf16 v[116:119], v[228:231], v[208:211], v[116:119]
    buffer_load_dwordx2 v[20:21], v5, s[64:67], s12 offen offset:0 sc1
    v_mfma_f32_16x16x32_bf16 v[108:111], v[220:223], v[208:211], v[108:111]
    v_mfma_f32_16x16x32_bf16 v[124:127], v[220:223], v[212:215], v[124:127]
    buffer_load_dwordx2 v[22:23], v5, s[64:67], s12 offen offset:128 sc1
    v_mfma_f32_16x16x32_bf16 v[132:135], v[228:231], v[212:215], v[132:135]
    v_mfma_f32_16x16x32_bf16 v[128:131], v[224:227], v[212:215], v[128:131]
    buffer_load_dwordx2 v[24:25], v5, s[64:67], s12 offen offset:256 sc1
    v_mfma_f32_16x16x32_bf16 v[136:139], v[232:235], v[212:215], v[136:139]
    v_mfma_f32_16x16x32_bf16 v[152:155], v[232:235], v[216:219], v[152:155]
    buffer_load_dwordx2 v[26:27], v5, s[64:67], s12 offen offset:384 sc1
    v_mfma_f32_16x16x32_bf16 v[144:147], v[224:227], v[216:219], v[144:147]
    v_mfma_f32_16x16x32_bf16 v[148:151], v[228:231], v[216:219], v[148:151]
    buffer_load_dwordx2 v[28:29], v5, s[64:67], s12 offen offset:512 sc1
    v_mfma_f32_16x16x32_bf16 v[140:143], v[220:223], v[216:219], v[140:143]
    s_waitcnt lgkmcnt(11)
    v_mfma_f32_16x16x32_bf16 v[60:63], v[180:183], v[156:159], v[60:63]
    ds_read_b128 v[196:199], v47 offset:0
    s_waitcnt lgkmcnt(10)
    v_mfma_f32_16x16x32_bf16 v[68:71], v[188:191], v[156:159], v[68:71]
    ds_read_b64_tr_b16 v[220:221], v52 offset:4096
    s_waitcnt lgkmcnt(9)
    v_mfma_f32_16x16x32_bf16 v[64:67], v[184:187], v[156:159], v[64:67]
    ds_read_b64_tr_b16 v[222:223], v52 offset:4608
    s_waitcnt lgkmcnt(8)
    v_mfma_f32_16x16x32_bf16 v[72:75], v[192:195], v[156:159], v[72:75]
    ds_read_b64_tr_b16 v[228:229], v52 offset:12288
    s_waitcnt lgkmcnt(8)
    v_mfma_f32_16x16x32_bf16 v[88:91], v[192:195], v[160:163], v[88:91]
    ds_read_b64_tr_b16 v[230:231], v52 offset:12800
    v_mfma_f32_16x16x32_bf16 v[80:83], v[184:187], v[160:163], v[80:83]
    ds_read_b64_tr_b16 v[224:225], v53 offset:4096
    v_mfma_f32_16x16x32_bf16 v[84:87], v[188:191], v[160:163], v[84:87]
    ds_read_b64_tr_b16 v[226:227], v53 offset:4608
    v_mfma_f32_16x16x32_bf16 v[76:79], v[180:183], v[160:163], v[76:79]
    ds_read_b64_tr_b16 v[232:233], v53 offset:12288
    s_waitcnt lgkmcnt(11)
    v_mfma_f32_16x16x32_bf16 v[92:95], v[180:183], v[164:167], v[92:95]
    ds_read_b64_tr_b16 v[234:235], v53 offset:12800
    v_mfma_f32_16x16x32_bf16 v[100:103], v[188:191], v[164:167], v[100:103]
    ds_read_b128 v[200:203], v47 offset:2048
    v_mfma_f32_16x16x32_bf16 v[96:99], v[184:187], v[164:167], v[96:99]
    ds_read_b128 v[204:207], v47 offset:4096
    v_mfma_f32_16x16x32_bf16 v[104:107], v[192:195], v[164:167], v[104:107]
    ds_read_b128 v[208:211], v47 offset:6144
    s_waitcnt lgkmcnt(14)
    v_mfma_f32_16x16x32_bf16 v[120:123], v[192:195], v[168:171], v[120:123]
    ds_read_b128 v[212:215], v47 offset:8192
    v_mfma_f32_16x16x32_bf16 v[112:115], v[184:187], v[168:171], v[112:115]
    ds_read_b128 v[216:219], v47 offset:10240
    v_mfma_f32_16x16x32_bf16 v[116:119], v[188:191], v[168:171], v[116:119]
    buffer_load_dwordx2 v[30:31], v5, s[64:67], s12 offen offset:640 sc1
    v_mfma_f32_16x16x32_bf16 v[108:111], v[180:183], v[168:171], v[108:111]
    s_waitcnt lgkmcnt(15)
    v_mfma_f32_16x16x32_bf16 v[124:127], v[180:183], v[172:175], v[124:127]
    v_mfma_f32_16x16x32_bf16 v[132:135], v[188:191], v[172:175], v[132:135]
    v_mfma_f32_16x16x32_bf16 v[128:131], v[184:187], v[172:175], v[128:131]
    v_mfma_f32_16x16x32_bf16 v[136:139], v[192:195], v[172:175], v[136:139]
    s_waitcnt lgkmcnt(14)
    v_mfma_f32_16x16x32_bf16 v[152:155], v[192:195], v[176:179], v[152:155]
    v_mfma_f32_16x16x32_bf16 v[144:147], v[184:187], v[176:179], v[144:147]
    v_mfma_f32_16x16x32_bf16 v[148:151], v[188:191], v[176:179], v[148:151]
    v_mfma_f32_16x16x32_bf16 v[140:143], v[180:183], v[176:179], v[140:143]
    s_waitcnt lgkmcnt(0)
    s_barrier
    v_mfma_f32_16x16x32_bf16 v[60:63], v[220:223], v[196:199], v[60:63]
    ds_read_b128 v[156:159], v48 offset:0
    v_mfma_f32_16x16x32_bf16 v[68:71], v[228:231], v[196:199], v[68:71]
    ds_read_b64_tr_b16 v[180:181], v54 offset:0
    v_mfma_f32_16x16x32_bf16 v[64:67], v[224:227], v[196:199], v[64:67]
    ds_read_b64_tr_b16 v[182:183], v54 offset:512
    v_mfma_f32_16x16x32_bf16 v[72:75], v[232:235], v[196:199], v[72:75]
    ds_read_b64_tr_b16 v[188:189], v54 offset:8192
    v_mfma_f32_16x16x32_bf16 v[88:91], v[232:235], v[200:203], v[88:91]
    ds_read_b64_tr_b16 v[190:191], v54 offset:8704
    v_mfma_f32_16x16x32_bf16 v[80:83], v[224:227], v[200:203], v[80:83]
    ds_read_b64_tr_b16 v[184:185], v55 offset:0
    v_mfma_f32_16x16x32_bf16 v[84:87], v[228:231], v[200:203], v[84:87]
    ds_read_b64_tr_b16 v[186:187], v55 offset:512
    v_mfma_f32_16x16x32_bf16 v[76:79], v[220:223], v[200:203], v[76:79]
    ds_read_b64_tr_b16 v[192:193], v55 offset:8192
    v_mfma_f32_16x16x32_bf16 v[92:95], v[220:223], v[204:207], v[92:95]
    ds_read_b64_tr_b16 v[194:195], v55 offset:8704
    v_mfma_f32_16x16x32_bf16 v[100:103], v[228:231], v[204:207], v[100:103]
    ds_read_b128 v[160:163], v48 offset:2048
    v_mfma_f32_16x16x32_bf16 v[96:99], v[224:227], v[204:207], v[96:99]
    ds_read_b128 v[164:167], v48 offset:4096
    v_mfma_f32_16x16x32_bf16 v[104:107], v[232:235], v[204:207], v[104:107]
    ds_read_b128 v[168:171], v48 offset:6144
    v_mfma_f32_16x16x32_bf16 v[120:123], v[232:235], v[208:211], v[120:123]
    ds_read_b128 v[172:175], v48 offset:8192
    v_mfma_f32_16x16x32_bf16 v[112:115], v[224:227], v[208:211], v[112:115]
    ds_read_b128 v[176:179], v48 offset:10240
    v_mfma_f32_16x16x32_bf16 v[116:119], v[228:231], v[208:211], v[116:119]
    v_mfma_f32_16x16x32_bf16 v[108:111], v[220:223], v[208:211], v[108:111]
    v_mfma_f32_16x16x32_bf16 v[124:127], v[220:223], v[212:215], v[124:127]
    v_mfma_f32_16x16x32_bf16 v[132:135], v[228:231], v[212:215], v[132:135]
    v_mfma_f32_16x16x32_bf16 v[128:131], v[224:227], v[212:215], v[128:131]
    v_mfma_f32_16x16x32_bf16 v[136:139], v[232:235], v[212:215], v[136:139]
    v_mfma_f32_16x16x32_bf16 v[152:155], v[232:235], v[216:219], v[152:155]
    v_mfma_f32_16x16x32_bf16 v[144:147], v[224:227], v[216:219], v[144:147]
    v_mfma_f32_16x16x32_bf16 v[148:151], v[228:231], v[216:219], v[148:151]
    v_mfma_f32_16x16x32_bf16 v[140:143], v[220:223], v[216:219], v[140:143]
    s_waitcnt lgkmcnt(11)
    v_mfma_f32_16x16x32_bf16 v[60:63], v[180:183], v[156:159], v[60:63]
    ds_read_b128 v[196:199], v49 offset:0
    s_waitcnt lgkmcnt(10)
    v_mfma_f32_16x16x32_bf16 v[68:71], v[188:191], v[156:159], v[68:71]
    ds_read_b64_tr_b16 v[220:221], v54 offset:4096
    s_waitcnt lgkmcnt(9)
    v_mfma_f32_16x16x32_bf16 v[64:67], v[184:187], v[156:159], v[64:67]
    ds_read_b64_tr_b16 v[222:223], v54 offset:4608
    s_waitcnt lgkmcnt(8)
    v_mfma_f32_16x16x32_bf16 v[72:75], v[192:195], v[156:159], v[72:75]
    ds_read_b64_tr_b16 v[228:229], v54 offset:12288
    s_waitcnt lgkmcnt(8)
    v_mfma_f32_16x16x32_bf16 v[88:91], v[192:195], v[160:163], v[88:91]
    ds_read_b64_tr_b16 v[230:231], v54 offset:12800
    v_mfma_f32_16x16x32_bf16 v[80:83], v[184:187], v[160:163], v[80:83]
    ds_read_b64_tr_b16 v[224:225], v55 offset:4096
    v_mfma_f32_16x16x32_bf16 v[84:87], v[188:191], v[160:163], v[84:87]
    ds_read_b64_tr_b16 v[226:227], v55 offset:4608
    v_mfma_f32_16x16x32_bf16 v[76:79], v[180:183], v[160:163], v[76:79]
    ds_read_b64_tr_b16 v[232:233], v55 offset:12288
    s_waitcnt lgkmcnt(11)
    v_mfma_f32_16x16x32_bf16 v[92:95], v[180:183], v[164:167], v[92:95]
    ds_read_b64_tr_b16 v[234:235], v55 offset:12800
    v_mfma_f32_16x16x32_bf16 v[100:103], v[188:191], v[164:167], v[100:103]
    ds_read_b128 v[200:203], v49 offset:2048
    v_mfma_f32_16x16x32_bf16 v[96:99], v[184:187], v[164:167], v[96:99]
    ds_read_b128 v[204:207], v49 offset:4096
    v_mfma_f32_16x16x32_bf16 v[104:107], v[192:195], v[164:167], v[104:107]
    ds_read_b128 v[208:211], v49 offset:6144
    s_waitcnt lgkmcnt(14)
    v_mfma_f32_16x16x32_bf16 v[120:123], v[192:195], v[168:171], v[120:123]
    ds_read_b128 v[212:215], v49 offset:8192
    v_mfma_f32_16x16x32_bf16 v[112:115], v[184:187], v[168:171], v[112:115]
    ds_read_b128 v[216:219], v49 offset:10240
    v_mfma_f32_16x16x32_bf16 v[116:119], v[188:191], v[168:171], v[116:119]
    buffer_load_dwordx4 v[12:15], v6, s[64:67], s28 offen offset:0 sc1
    v_mfma_f32_16x16x32_bf16 v[108:111], v[180:183], v[168:171], v[108:111]
    s_waitcnt lgkmcnt(15)
    v_mfma_f32_16x16x32_bf16 v[124:127], v[180:183], v[172:175], v[124:127]
    buffer_load_dwordx4 v[16:19], v6, s[64:67], s28 offen offset:1024 sc1
    v_mfma_f32_16x16x32_bf16 v[132:135], v[188:191], v[172:175], v[132:135]
    v_mfma_f32_16x16x32_bf16 v[128:131], v[184:187], v[172:175], v[128:131]
    v_and_b32 v7, 3, v1
    v_lshlrev_b32 v7, 2, v7
    v_mfma_f32_16x16x32_bf16 v[136:139], v[192:195], v[172:175], v[136:139]
    v_add_u32 v7, 145120, v7
    s_waitcnt lgkmcnt(14)
    v_mfma_f32_16x16x32_bf16 v[152:155], v[192:195], v[176:179], v[152:155]
    buffer_load_dwordx4 v[32:35], v6, s[64:67], s28 offen offset:2048 sc1
    v_mfma_f32_16x16x32_bf16 v[144:147], v[184:187], v[176:179], v[144:147]
    v_mfma_f32_16x16x32_bf16 v[148:151], v[188:191], v[176:179], v[148:151]
    buffer_load_dwordx4 v[36:39], v6, s[64:67], s28 offen offset:3072 sc1
    v_mfma_f32_16x16x32_bf16 v[140:143], v[180:183], v[176:179], v[140:143]
    s_waitcnt lgkmcnt(11)
    v_mfma_f32_16x16x32_bf16 v[60:63], v[220:223], v[196:199], v[60:63]
    ds_read_b32 v8, v7
    s_waitcnt lgkmcnt(10)
    v_mfma_f32_16x16x32_bf16 v[68:71], v[228:231], v[196:199], v[68:71]
    v_lshrrev_b32 v3, 4, v1
    v_cmp_gt_u32 s[10:11], 2, v3
    v_cmp_ne_u32 s[6:7], 2, v3
    s_waitcnt lgkmcnt(8)
    v_mfma_f32_16x16x32_bf16 v[64:67], v[224:227], v[196:199], v[64:67]
    s_waitcnt vmcnt(9)
    v_cndmask_b32 v156, 0, v20, s[10:11]
    v_cndmask_b32 v157, 0, v20, s[10:11]
    v_cndmask_b32 v158, 0, v20, s[6:7]
    s_waitcnt lgkmcnt(6)
    v_mfma_f32_16x16x32_bf16 v[72:75], v[232:235], v[196:199], v[72:75]
    v_cndmask_b32 v159, 0, v20, s[6:7]
    s_waitcnt vmcnt(8)
    v_cndmask_b32 v160, 0, v22, s[10:11]
    v_cndmask_b32 v161, 0, v22, s[10:11]
    s_waitcnt lgkmcnt(5)
    v_mfma_f32_16x16x32_bf16 v[88:91], v[232:235], v[200:203], v[88:91]
    v_cndmask_b32 v162, 0, v22, s[6:7]
    v_cndmask_b32 v163, 0, v22, s[6:7]
    s_waitcnt vmcnt(7)
    v_cndmask_b32 v164, 0, v24, s[10:11]
    v_mfma_f32_16x16x32_bf16 v[80:83], v[224:227], v[200:203], v[80:83]
    v_cndmask_b32 v165, 0, v24, s[10:11]
    v_cndmask_b32 v166, 0, v24, s[6:7]
    v_cndmask_b32 v167, 0, v24, s[6:7]
    v_mfma_f32_16x16x32_bf16 v[84:87], v[228:231], v[200:203], v[84:87]
    s_waitcnt lgkmcnt(0)
    v_cmp_eq_u32 vcc, 0, v8
    s_nop 1
    s_cbranch_vccnz FC_7
FCB_8:
    v_mfma_f32_16x16x32_bf16 v[76:79], v[220:223], v[200:203], v[76:79]
    ds_read_b64_tr_b16 v[180:181], v58 offset:0
    v_mfma_f32_16x16x32_bf16 v[92:95], v[220:223], v[204:207], v[92:95]
    ds_read_b64_tr_b16 v[182:183], v58 offset:512
    v_mfma_f32_16x16x32_bf16 v[100:103], v[228:231], v[204:207], v[100:103]
    ds_read_b64_tr_b16 v[188:189], v58 offset:4096
    v_mfma_f32_16x16x32_bf16 v[96:99], v[224:227], v[204:207], v[96:99]
    ds_read_b64_tr_b16 v[190:191], v58 offset:4608
    v_mfma_f32_16x16x32_bf16 v[104:107], v[232:235], v[204:207], v[104:107]
    ds_read_b64_tr_b16 v[184:185], v59 offset:0
    v_mfma_f32_16x16x32_bf16 v[120:123], v[232:235], v[208:211], v[120:123]
    ds_read_b64_tr_b16 v[186:187], v59 offset:512
    v_mfma_f32_16x16x32_bf16 v[112:115], v[224:227], v[208:211], v[112:115]
    ds_read_b64_tr_b16 v[192:193], v59 offset:4096
    v_mfma_f32_16x16x32_bf16 v[116:119], v[228:231], v[208:211], v[116:119]
    ds_read_b64_tr_b16 v[194:195], v59 offset:4608
    v_mfma_f32_16x16x32_bf16 v[108:111], v[220:223], v[208:211], v[108:111]
    s_waitcnt vmcnt(6)
    v_cndmask_b32 v168, 0, v26, s[10:11]
    v_cndmask_b32 v169, 0, v26, s[10:11]
    v_cndmask_b32 v170, 0, v26, s[6:7]
    v_mfma_f32_16x16x32_bf16 v[124:127], v[220:223], v[212:215], v[124:127]
    v_cndmask_b32 v171, 0, v26, s[6:7]
    s_waitcnt vmcnt(5)
    v_cndmask_b32 v172, 0, v28, s[10:11]
    v_cndmask_b32 v173, 0, v28, s[10:11]
    v_mfma_f32_16x16x32_bf16 v[132:135], v[228:231], v[212:215], v[132:135]
    v_cndmask_b32 v174, 0, v28, s[6:7]
    v_cndmask_b32 v175, 0, v28, s[6:7]
    s_waitcnt vmcnt(4)
    v_cndmask_b32 v176, 0, v30, s[10:11]
    v_mfma_f32_16x16x32_bf16 v[128:131], v[224:227], v[212:215], v[128:131]
    v_cndmask_b32 v177, 0, v30, s[10:11]
    v_cndmask_b32 v178, 0, v30, s[6:7]
    v_cndmask_b32 v179, 0, v30, s[6:7]
    v_mfma_f32_16x16x32_bf16 v[136:139], v[232:235], v[212:215], v[136:139]
    v_mfma_f32_16x16x32_bf16 v[152:155], v[232:235], v[216:219], v[152:155]
    v_mfma_f32_16x16x32_bf16 v[144:147], v[224:227], v[216:219], v[144:147]
    v_mfma_f32_16x16x32_bf16 v[148:151], v[228:231], v[216:219], v[148:151]
    v_mfma_f32_16x16x32_bf16 v[140:143], v[220:223], v[216:219], v[140:143]
    buffer_load_dwordx4 v[40:43], v9, s[64:67], s28 offen offset:0 sc1
    buffer_load_dwordx4 v[236:239], v6, s[64:67], s29 offen offset:0 sc1
    buffer_load_dwordx4 v[240:243], v6, s[64:67], s29 offen offset:1024 sc1
    buffer_load_dwordx4 v[244:247], v6, s[64:67], s29 offen offset:2048 sc1
    buffer_load_dwordx4 v[248:251], v6, s[64:67], s29 offen offset:3072 sc1
    buffer_load_dwordx4 v[252:255], v9, s[64:67], s29 offen offset:0 sc1
    ds_write_b32 v10, v10 offset:64
    s_waitcnt lgkmcnt(7)
    v_mfma_f32_16x16x32_bf16 v[60:63], v[180:183], v[156:159], v[60:63]
    v_rcp_f32 v3, v21
    v_mul_f32 v208, v21, v21
    s_waitcnt lgkmcnt(5)
    v_mfma_f32_16x16x32_bf16 v[68:71], v[188:191], v[156:159], v[68:71]
    v_mul_f32 v196, 0xc0135761, v3
    v_mul_f32 v4, v3, v3
    s_waitcnt lgkmcnt(3)
    v_mfma_f32_16x16x32_bf16 v[64:67], v[184:187], v[156:159], v[64:67]
    v_mul_f32 v4, 0x3d372713, v4
    v_mul_f32 v197, v4, v196
    s_waitcnt lgkmcnt(1)
    v_mfma_f32_16x16x32_bf16 v[72:75], v[192:195], v[156:159], v[72:75]
    v_rcp_f32 v3, v23
    v_mul_f32 v209, v23, v23
    v_mfma_f32_16x16x32_bf16 v[88:91], v[192:195], v[160:163], v[88:91]
    v_mul_f32 v198, 0xc0135761, v3
    v_mul_f32 v4, v3, v3
    v_mfma_f32_16x16x32_bf16 v[80:83], v[184:187], v[160:163], v[80:83]
    v_mul_f32 v4, 0x3d372713, v4
    v_mul_f32 v199, v4, v198
    v_mfma_f32_16x16x32_bf16 v[84:87], v[188:191], v[160:163], v[84:87]
    v_rcp_f32 v3, v25
    v_mul_f32 v210, v25, v25
    v_mfma_f32_16x16x32_bf16 v[76:79], v[180:183], v[160:163], v[76:79]
    v_mul_f32 v200, 0xc0135761, v3
    v_mul_f32 v4, v3, v3
    v_mfma_f32_16x16x32_bf16 v[92:95], v[180:183], v[164:167], v[92:95]
    v_mul_f32 v4, 0x3d372713, v4
    v_mul_f32 v201, v4, v200
    v_mfma_f32_16x16x32_bf16 v[100:103], v[188:191], v[164:167], v[100:103]
    v_rcp_f32 v3, v27
    v_mul_f32 v211, v27, v27
    v_mfma_f32_16x16x32_bf16 v[96:99], v[184:187], v[164:167], v[96:99]
    v_mul_f32 v202, 0xc0135761, v3
    v_mul_f32 v4, v3, v3
    v_mfma_f32_16x16x32_bf16 v[104:107], v[192:195], v[164:167], v[104:107]
    v_mul_f32 v4, 0x3d372713, v4
    v_mul_f32 v203, v4, v202
    v_mfma_f32_16x16x32_bf16 v[120:123], v[192:195], v[168:171], v[120:123]
    v_rcp_f32 v3, v29
    v_mul_f32 v212, v29, v29
    v_mfma_f32_16x16x32_bf16 v[112:115], v[184:187], v[168:171], v[112:115]
    v_mul_f32 v204, 0xc0135761, v3
    v_mul_f32 v4, v3, v3
    v_mfma_f32_16x16x32_bf16 v[116:119], v[188:191], v[168:171], v[116:119]
    v_mul_f32 v4, 0x3d372713, v4
    v_mul_f32 v205, v4, v204
    v_mfma_f32_16x16x32_bf16 v[108:111], v[180:183], v[168:171], v[108:111]
    v_rcp_f32 v3, v31
    v_mul_f32 v213, v31, v31
    v_mfma_f32_16x16x32_bf16 v[124:127], v[180:183], v[172:175], v[124:127]
    v_mul_f32 v206, 0xc0135761, v3
    v_mul_f32 v4, v3, v3
    v_mfma_f32_16x16x32_bf16 v[132:135], v[188:191], v[172:175], v[132:135]
    v_mul_f32 v4, 0x3d372713, v4
    v_mul_f32 v207, v4, v206
    v_mfma_f32_16x16x32_bf16 v[128:131], v[184:187], v[172:175], v[128:131]
    v_mfma_f32_16x16x32_bf16 v[136:139], v[192:195], v[172:175], v[136:139]
    v_mfma_f32_16x16x32_bf16 v[152:155], v[192:195], v[176:179], v[152:155]
    v_mfma_f32_16x16x32_bf16 v[144:147], v[184:187], v[176:179], v[144:147]
    v_mfma_f32_16x16x32_bf16 v[148:151], v[188:191], v[176:179], v[148:151]
    v_mfma_f32_16x16x32_bf16 v[140:143], v[180:183], v[176:179], v[140:143]
.p2align 3
    v_pk_mul_f32 v[216:217], v[60:61], v[60:61]
    v_pk_mul_f32 v[218:219], v[62:63], v[62:63]
    v_pk_mul_f32 v[220:221], v[76:77], v[76:77]
    v_pk_mul_f32 v[222:223], v[78:79], v[78:79]
    v_pk_fma_f32 v[216:217], v[216:217], v[196:197], v[196:197] op_sel:[0,1,0] op_sel_hi:[1,1,0]
    v_pk_fma_f32 v[218:219], v[218:219], v[196:197], v[196:197] op_sel:[0,1,0] op_sel_hi:[1,1,0]
    v_pk_fma_f32 v[220:221], v[220:221], v[198:199], v[198:199] op_sel:[0,1,0] op_sel_hi:[1,1,0]
    v_pk_fma_f32 v[222:223], v[222:223], v[198:199], v[198:199] op_sel:[0,1,0] op_sel_hi:[1,1,0]
    v_pk_mul_f32 v[216:217], v[216:217], v[60:61]
    v_pk_mul_f32 v[218:219], v[218:219], v[62:63]
    v_pk_mul_f32 v[220:221], v[220:221], v[76:77]
    v_pk_mul_f32 v[222:223], v[222:223], v[78:79]
    v_exp_f32 v216, v216
    v_exp_f32 v217, v217
    v_exp_f32 v218, v218
    v_exp_f32 v219, v219
    v_exp_f32 v220, v220
    v_exp_f32 v221, v221
    v_exp_f32 v222, v222
    v_exp_f32 v223, v223
    v_pk_mul_f32 v[60:61], v[60:61], v[68:69]
    v_pk_mul_f32 v[62:63], v[62:63], v[70:71]
    v_pk_mul_f32 v[76:77], v[76:77], v[84:85]
    v_pk_mul_f32 v[78:79], v[78:79], v[86:87]
    v_pk_fma_f32 v[216:217], v[216:217], v[208:209], v[208:209] op_sel:[0,0,0] op_sel_hi:[1,0,0]
    v_pk_fma_f32 v[218:219], v[218:219], v[208:209], v[208:209] op_sel:[0,0,0] op_sel_hi:[1,0,0]
    v_pk_fma_f32 v[220:221], v[220:221], v[208:209], v[208:209] op_sel:[0,1,1] op_sel_hi:[1,1,1]
    v_pk_fma_f32 v[222:223], v[222:223], v[208:209], v[208:209] op_sel:[0,1,1] op_sel_hi:[1,1,1]
    v_rcp_f32 v216, v216
    v_rcp_f32 v217, v217
    v_rcp_f32 v218, v218
    v_rcp_f32 v219, v219
    v_rcp_f32 v220, v220
    v_rcp_f32 v221, v221
    v_rcp_f32 v222, v222
    v_rcp_f32 v223, v223
    v_pk_mul_f32 v[60:61], v[60:61], v[216:217]
    v_pk_mul_f32 v[62:63], v[62:63], v[218:219]
    v_pk_mul_f32 v[76:77], v[76:77], v[220:221]
    v_pk_mul_f32 v[78:79], v[78:79], v[222:223]
    v_cvt_pk_bf16_f32 v224, v60, v61
    v_cvt_pk_bf16_f32 v226, v76, v77
    v_cvt_pk_bf16_f32 v225, v62, v63
    v_cvt_pk_bf16_f32 v227, v78, v79
    v_permlane16_swap_b32 v224, v226
    s_nop 0
    v_permlane16_swap_b32 v225, v227
    buffer_store_dwordx4 v[224:227], v0, s[64:67], s52 offen sc1
.p2align 3
    v_pk_mul_f32 v[216:217], v[64:65], v[64:65]
    v_pk_mul_f32 v[218:219], v[66:67], v[66:67]
    v_pk_mul_f32 v[220:221], v[80:81], v[80:81]
    v_pk_mul_f32 v[222:223], v[82:83], v[82:83]
    v_pk_fma_f32 v[216:217], v[216:217], v[196:197], v[196:197] op_sel:[0,1,0] op_sel_hi:[1,1,0]
    v_pk_fma_f32 v[218:219], v[218:219], v[196:197], v[196:197] op_sel:[0,1,0] op_sel_hi:[1,1,0]
    v_pk_fma_f32 v[220:221], v[220:221], v[198:199], v[198:199] op_sel:[0,1,0] op_sel_hi:[1,1,0]
    v_pk_fma_f32 v[222:223], v[222:223], v[198:199], v[198:199] op_sel:[0,1,0] op_sel_hi:[1,1,0]
    v_pk_mul_f32 v[216:217], v[216:217], v[64:65]
    v_pk_mul_f32 v[218:219], v[218:219], v[66:67]
    v_pk_mul_f32 v[220:221], v[220:221], v[80:81]
    v_pk_mul_f32 v[222:223], v[222:223], v[82:83]
    v_exp_f32 v216, v216
    v_exp_f32 v217, v217
    v_exp_f32 v218, v218
    v_exp_f32 v219, v219
    v_exp_f32 v220, v220
    v_exp_f32 v221, v221
    v_exp_f32 v222, v222
    v_exp_f32 v223, v223
    v_pk_mul_f32 v[64:65], v[64:65], v[72:73]
    v_pk_mul_f32 v[66:67], v[66:67], v[74:75]
    v_pk_mul_f32 v[80:81], v[80:81], v[88:89]
    v_pk_mul_f32 v[82:83], v[82:83], v[90:91]
    v_pk_fma_f32 v[216:217], v[216:217], v[208:209], v[208:209] op_sel:[0,0,0] op_sel_hi:[1,0,0]
    v_pk_fma_f32 v[218:219], v[218:219], v[208:209], v[208:209] op_sel:[0,0,0] op_sel_hi:[1,0,0]
    v_pk_fma_f32 v[220:221], v[220:221], v[208:209], v[208:209] op_sel:[0,1,1] op_sel_hi:[1,1,1]
    v_pk_fma_f32 v[222:223], v[222:223], v[208:209], v[208:209] op_sel:[0,1,1] op_sel_hi:[1,1,1]
    v_rcp_f32 v216, v216
    v_rcp_f32 v217, v217
    v_rcp_f32 v218, v218
    v_rcp_f32 v219, v219
    v_rcp_f32 v220, v220
    v_rcp_f32 v221, v221
    v_rcp_f32 v222, v222
    v_rcp_f32 v223, v223
    v_pk_mul_f32 v[64:65], v[64:65], v[216:217]
    v_pk_mul_f32 v[66:67], v[66:67], v[218:219]
    v_pk_mul_f32 v[80:81], v[80:81], v[220:221]
    v_pk_mul_f32 v[82:83], v[82:83], v[222:223]
    v_cvt_pk_bf16_f32 v228, v64, v65
    v_cvt_pk_bf16_f32 v230, v80, v81
    v_cvt_pk_bf16_f32 v229, v66, v67
    v_cvt_pk_bf16_f32 v231, v82, v83
    v_permlane16_swap_b32 v228, v230
    s_nop 0
    v_permlane16_swap_b32 v229, v231
    buffer_store_dwordx4 v[228:231], v0, s[64:67], s53 offen sc1
.p2align 3
    v_pk_mul_f32 v[216:217], v[92:93], v[92:93]
    v_pk_mul_f32 v[218:219], v[94:95], v[94:95]
    v_pk_mul_f32 v[220:221], v[108:109], v[108:109]
    v_pk_mul_f32 v[222:223], v[110:111], v[110:111]
    v_pk_fma_f32 v[216:217], v[216:217], v[200:201], v[200:201] op_sel:[0,1,0] op_sel_hi:[1,1,0]
    v_pk_fma_f32 v[218:219], v[218:219], v[200:201], v[200:201] op_sel:[0,1,0] op_sel_hi:[1,1,0]
    v_pk_fma_f32 v[220:221], v[220:221], v[202:203], v[202:203] op_sel:[0,1,0] op_sel_hi:[1,1,0]
    v_pk_fma_f32 v[222:223], v[222:223], v[202:203], v[202:203] op_sel:[0,1,0] op_sel_hi:[1,1,0]
    v_pk_mul_f32 v[216:217], v[216:217], v[92:93]
    v_pk_mul_f32 v[218:219], v[218:219], v[94:95]
    v_pk_mul_f32 v[220:221], v[220:221], v[108:109]
    v_pk_mul_f32 v[222:223], v[222:223], v[110:111]
    v_exp_f32 v216, v216
    v_exp_f32 v217, v217
    v_exp_f32 v218, v218
    v_exp_f32 v219, v219
    v_exp_f32 v220, v220
    v_exp_f32 v221, v221
    v_exp_f32 v222, v222
    v_exp_f32 v223, v223
    v_pk_mul_f32 v[92:93], v[92:93], v[100:101]
    v_pk_mul_f32 v[94:95], v[94:95], v[102:103]
    v_pk_mul_f32 v[108:109], v[108:109], v[116:117]
    v_pk_mul_f32 v[110:111], v[110:111], v[118:119]
    v_pk_fma_f32 v[216:217], v[216:217], v[210:211], v[210:211] op_sel:[0,0,0] op_sel_hi:[1,0,0]
    v_pk_fma_f32 v[218:219], v[218:219], v[210:211], v[210:211] op_sel:[0,0,0] op_sel_hi:[1,0,0]
    v_pk_fma_f32 v[220:221], v[220:221], v[210:211], v[210:211] op_sel:[0,1,1] op_sel_hi:[1,1,1]
    v_pk_fma_f32 v[222:223], v[222:223], v[210:211], v[210:211] op_sel:[0,1,1] op_sel_hi:[1,1,1]
    v_rcp_f32 v216, v216
    v_rcp_f32 v217, v217
    v_rcp_f32 v218, v218
    v_rcp_f32 v219, v219
    v_rcp_f32 v220, v220
    v_rcp_f32 v221, v221
    v_rcp_f32 v222, v222
    v_rcp_f32 v223, v223
    v_pk_mul_f32 v[92:93], v[92:93], v[216:217]
    v_pk_mul_f32 v[94:95], v[94:95], v[218:219]
    v_pk_mul_f32 v[108:109], v[108:109], v[220:221]
    v_pk_mul_f32 v[110:111], v[110:111], v[222:223]
    v_cvt_pk_bf16_f32 v224, v92, v93
    v_cvt_pk_bf16_f32 v226, v108, v109
    v_cvt_pk_bf16_f32 v225, v94, v95
    v_cvt_pk_bf16_f32 v227, v110, v111
    v_permlane16_swap_b32 v224, v226
    s_nop 0
    v_permlane16_swap_b32 v225, v227
    buffer_store_dwordx4 v[224:227], v0, s[64:67], s54 offen sc1
.p2align 3
    v_pk_mul_f32 v[216:217], v[96:97], v[96:97]
    v_pk_mul_f32 v[218:219], v[98:99], v[98:99]
    v_pk_mul_f32 v[220:221], v[112:113], v[112:113]
    v_pk_mul_f32 v[222:223], v[114:115], v[114:115]
    v_pk_fma_f32 v[216:217], v[216:217], v[200:201], v[200:201] op_sel:[0,1,0] op_sel_hi:[1,1,0]
    v_pk_fma_f32 v[218:219], v[218:219], v[200:201], v[200:201] op_sel:[0,1,0] op_sel_hi:[1,1,0]
    v_pk_fma_f32 v[220:221], v[220:221], v[202:203], v[202:203] op_sel:[0,1,0] op_sel_hi:[1,1,0]
    v_pk_fma_f32 v[222:223], v[222:223], v[202:203], v[202:203] op_sel:[0,1,0] op_sel_hi:[1,1,0]
    v_pk_mul_f32 v[216:217], v[216:217], v[96:97]
    v_pk_mul_f32 v[218:219], v[218:219], v[98:99]
    v_pk_mul_f32 v[220:221], v[220:221], v[112:113]
    v_pk_mul_f32 v[222:223], v[222:223], v[114:115]
    v_exp_f32 v216, v216
    v_exp_f32 v217, v217
    v_exp_f32 v218, v218
    v_exp_f32 v219, v219
    v_exp_f32 v220, v220
    v_exp_f32 v221, v221
    v_exp_f32 v222, v222
    v_exp_f32 v223, v223
    v_pk_mul_f32 v[96:97], v[96:97], v[104:105]
    v_pk_mul_f32 v[98:99], v[98:99], v[106:107]
    v_pk_mul_f32 v[112:113], v[112:113], v[120:121]
    v_pk_mul_f32 v[114:115], v[114:115], v[122:123]
    v_pk_fma_f32 v[216:217], v[216:217], v[210:211], v[210:211] op_sel:[0,0,0] op_sel_hi:[1,0,0]
    v_pk_fma_f32 v[218:219], v[218:219], v[210:211], v[210:211] op_sel:[0,0,0] op_sel_hi:[1,0,0]
    v_pk_fma_f32 v[220:221], v[220:221], v[210:211], v[210:211] op_sel:[0,1,1] op_sel_hi:[1,1,1]
    v_pk_fma_f32 v[222:223], v[222:223], v[210:211], v[210:211] op_sel:[0,1,1] op_sel_hi:[1,1,1]
    v_rcp_f32 v216, v216
    v_rcp_f32 v217, v217
    v_rcp_f32 v218, v218
    v_rcp_f32 v219, v219
    v_rcp_f32 v220, v220
    v_rcp_f32 v221, v221
    v_rcp_f32 v222, v222
    v_rcp_f32 v223, v223
    v_pk_mul_f32 v[96:97], v[96:97], v[216:217]
    v_pk_mul_f32 v[98:99], v[98:99], v[218:219]
    v_pk_mul_f32 v[112:113], v[112:113], v[220:221]
    v_pk_mul_f32 v[114:115], v[114:115], v[222:223]
    v_cvt_pk_bf16_f32 v228, v96, v97
    v_cvt_pk_bf16_f32 v230, v112, v113
    v_cvt_pk_bf16_f32 v229, v98, v99
    v_cvt_pk_bf16_f32 v231, v114, v115
    v_permlane16_swap_b32 v228, v230
    s_nop 0
    v_permlane16_swap_b32 v229, v231
    buffer_store_dwordx4 v[228:231], v0, s[64:67], s55 offen sc1
.p2align 3
    v_pk_mul_f32 v[216:217], v[124:125], v[124:125]
    v_pk_mul_f32 v[218:219], v[126:127], v[126:127]
    v_pk_mul_f32 v[220:221], v[140:141], v[140:141]
    v_pk_mul_f32 v[222:223], v[142:143], v[142:143]
    v_pk_fma_f32 v[216:217], v[216:217], v[204:205], v[204:205] op_sel:[0,1,0] op_sel_hi:[1,1,0]
    v_pk_fma_f32 v[218:219], v[218:219], v[204:205], v[204:205] op_sel:[0,1,0] op_sel_hi:[1,1,0]
    v_pk_fma_f32 v[220:221], v[220:221], v[206:207], v[206:207] op_sel:[0,1,0] op_sel_hi:[1,1,0]
    v_pk_fma_f32 v[222:223], v[222:223], v[206:207], v[206:207] op_sel:[0,1,0] op_sel_hi:[1,1,0]
    v_pk_mul_f32 v[216:217], v[216:217], v[124:125]
    v_pk_mul_f32 v[218:219], v[218:219], v[126:127]
    v_pk_mul_f32 v[220:221], v[220:221], v[140:141]
    v_pk_mul_f32 v[222:223], v[222:223], v[142:143]
    v_exp_f32 v216, v216
    v_exp_f32 v217, v217
    v_exp_f32 v218, v218
    v_exp_f32 v219, v219
    v_exp_f32 v220, v220
    v_exp_f32 v221, v221
    v_exp_f32 v222, v222
    v_exp_f32 v223, v223
    v_pk_mul_f32 v[124:125], v[124:125], v[132:133]
    v_pk_mul_f32 v[126:127], v[126:127], v[134:135]
    v_pk_mul_f32 v[140:141], v[140:141], v[148:149]
    v_pk_mul_f32 v[142:143], v[142:143], v[150:151]
    v_pk_fma_f32 v[216:217], v[216:217], v[212:213], v[212:213] op_sel:[0,0,0] op_sel_hi:[1,0,0]
    v_pk_fma_f32 v[218:219], v[218:219], v[212:213], v[212:213] op_sel:[0,0,0] op_sel_hi:[1,0,0]
    v_pk_fma_f32 v[220:221], v[220:221], v[212:213], v[212:213] op_sel:[0,1,1] op_sel_hi:[1,1,1]
    v_pk_fma_f32 v[222:223], v[222:223], v[212:213], v[212:213] op_sel:[0,1,1] op_sel_hi:[1,1,1]
    v_rcp_f32 v216, v216
    v_rcp_f32 v217, v217
    v_rcp_f32 v218, v218
    v_rcp_f32 v219, v219
    v_rcp_f32 v220, v220
    v_rcp_f32 v221, v221
    v_rcp_f32 v222, v222
    v_rcp_f32 v223, v223
    v_pk_mul_f32 v[124:125], v[124:125], v[216:217]
    v_pk_mul_f32 v[126:127], v[126:127], v[218:219]
    v_pk_mul_f32 v[140:141], v[140:141], v[220:221]
    v_pk_mul_f32 v[142:143], v[142:143], v[222:223]
    v_cvt_pk_bf16_f32 v224, v124, v125
    v_cvt_pk_bf16_f32 v226, v140, v141
    v_cvt_pk_bf16_f32 v225, v126, v127
    v_cvt_pk_bf16_f32 v227, v142, v143
    v_permlane16_swap_b32 v224, v226
    s_nop 0
    v_permlane16_swap_b32 v225, v227
    buffer_store_dwordx4 v[224:227], v0, s[64:67], s56 offen sc1
.p2align 3
    v_pk_mul_f32 v[216:217], v[128:129], v[128:129]
    v_pk_mul_f32 v[218:219], v[130:131], v[130:131]
    v_pk_mul_f32 v[220:221], v[144:145], v[144:145]
    v_pk_mul_f32 v[222:223], v[146:147], v[146:147]
    v_pk_fma_f32 v[216:217], v[216:217], v[204:205], v[204:205] op_sel:[0,1,0] op_sel_hi:[1,1,0]
    v_pk_fma_f32 v[218:219], v[218:219], v[204:205], v[204:205] op_sel:[0,1,0] op_sel_hi:[1,1,0]
    v_pk_fma_f32 v[220:221], v[220:221], v[206:207], v[206:207] op_sel:[0,1,0] op_sel_hi:[1,1,0]
    v_pk_fma_f32 v[222:223], v[222:223], v[206:207], v[206:207] op_sel:[0,1,0] op_sel_hi:[1,1,0]
    v_pk_mul_f32 v[216:217], v[216:217], v[128:129]
    v_pk_mul_f32 v[218:219], v[218:219], v[130:131]
    v_pk_mul_f32 v[220:221], v[220:221], v[144:145]
    v_pk_mul_f32 v[222:223], v[222:223], v[146:147]
    v_exp_f32 v216, v216
    v_exp_f32 v217, v217
    v_exp_f32 v218, v218
    v_exp_f32 v219, v219
    v_exp_f32 v220, v220
    v_exp_f32 v221, v221
    v_exp_f32 v222, v222
    v_exp_f32 v223, v223
    v_pk_mul_f32 v[128:129], v[128:129], v[136:137]
    v_pk_mul_f32 v[130:131], v[130:131], v[138:139]
    v_pk_mul_f32 v[144:145], v[144:145], v[152:153]
    v_pk_mul_f32 v[146:147], v[146:147], v[154:155]
    v_pk_fma_f32 v[216:217], v[216:217], v[212:213], v[212:213] op_sel:[0,0,0] op_sel_hi:[1,0,0]
    v_pk_fma_f32 v[218:219], v[218:219], v[212:213], v[212:213] op_sel:[0,0,0] op_sel_hi:[1,0,0]
    v_pk_fma_f32 v[220:221], v[220:221], v[212:213], v[212:213] op_sel:[0,1,1] op_sel_hi:[1,1,1]
    v_pk_fma_f32 v[222:223], v[222:223], v[212:213], v[212:213] op_sel:[0,1,1] op_sel_hi:[1,1,1]
    v_rcp_f32 v216, v216
    v_rcp_f32 v217, v217
    v_rcp_f32 v218, v218
    v_rcp_f32 v219, v219
    v_rcp_f32 v220, v220
    v_rcp_f32 v221, v221
    v_rcp_f32 v222, v222
    v_rcp_f32 v223, v223
    v_pk_mul_f32 v[128:129], v[128:129], v[216:217]
    v_pk_mul_f32 v[130:131], v[130:131], v[218:219]
    v_pk_mul_f32 v[144:145], v[144:145], v[220:221]
    v_pk_mul_f32 v[146:147], v[146:147], v[222:223]
    v_cvt_pk_bf16_f32 v228, v128, v129
    v_cvt_pk_bf16_f32 v230, v144, v145
    v_cvt_pk_bf16_f32 v229, v130, v131
    v_cvt_pk_bf16_f32 v231, v146, v147
    v_permlane16_swap_b32 v228, v230
    s_nop 0
    v_permlane16_swap_b32 v229, v231
    buffer_store_dwordx4 v[228:231], v0, s[64:67], s57 offen sc1
.p2align 3
L_G1J:
    ds_write_b32 v10, v10
    s_setprio 0
    s_add_u32 s4, s3, 1
    s_and_b32 s4, s4, 3
    s_lshl_b32 s4, s4, 10
    v_add_u32 v0, s4, v6
    s_add_u32 s4, s3, 2
    s_and_b32 s4, s4, 3
    s_lshl_b32 s4, s4, 10
    v_add_u32 v2, s4, v6
    s_add_u32 s4, s3, 3
    s_and_b32 s4, s4, 3
    s_lshl_b32 s4, s4, 10
    v_add_u32 v7, s4, v6
    s_add_u32 s4, s3, 4
    s_and_b32 s4, s4, 3
    s_lshl_b32 s4, s4, 10
    v_add_u32 v8, s4, v6
    v_add_u32 v5, s13, v6
    v_mov_b32 v3, 1
    v_mov_b32 v31, 145076
    s_waitcnt vmcnt(0)
    s_mov_b64 exec, 1
    ds_add_rtn_u32 v4, v31, v3
    s_mov_b64 exec, -1
    s_waitcnt lgkmcnt(0)
    v_readfirstlane_b32 s4, v4
    s_nop 1
    s_cmp_lg_u32 s4, 3
    s_cbranch_scc1 L_F1W
    v_mov_b32 v3, s78
    v_mov_b32 v4, 0
    s_mov_b64 exec, 1
    buffer_store_dword v3, v4, s[64:67], s59 offen sc1
    s_mov_b64 exec, -1
    ds_write_b32 v31, v10 offset:4
L_F1W:
    s_mov_b32 s4, 0
LW_13:
    ds_read_b32 v3, v31 offset:4
    s_waitcnt lgkmcnt(0)
    v_cmp_eq_u32 vcc, 0, v3
    s_add_u32 s4, s4, 1
    s_nop 0
    s_cbranch_vccz LWD_14
    s_sleep 1
    s_cmp_lt_u32 s4, 0x80000
    s_cbranch_scc1 LW_13
LWD_14:
    s_cmp_ge_u32 s73, 20
    s_cbranch_scc1 L_NOMB
    s_mul_i32 s5, s3, 5120
    s_add_u32 s5, s5, 123904
L_NOMB:
    buffer_load_dwordx4 v[20:23], v6, s[64:67], s30 offen offset:0 sc1
    buffer_load_dwordx4 v[24:27], v6, s[64:67], s30 offen offset:1024 sc1
    buffer_load_dwordx4 v[124:127], v6, s[64:67], s30 offen offset:2048 sc1
    buffer_load_dwordx4 v[128:131], v6, s[64:67], s30 offen offset:3072 sc1
    buffer_load_dwordx4 v[132:135], v9, s[64:67], s30 offen offset:0 sc1
    buffer_load_dwordx4 v[136:139], v6, s[64:67], s31 offen offset:0 sc1
    buffer_load_dwordx4 v[140:143], v6, s[64:67], s31 offen offset:1024 sc1
    buffer_load_dwordx4 v[144:147], v6, s[64:67], s31 offen offset:2048 sc1
    buffer_load_dwordx4 v[148:151], v6, s[64:67], s31 offen offset:3072 sc1
    buffer_load_dwordx4 v[152:155], v9, s[64:67], s31 offen offset:0 sc1
    buffer_load_dwordx4 v[156:159], v6, s[64:67], s32 offen offset:0 sc1
    buffer_load_dwordx4 v[160:163], v6, s[64:67], s32 offen offset:1024 sc1
    buffer_load_dwordx4 v[164:167], v6, s[64:67], s32 offen offset:2048 sc1
    buffer_load_dwordx4 v[168:171], v6, s[64:67], s32 offen offset:3072 sc1
    buffer_load_dwordx4 v[172:175], v9, s[64:67], s32 offen offset:0 sc1
    buffer_load_dword v4, v11, s[64:67], s14 offen sc1
    buffer_load_dwordx4 v[176:179], v6, s[64:67], s33 offen offset:0 sc1
    buffer_load_dwordx4 v[180:183], v6, s[64:67], s33 offen offset:1024 sc1
    buffer_load_dwordx4 v[184:187], v6, s[64:67], s33 offen offset:2048 sc1
    buffer_load_dwordx4 v[188:191], v6, s[64:67], s33 offen offset:3072 sc1
    buffer_load_dwordx4 v[192:195], v9, s[64:67], s33 offen offset:0 sc1
    s_mov_b32 s4, 0
LW_15:
    ds_read_b128 v[196:199], v31 offset:28
    s_waitcnt lgkmcnt(0)
    v_min_u32 v196, v196, v197
    v_min_u32 v196, v196, v198
    v_min_u32 v196, v196, v199
    v_cmp_eq_u32 vcc, 0, v196
    s_add_u32 s4, s4, 1
    s_nop 0
    s_cbranch_vccz LWD_16
    s_sleep 1
    s_cmp_lt_u32 s4, 0x80000
    s_cbranch_scc1 LW_15
LWD_16:
    s_waitcnt vmcnt(5)
    v_cmp_ne_u32 vcc, s78, v4
    s_nop 1
    s_cbranch_vccz PDONE_18
    s_mov_b32 s4, 0
POLL_17:
    buffer_load_dword v4, v11, s[64:67], s14 offen sc1
    s_waitcnt vmcnt(0)
    v_cmp_ne_u32 vcc, s78, v4
    s_add_u32 s4, s4, 1
    s_nop 0
    s_cbranch_vccz PDONE_18
    s_cmp_lt_u32 s4, 0x20000
    s_cbranch_scc1 POLL_17
PDONE_18:
    s_mul_i32 s4, s3, 5120
    s_add_u32 s4, s4, 123904
    v_add_u32 v31, s4, v6
    buffer_load_dwordx4 v[196:199], v0, s[64:67], s16 offen sc1
    buffer_load_dwordx4 v[200:203], v2, s[64:67], s16 offen sc1
    buffer_load_dwordx4 v[204:207], v7, s[64:67], s16 offen sc1
    buffer_load_dwordx4 v[208:211], v8, s[64:67], s16 offen sc1
    buffer_load_dwordx4 v[212:215], v0, s[64:67], s17 offen sc1
    buffer_load_dwordx4 v[216:219], v2, s[64:67], s17 offen sc1
    buffer_load_dwordx4 v[220:223], v7, s[64:67], s17 offen sc1
    buffer_load_dwordx4 v[224:227], v8, s[64:67], s17 offen sc1
    s_add_u32 m0, s13, 0
    s_nop 0
    buffer_load_dwordx4 v6, s[64:67], s37 offen offset:0 sc1 lds
    buffer_load_dwordx4 v6, s[64:67], s37 offen offset:1024 sc1 lds
    buffer_load_dwordx4 v6, s[64:67], s37 offen offset:2048 sc1 lds
    buffer_load_dwordx4 v6, s[64:67], s37 offen offset:3072 sc1 lds
    s_add_u32 m0, s13, 4096
    s_nop 0
    buffer_load_dwordx4 v9, s[64:67], s37 offen offset:0 sc1 lds
    s_add_u32 m0, s13, 5120
    s_nop 0
    buffer_load_dwordx4 v6, s[64:67], s38 offen offset:0 sc1 lds
    buffer_load_dwordx4 v6, s[64:67], s38 offen offset:1024 sc1 lds
    buffer_load_dwordx4 v6, s[64:67], s38 offen offset:2048 sc1 lds
    buffer_load_dwordx4 v6, s[64:67], s38 offen offset:3072 sc1 lds
    s_add_u32 m0, s13, 9216
    s_nop 0
    buffer_load_dwordx4 v9, s[64:67], s38 offen offset:0 sc1 lds
    s_mul_i32 s12, s80, 2560
    s_add_u32 s12, s12, 131072
    s_mul_i32 s4, s80, 327680
    s_lshl_b32 s5, s79, 2
    s_add_u32 s5, s5, s3
    s_lshl_b32 s5, s5, 7
    s_add_u32 s4, s4, s5
    s_add_u32 s52, s4, 19922944
    s_and_b32 s5, s80, 1
    s_xor_b32 s4, s5, 1
    s_lshl_b32 s6, s4, 18
    s_add_u32 s56, s52, s6
    s_lshl_b32 s6, s4, 7
    s_add_u32 s89, s88, s6
    s_lshl_b32 s6, s5, 16
    s_add_u32 s52, s52, s6
    s_lshl_b32 s6, s5, 5
    s_add_u32 s88, s88, s6
    s_add_u32 s53, s52, 65536
    s_add_u32 s54, s53, 65536
    s_add_u32 s55, s54, 65536
    s_mov_b32 s4, 0
LW_19:
    ds_read_b32 v3, v10 offset:16
    s_waitcnt lgkmcnt(0)
    v_cmp_eq_u32 vcc, 0, v3
    s_add_u32 s4, s4, 1
    s_nop 0
    s_cbranch_vccz LWD_20
    s_sleep 1
    s_cmp_lt_u32 s4, 0x80000
    s_cbranch_scc1 LW_19
LWD_20:
    s_waitcnt vmcnt(17)
    v_mfma_f32_16x16x32_bf16 v[44:47], v[12:15], v[196:199], 0
    v_mfma_f32_16x16x32_bf16 v[48:51], v[16:19], v[196:199], 0
    v_mfma_f32_16x16x32_bf16 v[52:55], v[32:35], v[196:199], 0
    v_mfma_f32_16x16x32_bf16 v[56:59], v[36:39], v[196:199], 0
    v_mfma_f32_16x16x32_bf16 v[60:63], v[40:43], v[196:199], 0
    s_waitcnt vmcnt(16)
    v_mfma_f32_16x16x32_bf16 v[80:83], v[40:43], v[200:203], 0
    buffer_load_dwordx4 v[196:199], v0, s[64:67], s18 offen sc1
    v_mfma_f32_16x16x32_bf16 v[76:79], v[36:39], v[200:203], 0
    v_mfma_f32_16x16x32_bf16 v[72:75], v[32:35], v[200:203], 0
    v_mfma_f32_16x16x32_bf16 v[68:71], v[16:19], v[200:203], 0
    v_mfma_f32_16x16x32_bf16 v[64:67], v[12:15], v[200:203], 0
    s_waitcnt vmcnt(16)
    v_mfma_f32_16x16x32_bf16 v[84:87], v[12:15], v[204:207], 0
    buffer_load_dwordx4 v[200:203], v2, s[64:67], s18 offen sc1
    v_mfma_f32_16x16x32_bf16 v[88:91], v[16:19], v[204:207], 0
    v_mfma_f32_16x16x32_bf16 v[92:95], v[32:35], v[204:207], 0
    v_mfma_f32_16x16x32_bf16 v[96:99], v[36:39], v[204:207], 0
    v_mfma_f32_16x16x32_bf16 v[100:103], v[40:43], v[204:207], 0
    s_waitcnt vmcnt(16)
    v_mfma_f32_16x16x32_bf16 v[120:123], v[40:43], v[208:211], 0
    buffer_load_dwordx4 v[204:207], v7, s[64:67], s18 offen sc1
    v_mfma_f32_16x16x32_bf16 v[116:119], v[36:39], v[208:211], 0
    v_mfma_f32_16x16x32_bf16 v[112:115], v[32:35], v[208:211], 0
    v_mfma_f32_16x16x32_bf16 v[108:111], v[16:19], v[208:211], 0
    v_mfma_f32_16x16x32_bf16 v[104:107], v[12:15], v[208:211], 0
    s_waitcnt vmcnt(16)
    v_mfma_f32_16x16x32_bf16 v[44:47], v[236:239], v[212:215], v[44:47]
    buffer_load_dwordx4 v[12:15], v8, s[64:67], s18 offen sc1
    v_mfma_f32_16x16x32_bf16 v[48:51], v[240:243], v[212:215], v[48:51]
    buffer_load_dwordx4 v[16:19], v0, s[64:67], s19 offen sc1
    v_mfma_f32_16x16x32_bf16 v[52:55], v[244:247], v[212:215], v[52:55]
    v_mfma_f32_16x16x32_bf16 v[56:59], v[248:251], v[212:215], v[56:59]
    v_mfma_f32_16x16x32_bf16 v[60:63], v[252:255], v[212:215], v[60:63]
    s_waitcnt vmcnt(17)
    v_mfma_f32_16x16x32_bf16 v[80:83], v[252:255], v[216:219], v[80:83]
    buffer_load_dwordx4 v[32:35], v2, s[64:67], s19 offen sc1
    v_mfma_f32_16x16x32_bf16 v[76:79], v[248:251], v[216:219], v[76:79]
    buffer_load_dwordx4 v[36:39], v7, s[64:67], s19 offen sc1
    v_mfma_f32_16x16x32_bf16 v[72:75], v[244:247], v[216:219], v[72:75]
    v_mfma_f32_16x16x32_bf16 v[68:71], v[240:243], v[216:219], v[68:71]
    v_mfma_f32_16x16x32_bf16 v[64:67], v[236:239], v[216:219], v[64:67]
    s_waitcnt vmcnt(18)
    v_mfma_f32_16x16x32_bf16 v[84:87], v[236:239], v[220:223], v[84:87]
    buffer_load_dwordx4 v[40:43], v8, s[64:67], s19 offen sc1
    v_mfma_f32_16x16x32_bf16 v[88:91], v[240:243], v[220:223], v[88:91]
    buffer_load_dwordx4 v[208:211], v0, s[64:67], s20 offen sc1
    v_mfma_f32_16x16x32_bf16 v[92:95], v[244:247], v[220:223], v[92:95]
    v_mfma_f32_16x16x32_bf16 v[96:99], v[248:251], v[220:223], v[96:99]
    v_mfma_f32_16x16x32_bf16 v[100:103], v[252:255], v[220:223], v[100:103]
    s_waitcnt vmcnt(19)
    v_mfma_f32_16x16x32_bf16 v[120:123], v[252:255], v[224:227], v[120:123]
    buffer_load_dwordx4 v[212:215], v2, s[64:67], s20 offen sc1
    v_mfma_f32_16x16x32_bf16 v[116:119], v[248:251], v[224:227], v[116:119]
    buffer_load_dwordx4 v[216:219], v7, s[64:67], s20 offen sc1
    v_mfma_f32_16x16x32_bf16 v[112:115], v[244:247], v[224:227], v[112:115]
    v_mfma_f32_16x16x32_bf16 v[108:111], v[240:243], v[224:227], v[108:111]
    v_mfma_f32_16x16x32_bf16 v[104:107], v[236:239], v[224:227], v[104:107]
    s_waitcnt vmcnt(10)
    v_mfma_f32_16x16x32_bf16 v[44:47], v[20:23], v[196:199], v[44:47]
    buffer_load_dwordx4 v[220:223], v8, s[64:67], s20 offen sc1
    v_mfma_f32_16x16x32_bf16 v[48:51], v[24:27], v[196:199], v[48:51]
    v_mfma_f32_16x16x32_bf16 v[52:55], v[124:127], v[196:199], v[52:55]
    v_mfma_f32_16x16x32_bf16 v[56:59], v[128:131], v[196:199], v[56:59]
    v_mfma_f32_16x16x32_bf16 v[60:63], v[132:135], v[196:199], v[60:63]
    s_waitcnt vmcnt(10)
    v_mfma_f32_16x16x32_bf16 v[80:83], v[132:135], v[200:203], v[80:83]
    buffer_load_dwordx4 v[196:199], v0, s[64:67], s21 offen sc1
    v_mfma_f32_16x16x32_bf16 v[76:79], v[128:131], v[200:203], v[76:79]
    buffer_load_dwordx4 v[224:227], v6, s[64:67], s39 offen offset:0 sc1
    v_mfma_f32_16x16x32_bf16 v[72:75], v[124:127], v[200:203], v[72:75]
    v_mfma_f32_16x16x32_bf16 v[68:71], v[24:27], v[200:203], v[68:71]
    v_mfma_f32_16x16x32_bf16 v[64:67], v[20:23], v[200:203], v[64:67]
    s_waitcnt vmcnt(11)
    v_mfma_f32_16x16x32_bf16 v[84:87], v[20:23], v[204:207], v[84:87]
    buffer_load_dwordx4 v[200:203], v2, s[64:67], s21 offen sc1
    v_mfma_f32_16x16x32_bf16 v[88:91], v[24:27], v[204:207], v[88:91]
    v_mfma_f32_16x16x32_bf16 v[92:95], v[124:127], v[204:207], v[92:95]
    v_mfma_f32_16x16x32_bf16 v[96:99], v[128:131], v[204:207], v[96:99]
    v_mfma_f32_16x16x32_bf16 v[100:103], v[132:135], v[204:207], v[100:103]
    s_waitcnt vmcnt(11)
    v_mfma_f32_16x16x32_bf16 v[120:123], v[132:135], v[12:15], v[120:123]
    buffer_load_dwordx4 v[204:207], v7, s[64:67], s21 offen sc1
    v_mfma_f32_16x16x32_bf16 v[116:119], v[128:131], v[12:15], v[116:119]
    v_mfma_f32_16x16x32_bf16 v[112:115], v[124:127], v[12:15], v[112:115]
    v_mfma_f32_16x16x32_bf16 v[108:111], v[24:27], v[12:15], v[108:111]
    v_mfma_f32_16x16x32_bf16 v[104:107], v[20:23], v[12:15], v[104:107]
    s_waitcnt vmcnt(11)
    v_mfma_f32_16x16x32_bf16 v[44:47], v[136:139], v[16:19], v[44:47]
    buffer_load_dwordx4 v[12:15], v8, s[64:67], s21 offen sc1
    v_mfma_f32_16x16x32_bf16 v[48:51], v[140:143], v[16:19], v[48:51]
    buffer_load_dwordx4 v[20:23], v6, s[64:67], s39 offen offset:1024 sc1
    v_mfma_f32_16x16x32_bf16 v[52:55], v[144:147], v[16:19], v[52:55]
    v_mfma_f32_16x16x32_bf16 v[56:59], v[148:151], v[16:19], v[56:59]
    v_mfma_f32_16x16x32_bf16 v[60:63], v[152:155], v[16:19], v[60:63]
    s_waitcnt vmcnt(12)
    v_mfma_f32_16x16x32_bf16 v[80:83], v[152:155], v[32:35], v[80:83]
    buffer_load_dwordx4 v[16:19], v0, s[64:67], s22 offen sc1
    v_mfma_f32_16x16x32_bf16 v[76:79], v[148:151], v[32:35], v[76:79]
    v_mfma_f32_16x16x32_bf16 v[72:75], v[144:147], v[32:35], v[72:75]
    v_mfma_f32_16x16x32_bf16 v[68:71], v[140:143], v[32:35], v[68:71]
    v_mfma_f32_16x16x32_bf16 v[64:67], v[136:139], v[32:35], v[64:67]
    s_waitcnt vmcnt(12)
    v_mfma_f32_16x16x32_bf16 v[84:87], v[136:139], v[36:39], v[84:87]
    buffer_load_dwordx4 v[24:27], v2, s[64:67], s22 offen sc1
    v_mfma_f32_16x16x32_bf16 v[88:91], v[140:143], v[36:39], v[88:91]
    v_mfma_f32_16x16x32_bf16 v[92:95], v[144:147], v[36:39], v[92:95]
    v_mfma_f32_16x16x32_bf16 v[96:99], v[148:151], v[36:39], v[96:99]
    v_mfma_f32_16x16x32_bf16 v[100:103], v[152:155], v[36:39], v[100:103]
    s_waitcnt vmcnt(12)
    v_mfma_f32_16x16x32_bf16 v[120:123], v[152:155], v[40:43], v[120:123]
    buffer_load_dwordx4 v[232:235], v7, s[64:67], s22 offen sc1
    v_mfma_f32_16x16x32_bf16 v[116:119], v[148:151], v[40:43], v[116:119]
    buffer_load_dwordx4 v[236:239], v6, s[64:67], s39 offen offset:2048 sc1
    v_mfma_f32_16x16x32_bf16 v[112:115], v[144:147], v[40:43], v[112:115]
    s_mul_i32 s7, s3, 5120
    v_mfma_f32_16x16x32_bf16 v[108:111], v[140:143], v[40:43], v[108:111]
    s_add_u32 s7, s7, 123904
    v_mfma_f32_16x16x32_bf16 v[104:107], v[136:139], v[40:43], v[104:107]
    v_lshrrev_b32 v3, 2, v1
    s_waitcnt vmcnt(13)
    v_mfma_f32_16x16x32_bf16 v[44:47], v[156:159], v[208:211], v[44:47]
    buffer_load_dwordx4 v[40:43], v8, s[64:67], s22 offen sc1
    v_mfma_f32_16x16x32_bf16 v[48:51], v[160:163], v[208:211], v[48:51]
    v_mul_u32_u24 v11, 1280, v3
    v_mfma_f32_16x16x32_bf16 v[52:55], v[164:167], v[208:211], v[52:55]
    v_and_b32 v3, 3, v1
    v_mfma_f32_16x16x32_bf16 v[56:59], v[168:171], v[208:211], v[56:59]
    v_lshl_add_u32 v11, v3, 4, v11
    v_mfma_f32_16x16x32_bf16 v[60:63], v[172:175], v[208:211], v[60:63]
    v_lshrrev_b32 v3, 2, v1
    s_waitcnt vmcnt(13)
    v_mfma_f32_16x16x32_bf16 v[80:83], v[172:175], v[212:215], v[80:83]
    buffer_load_dwordx4 v[134:137], v0, s[64:67], s23 offen sc1
    v_mfma_f32_16x16x32_bf16 v[76:79], v[168:171], v[212:215], v[76:79]
    v_mul_u32_u24 v30, 80, v3
    v_mfma_f32_16x16x32_bf16 v[72:75], v[164:167], v[212:215], v[72:75]
    v_and_b32 v3, 3, v1
    v_mfma_f32_16x16x32_bf16 v[68:71], v[160:163], v[212:215], v[68:71]
    v_lshl_add_u32 v30, v3, 4, v30
    v_mfma_f32_16x16x32_bf16 v[64:67], v[156:159], v[212:215], v[64:67]
    v_add_u32 v30, s7, v30
    s_waitcnt vmcnt(13)
    v_mfma_f32_16x16x32_bf16 v[84:87], v[156:159], v[216:219], v[84:87]
    buffer_load_dwordx4 v[138:141], v2, s[64:67], s23 offen sc1
    v_mfma_f32_16x16x32_bf16 v[88:91], v[160:163], v[216:219], v[88:91]
    buffer_load_dwordx4 v[142:145], v6, s[64:67], s39 offen offset:3072 sc1
    v_mfma_f32_16x16x32_bf16 v[92:95], v[164:167], v[216:219], v[92:95]
    v_bfe_u32 v3, v1, 1, 4
    v_mfma_f32_16x16x32_bf16 v[96:99], v[168:171], v[216:219], v[96:99]
    v_mul_u32_u24 v29, 1280, v3
    v_mfma_f32_16x16x32_bf16 v[100:103], v[172:175], v[216:219], v[100:103]
    v_and_b32 v3, 1, v1
    s_waitcnt vmcnt(14)
    v_mfma_f32_16x16x32_bf16 v[120:123], v[172:175], v[220:223], v[120:123]
    buffer_load_dwordx4 v[146:149], v7, s[64:67], s23 offen sc1
    v_mfma_f32_16x16x32_bf16 v[116:119], v[168:171], v[220:223], v[116:119]
    v_lshl_add_u32 v29, v3, 4, v29
    v_mfma_f32_16x16x32_bf16 v[112:115], v[164:167], v[220:223], v[112:115]
    v_bfe_u32 v3, v1, 1, 4
    v_mfma_f32_16x16x32_bf16 v[108:111], v[160:163], v[220:223], v[108:111]
    v_mul_u32_u24 v28, 80, v3
    v_mfma_f32_16x16x32_bf16 v[104:107], v[156:159], v[220:223], v[104:107]
    v_and_b32 v3, 1, v1
    s_waitcnt vmcnt(14)
    v_mfma_f32_16x16x32_bf16 v[44:47], v[176:179], v[196:199], v[44:47]
    buffer_load_dwordx4 v[150:153], v8, s[64:67], s23 offen sc1
    v_mfma_f32_16x16x32_bf16 v[48:51], v[180:183], v[196:199], v[48:51]
    ds_read_b128 v[154:157], v31 offset:0
    v_mfma_f32_16x16x32_bf16 v[52:55], v[184:187], v[196:199], v[52:55]
    ds_read_b128 v[158:161], v31 offset:1024
    v_mfma_f32_16x16x32_bf16 v[56:59], v[188:191], v[196:199], v[56:59]
    ds_read_b128 v[162:165], v31 offset:2048
    v_mfma_f32_16x16x32_bf16 v[60:63], v[192:195], v[196:199], v[60:63]
    ds_read_b128 v[166:169], v31 offset:3072
    s_waitcnt vmcnt(13)
    v_mfma_f32_16x16x32_bf16 v[80:83], v[192:195], v[200:203], v[80:83]
    buffer_load_dwordx4 v[170:173], v0, s[64:67], s24 offen sc1
    v_mfma_f32_16x16x32_bf16 v[76:79], v[188:191], v[200:203], v[76:79]
    buffer_load_dwordx4 v[196:199], v9, s[64:67], s39 offen offset:0 sc1
    v_mfma_f32_16x16x32_bf16 v[72:75], v[184:187], v[200:203], v[72:75]
    ds_read_b128 v[208:211], v31 offset:4096
    v_mfma_f32_16x16x32_bf16 v[68:71], v[180:183], v[200:203], v[68:71]
    v_lshl_add_u32 v28, v3, 4, v28
    v_mfma_f32_16x16x32_bf16 v[64:67], v[176:179], v[200:203], v[64:67]
    v_add_u32 v28, s7, v28
    s_waitcnt vmcnt(14)
    v_mfma_f32_16x16x32_bf16 v[84:87], v[176:179], v[204:207], v[84:87]
    buffer_load_dwordx4 v[200:203], v2, s[64:67], s24 offen sc1
    v_mfma_f32_16x16x32_bf16 v[88:91], v[180:183], v[204:207], v[88:91]
    v_and_b32 v3, 15, v1
    v_mfma_f32_16x16x32_bf16 v[92:95], v[184:187], v[204:207], v[92:95]
    v_lshrrev_b32 v37, 4, v1
    v_mfma_f32_16x16x32_bf16 v[96:99], v[188:191], v[204:207], v[96:99]
    v_mul_u32_u24 v39, 80, v3
    v_mfma_f32_16x16x32_bf16 v[100:103], v[192:195], v[204:207], v[100:103]
    v_lshl_add_u32 v39, v37, 3, v39
    s_waitcnt vmcnt(14)
    v_mfma_f32_16x16x32_bf16 v[120:123], v[192:195], v[12:15], v[120:123]
    buffer_load_dwordx4 v[204:207], v7, s[64:67], s24 offen sc1
    v_mfma_f32_16x16x32_bf16 v[116:119], v[188:191], v[12:15], v[116:119]
    v_add_u32 v39, s7, v39
    v_mfma_f32_16x16x32_bf16 v[112:115], v[184:187], v[12:15], v[112:115]
    v_lshlrev_b32 v38, 14, v37
    v_mfma_f32_16x16x32_bf16 v[108:111], v[180:183], v[12:15], v[108:111]
    v_lshl_add_u32 v38, v3, 3, v38
    v_mfma_f32_16x16x32_bf16 v[104:107], v[176:179], v[12:15], v[104:107]
    v_min_u32 v37, 19, v1
    s_waitcnt vmcnt(13) lgkmcnt(4)
    v_mfma_f32_16x16x32_bf16 v[44:47], v[154:157], v[16:19], v[44:47]
    buffer_load_dwordx4 v[12:15], v8, s[64:67], s24 offen sc1
    s_waitcnt lgkmcnt(3)
    v_mfma_f32_16x16x32_bf16 v[48:51], v[158:161], v[16:19], v[48:51]
    ds_read_b128 v[174:177], v5 offset:40960
    s_waitcnt lgkmcnt(3)
    v_mfma_f32_16x16x32_bf16 v[52:55], v[162:165], v[16:19], v[52:55]
    ds_read_b128 v[178:181], v5 offset:41984
    s_waitcnt lgkmcnt(3)
    v_mfma_f32_16x16x32_bf16 v[56:59], v[166:169], v[16:19], v[56:59]
    ds_read_b128 v[182:185], v5 offset:43008
    s_waitcnt lgkmcnt(3)
    v_mfma_f32_16x16x32_bf16 v[60:63], v[208:211], v[16:19], v[60:63]
    ds_read_b128 v[186:189], v5 offset:44032
    s_waitcnt vmcnt(13)
    v_mfma_f32_16x16x32_bf16 v[80:83], v[208:211], v[24:27], v[80:83]
    buffer_load_dwordx4 v[16:19], v0, s[64:67], s25 offen sc1
    v_mfma_f32_16x16x32_bf16 v[76:79], v[166:169], v[24:27], v[76:79]
    ds_read_b128 v[190:193], v5 offset:45056
    v_mfma_f32_16x16x32_bf16 v[72:75], v[162:165], v[24:27], v[72:75]
    v_lshlrev_b32 v37, 7, v37
    v_mfma_f32_16x16x32_bf16 v[68:71], v[158:161], v[24:27], v[68:71]
    s_sub_u32 s7, s3, 1
    v_mfma_f32_16x16x32_bf16 v[64:67], v[154:157], v[24:27], v[64:67]
    s_and_b32 s7, s7, 3
    s_waitcnt vmcnt(13)
    v_mfma_f32_16x16x32_bf16 v[84:87], v[154:157], v[232:235], v[84:87]
    buffer_load_dwordx4 v[24:27], v0, s[64:67], s26 offen sc1
    v_mfma_f32_16x16x32_bf16 v[88:91], v[158:161], v[232:235], v[88:91]
    s_mul_i32 s7, s7, 10240
    v_mfma_f32_16x16x32_bf16 v[92:95], v[162:165], v[232:235], v[92:95]
    v_add_u32 v36, s7, v6
    v_mfma_f32_16x16x32_bf16 v[96:99], v[166:169], v[232:235], v[96:99]
    s_sub_u32 s7, s3, 2
    v_mfma_f32_16x16x32_bf16 v[100:103], v[208:211], v[232:235], v[100:103]
    s_and_b32 s7, s7, 3
    s_waitcnt vmcnt(12)
    v_mfma_f32_16x16x32_bf16 v[120:123], v[208:211], v[40:43], v[120:123]
    buffer_load_dwordx4 v[212:215], v0, s[64:67], s27 offen sc1
    v_mfma_f32_16x16x32_bf16 v[116:119], v[166:169], v[40:43], v[116:119]
    s_mul_i32 s7, s7, 10240
    v_mfma_f32_16x16x32_bf16 v[112:115], v[162:165], v[40:43], v[112:115]
    v_add_u32 v35, s7, v6
    v_mfma_f32_16x16x32_bf16 v[108:111], v[158:161], v[40:43], v[108:111]
    s_sub_u32 s7, s3, 3
    v_mfma_f32_16x16x32_bf16 v[104:107], v[154:157], v[40:43], v[104:107]
    s_and_b32 s7, s7, 3
    s_waitcnt vmcnt(12) lgkmcnt(4)
    v_mfma_f32_16x16x32_bf16 v[44:47], v[174:177], v[134:137], v[44:47]
    buffer_load_dwordx4 v[40:43], v2, s[64:67], s25 offen sc1
    s_waitcnt lgkmcnt(3)
    v_mfma_f32_16x16x32_bf16 v[48:51], v[178:181], v[134:137], v[48:51]
    ds_read_b128 v[154:157], v5 offset:46080
    s_waitcnt lgkmcnt(3)
    v_mfma_f32_16x16x32_bf16 v[52:55], v[182:185], v[134:137], v[52:55]
    ds_read_b128 v[158:161], v5 offset:47104
    s_waitcnt lgkmcnt(3)
    v_mfma_f32_16x16x32_bf16 v[56:59], v[186:189], v[134:137], v[56:59]
    ds_read_b128 v[162:165], v5 offset:48128
    s_waitcnt lgkmcnt(3)
    v_mfma_f32_16x16x32_bf16 v[60:63], v[190:193], v[134:137], v[60:63]
    ds_read_b128 v[166:169], v5 offset:49152
    s_waitcnt vmcnt(12)
    v_mfma_f32_16x16x32_bf16 v[80:83], v[190:193], v[138:141], v[80:83]
    buffer_load_dwordx4 v[134:137], v2, s[64:67], s26 offen sc1
    v_mfma_f32_16x16x32_bf16 v[76:79], v[186:189], v[138:141], v[76:79]
    ds_read_b128 v[208:211], v5 offset:50176
    v_mfma_f32_16x16x32_bf16 v[72:75], v[182:185], v[138:141], v[72:75]
    s_mul_i32 s7, s7, 10240
    v_mfma_f32_16x16x32_bf16 v[68:71], v[178:181], v[138:141], v[68:71]
    v_add_u32 v34, s7, v6
    v_mfma_f32_16x16x32_bf16 v[64:67], v[174:177], v[138:141], v[64:67]
    s_sub_u32 s7, s3, 4
    s_waitcnt vmcnt(11)
    v_mfma_f32_16x16x32_bf16 v[84:87], v[174:177], v[146:149], v[84:87]
    buffer_load_dwordx4 v[138:141], v2, s[64:67], s27 offen sc1
    v_mfma_f32_16x16x32_bf16 v[88:91], v[178:181], v[146:149], v[88:91]
    s_and_b32 s7, s7, 3
    v_mfma_f32_16x16x32_bf16 v[92:95], v[182:185], v[146:149], v[92:95]
    s_mul_i32 s7, s7, 10240
    v_mfma_f32_16x16x32_bf16 v[96:99], v[186:189], v[146:149], v[96:99]
    v_add_u32 v33, s7, v6
    v_mfma_f32_16x16x32_bf16 v[100:103], v[190:193], v[146:149], v[100:103]
    v_mov_b32 v124, 0xbfb8aa3b
    s_waitcnt vmcnt(11)
    v_mfma_f32_16x16x32_bf16 v[120:123], v[190:193], v[150:153], v[120:123]
    buffer_load_dwordx4 v[146:149], v7, s[64:67], s25 offen sc1
    v_mfma_f32_16x16x32_bf16 v[116:119], v[186:189], v[150:153], v[116:119]
    v_mfma_f32_16x16x32_bf16 v[112:115], v[182:185], v[150:153], v[112:115]
    v_mfma_f32_16x16x32_bf16 v[108:111], v[178:181], v[150:153], v[108:111]
    v_mfma_f32_16x16x32_bf16 v[104:107], v[174:177], v[150:153], v[104:107]
    s_waitcnt vmcnt(11) lgkmcnt(4)
    v_mfma_f32_16x16x32_bf16 v[44:47], v[154:157], v[170:173], v[44:47]
    buffer_load_dwordx4 v[150:153], v7, s[64:67], s26 offen sc1
    s_waitcnt lgkmcnt(3)
    v_mfma_f32_16x16x32_bf16 v[48:51], v[158:161], v[170:173], v[48:51]
    ds_read_b128 v[174:177], v5 offset:0
    s_waitcnt lgkmcnt(3)
    v_mfma_f32_16x16x32_bf16 v[52:55], v[162:165], v[170:173], v[52:55]
    ds_read_b128 v[178:181], v5 offset:1024
    s_waitcnt lgkmcnt(3)
    v_mfma_f32_16x16x32_bf16 v[56:59], v[166:169], v[170:173], v[56:59]
    ds_read_b128 v[182:185], v5 offset:2048
    s_waitcnt lgkmcnt(3)
    v_mfma_f32_16x16x32_bf16 v[60:63], v[208:211], v[170:173], v[60:63]
    ds_read_b128 v[186:189], v5 offset:3072
    s_waitcnt vmcnt(10)
    v_mfma_f32_16x16x32_bf16 v[80:83], v[208:211], v[200:203], v[80:83]
    buffer_load_dwordx4 v[170:173], v7, s[64:67], s27 offen sc1
    v_mfma_f32_16x16x32_bf16 v[76:79], v[166:169], v[200:203], v[76:79]
    ds_read_b128 v[190:193], v5 offset:4096
    v_mfma_f32_16x16x32_bf16 v[72:75], v[162:165], v[200:203], v[72:75]
    ds_read_b128 v[216:219], v5 offset:5120
    v_mfma_f32_16x16x32_bf16 v[68:71], v[158:161], v[200:203], v[68:71]
    ds_read_b128 v[220:223], v5 offset:6144
    v_mfma_f32_16x16x32_bf16 v[64:67], v[154:157], v[200:203], v[64:67]
    ds_read_b128 v[232:235], v5 offset:7168
    s_waitcnt vmcnt(10)
    v_mfma_f32_16x16x32_bf16 v[84:87], v[154:157], v[204:207], v[84:87]
    buffer_load_dwordx4 v[200:203], v8, s[64:67], s25 offen sc1
    v_mfma_f32_16x16x32_bf16 v[88:91], v[158:161], v[204:207], v[88:91]
    ds_read_b128 v[240:243], v5 offset:8192
    v_mfma_f32_16x16x32_bf16 v[92:95], v[162:165], v[204:207], v[92:95]
    ds_read_b128 v[244:247], v5 offset:9216
    v_mfma_f32_16x16x32_bf16 v[96:99], v[166:169], v[204:207], v[96:99]
    v_mfma_f32_16x16x32_bf16 v[100:103], v[208:211], v[204:207], v[100:103]
    s_waitcnt vmcnt(10)
    v_mfma_f32_16x16x32_bf16 v[120:123], v[208:211], v[12:15], v[120:123]
    buffer_load_dwordx4 v[204:207], v8, s[64:67], s26 offen sc1
    v_mfma_f32_16x16x32_bf16 v[116:119], v[166:169], v[12:15], v[116:119]
    v_mfma_f32_16x16x32_bf16 v[112:115], v[162:165], v[12:15], v[112:115]
    v_mfma_f32_16x16x32_bf16 v[108:111], v[158:161], v[12:15], v[108:111]
    v_mfma_f32_16x16x32_bf16 v[104:107], v[154:157], v[12:15], v[104:107]
    s_waitcnt vmcnt(10) lgkmcnt(9)
    v_mfma_f32_16x16x32_bf16 v[44:47], v[174:177], v[16:19], v[44:47]
    buffer_load_dwordx4 v[12:15], v8, s[64:67], s27 offen sc1
    s_waitcnt lgkmcnt(8)
    v_mfma_f32_16x16x32_bf16 v[48:51], v[178:181], v[16:19], v[48:51]
    buffer_load_dwordx4 v[126:129], v29, s[48:51], s89 offen offset:0
    s_waitcnt lgkmcnt(7)
    v_mfma_f32_16x16x32_bf16 v[52:55], v[182:185], v[16:19], v[52:55]
    buffer_load_dwordx4 v[130:133], v11, s[48:51], s88 offen offset:0
    s_waitcnt lgkmcnt(6)
    v_mfma_f32_16x16x32_bf16 v[56:59], v[186:189], v[16:19], v[56:59]
    buffer_load_dwordx4 v[228:231], v11, s[48:51], s88 offen offset:64
    s_waitcnt lgkmcnt(5)
    v_mfma_f32_16x16x32_bf16 v[60:63], v[190:193], v[16:19], v[60:63]
    s_waitcnt vmcnt(13) lgkmcnt(4)
    v_mfma_f32_16x16x32_bf16 v[44:47], v[216:219], v[24:27], v[44:47]
    s_waitcnt lgkmcnt(3)
    v_mfma_f32_16x16x32_bf16 v[48:51], v[220:223], v[24:27], v[48:51]
    s_waitcnt lgkmcnt(2)
    v_mfma_f32_16x16x32_bf16 v[52:55], v[232:235], v[24:27], v[52:55]
    s_waitcnt lgkmcnt(1)
    v_mfma_f32_16x16x32_bf16 v[56:59], v[240:243], v[24:27], v[56:59]
    s_waitcnt lgkmcnt(0)
    v_mfma_f32_16x16x32_bf16 v[60:63], v[244:247], v[24:27], v[60:63]
    s_waitcnt vmcnt(12)
    v_mfma_f32_16x16x32_bf16 v[44:47], v[224:227], v[212:215], v[44:47]
    v_mfma_f32_16x16x32_bf16 v[48:51], v[20:23], v[212:215], v[48:51]
    v_mfma_f32_16x16x32_bf16 v[52:55], v[236:239], v[212:215], v[52:55]
    v_mfma_f32_16x16x32_bf16 v[56:59], v[142:145], v[212:215], v[56:59]
    v_mfma_f32_16x16x32_bf16 v[60:63], v[196:199], v[212:215], v[60:63]
    s_waitcnt vmcnt(11)
    v_mfma_f32_16x16x32_bf16 v[64:67], v[174:177], v[40:43], v[64:67]
    v_mfma_f32_16x16x32_bf16 v[68:71], v[178:181], v[40:43], v[68:71]
    v_mfma_f32_16x16x32_bf16 v[72:75], v[182:185], v[40:43], v[72:75]
    v_mfma_f32_16x16x32_bf16 v[76:79], v[186:189], v[40:43], v[76:79]
    v_mfma_f32_16x16x32_bf16 v[80:83], v[190:193], v[40:43], v[80:83]
    ds_write_b128 v5, v[44:47] offset:0
    s_waitcnt vmcnt(10)
    v_mfma_f32_16x16x32_bf16 v[64:67], v[216:219], v[134:137], v[64:67]
    v_mfma_f32_16x16x32_bf16 v[68:71], v[220:223], v[134:137], v[68:71]
    ds_write_b128 v5, v[48:51] offset:1024
    v_mfma_f32_16x16x32_bf16 v[72:75], v[232:235], v[134:137], v[72:75]
    v_mfma_f32_16x16x32_bf16 v[76:79], v[240:243], v[134:137], v[76:79]
    ds_write_b128 v5, v[52:55] offset:2048
    v_mfma_f32_16x16x32_bf16 v[80:83], v[244:247], v[134:137], v[80:83]
    s_waitcnt vmcnt(9)
    v_mfma_f32_16x16x32_bf16 v[64:67], v[224:227], v[138:141], v[64:67]
    ds_write_b128 v5, v[56:59] offset:3072
    v_mfma_f32_16x16x32_bf16 v[68:71], v[20:23], v[138:141], v[68:71]
    v_mfma_f32_16x16x32_bf16 v[72:75], v[236:239], v[138:141], v[72:75]
    ds_write_b128 v5, v[60:63] offset:4096
    v_mfma_f32_16x16x32_bf16 v[76:79], v[142:145], v[138:141], v[76:79]
    v_mfma_f32_16x16x32_bf16 v[80:83], v[196:199], v[138:141], v[80:83]
    s_waitcnt vmcnt(8)
    v_mfma_f32_16x16x32_bf16 v[84:87], v[174:177], v[146:149], v[84:87]
    buffer_load_dword v4, v37, s[64:67], s12 offen sc1
    v_mfma_f32_16x16x32_bf16 v[88:91], v[178:181], v[146:149], v[88:91]
    v_mfma_f32_16x16x32_bf16 v[92:95], v[182:185], v[146:149], v[92:95]
    v_mfma_f32_16x16x32_bf16 v[96:99], v[186:189], v[146:149], v[96:99]
    v_mfma_f32_16x16x32_bf16 v[100:103], v[190:193], v[146:149], v[100:103]
    ds_write_b128 v5, v[64:67] offset:5120
    s_waitcnt vmcnt(8)
    v_mfma_f32_16x16x32_bf16 v[84:87], v[216:219], v[150:153], v[84:87]
    s_waitcnt vmcnt(3)
    v_lshlrev_b32 v134, 16, v126
    v_mfma_f32_16x16x32_bf16 v[88:91], v[220:223], v[150:153], v[88:91]
    ds_write_b128 v5, v[68:71] offset:6144
    v_and_b32 v135, 0xffff0000, v126
    v_mfma_f32_16x16x32_bf16 v[92:95], v[232:235], v[150:153], v[92:95]
    v_lshlrev_b32 v136, 16, v127
    v_mfma_f32_16x16x32_bf16 v[96:99], v[240:243], v[150:153], v[96:99]
    ds_write_b128 v5, v[72:75] offset:7168
    v_and_b32 v137, 0xffff0000, v127
    v_mfma_f32_16x16x32_bf16 v[100:103], v[244:247], v[150:153], v[100:103]
    v_lshlrev_b32 v138, 16, v128
    v_mfma_f32_16x16x32_bf16 v[84:87], v[224:227], v[170:173], v[84:87]
    ds_write_b128 v5, v[76:79] offset:8192
    v_and_b32 v139, 0xffff0000, v128
    v_mfma_f32_16x16x32_bf16 v[88:91], v[20:23], v[170:173], v[88:91]
    v_lshlrev_b32 v140, 16, v129
    v_mfma_f32_16x16x32_bf16 v[92:95], v[236:239], v[170:173], v[92:95]
    ds_write_b128 v5, v[80:83] offset:9216
    v_and_b32 v141, 0xffff0000, v129
    v_mfma_f32_16x16x32_bf16 v[96:99], v[142:145], v[170:173], v[96:99]
    s_waitcnt vmcnt(2)
    v_lshlrev_b32 v154, 16, v130
    v_mfma_f32_16x16x32_bf16 v[100:103], v[196:199], v[170:173], v[100:103]
    v_and_b32 v155, 0xffff0000, v130
    v_mfma_f32_16x16x32_bf16 v[104:107], v[174:177], v[200:203], v[104:107]
    v_lshlrev_b32 v156, 16, v131
    v_mfma_f32_16x16x32_bf16 v[108:111], v[178:181], v[200:203], v[108:111]
    v_and_b32 v157, 0xffff0000, v131
    v_mfma_f32_16x16x32_bf16 v[112:115], v[182:185], v[200:203], v[112:115]
    v_lshlrev_b32 v158, 16, v132
    v_mfma_f32_16x16x32_bf16 v[116:119], v[186:189], v[200:203], v[116:119]
    v_and_b32 v159, 0xffff0000, v132
    v_mfma_f32_16x16x32_bf16 v[120:123], v[190:193], v[200:203], v[120:123]
    ds_write_b128 v5, v[84:87] offset:40960
    v_lshlrev_b32 v160, 16, v133
    v_mfma_f32_16x16x32_bf16 v[104:107], v[216:219], v[204:207], v[104:107]
    s_waitcnt vmcnt(0)
    v_cmp_ne_u32 s[10:11], s78, v4
    v_and_b32 v161, 0xffff0000, v133
    v_mfma_f32_16x16x32_bf16 v[108:111], v[220:223], v[204:207], v[108:111]
    s_cmp_eq_u64 s[10:11], 0
    s_cselect_b32 s4, 0, 0x70000000
    v_lshlrev_b32 v162, 16, v228
    v_mfma_f32_16x16x32_bf16 v[112:115], v[232:235], v[204:207], v[112:115]
    v_add_u32 v3, s4, v38
    v_and_b32 v163, 0xffff0000, v228
    v_mfma_f32_16x16x32_bf16 v[116:119], v[240:243], v[204:207], v[116:119]
    buffer_load_dwordx2 v[16:17], v3, s[64:67], s56 offen sc1
    v_lshlrev_b32 v164, 16, v229
    v_mfma_f32_16x16x32_bf16 v[120:123], v[244:247], v[204:207], v[120:123]
    buffer_load_dwordx2 v[18:19], v3, s[64:67], s52 offen sc1
    v_and_b32 v165, 0xffff0000, v229
    v_mfma_f32_16x16x32_bf16 v[104:107], v[224:227], v[12:15], v[104:107]
    buffer_load_dwordx2 v[24:25], v3, s[64:67], s53 offen sc1
    v_lshlrev_b32 v166, 16, v230
    v_mfma_f32_16x16x32_bf16 v[108:111], v[20:23], v[12:15], v[108:111]
    buffer_load_dwordx2 v[26:27], v3, s[64:67], s54 offen sc1
    v_and_b32 v167, 0xffff0000, v230
    v_mfma_f32_16x16x32_bf16 v[112:115], v[236:239], v[12:15], v[112:115]
    buffer_load_dwordx2 v[40:41], v3, s[64:67], s55 offen sc1
    v_lshlrev_b32 v168, 16, v231
    v_mfma_f32_16x16x32_bf16 v[116:119], v[142:145], v[12:15], v[116:119]
    v_and_b32 v169, 0xffff0000, v231
    v_mfma_f32_16x16x32_bf16 v[120:123], v[196:199], v[12:15], v[120:123]
    ds_write_b128 v5, v[88:91] offset:41984
    ds_write_b128 v5, v[92:95] offset:43008
    ds_write_b128 v5, v[96:99] offset:44032
    ds_write_b128 v5, v[100:103] offset:45056
    s_cmp_eq_u64 s[10:11], 0
    s_cbranch_scc1 L_SOK
    s_mov_b32 s4, 0
POLL_21:
    buffer_load_dword v4, v37, s[64:67], s12 offen sc1
    s_waitcnt vmcnt(0)
    v_cmp_ne_u32 vcc, s78, v4
    s_add_u32 s4, s4, 1
    s_nop 0
    s_cbranch_vccz PDONE_22
    s_cmp_lt_u32 s4, 0x20000
    s_cbranch_scc1 POLL_21
PDONE_22:
    buffer_load_dwordx2 v[16:17], v38, s[64:67], s56 offen sc1
    buffer_load_dwordx2 v[18:19], v38, s[64:67], s52 offen sc1
    buffer_load_dwordx2 v[24:25], v38, s[64:67], s53 offen sc1
    buffer_load_dwordx2 v[26:27], v38, s[64:67], s54 offen sc1
    buffer_load_dwordx2 v[40:41], v38, s[64:67], s55 offen sc1
L_SOK:
    s_waitcnt lgkmcnt(0)
    s_barrier
    ds_read_b128 v[42:45], v36 offset:4096
    ds_read_b128 v[46:49], v35 offset:9216
    ds_read_b128 v[50:53], v34 offset:45056
    ds_read_b128 v[54:57], v36 offset:0
    ds_read_b128 v[58:61], v35 offset:5120
    ds_read_b128 v[62:65], v34 offset:40960
    ds_read_b128 v[66:69], v36 offset:1024
    ds_read_b128 v[70:73], v35 offset:6144
    ds_read_b128 v[74:77], v34 offset:41984
    ds_read_b128 v[78:81], v36 offset:2048
    ds_read_b128 v[82:85], v35 offset:7168
    ds_read_b128 v[86:89], v34 offset:43008
    ds_read_b128 v[90:93], v36 offset:3072
    ds_read_b128 v[94:97], v35 offset:8192
    ds_read_b128 v[98:101], v34 offset:44032
.p2align 3
    s_waitcnt lgkmcnt(14)
    v_pk_add_f32 v[120:121], v[120:121], v[42:43]
    v_pk_add_f32 v[122:123], v[122:123], v[44:45]
    s_waitcnt lgkmcnt(13)
    v_pk_add_f32 v[120:121], v[120:121], v[46:47]
    v_pk_add_f32 v[122:123], v[122:123], v[48:49]
    s_waitcnt lgkmcnt(12)
    v_pk_add_f32 v[120:121], v[120:121], v[50:51]
    v_pk_add_f32 v[122:123], v[122:123], v[52:53]
    v_pk_mul_f32 v[170:171], v[120:121], v[124:125] op_sel_hi:[1,0]
    v_pk_mul_f32 v[172:173], v[122:123], v[124:125] op_sel_hi:[1,0]
    v_exp_f32 v170, v170
    v_exp_f32 v171, v171
    v_exp_f32 v172, v172
    v_exp_f32 v173, v173
    v_pk_add_f32 v[170:171], v[170:171], 1.0 op_sel_hi:[1,0]
    v_pk_add_f32 v[172:173], v[172:173], 1.0 op_sel_hi:[1,0]
    v_rcp_f32 v170, v170
    v_rcp_f32 v171, v171
    v_rcp_f32 v172, v172
    v_rcp_f32 v173, v173
    v_pk_mul_f32 v[120:121], v[120:121], v[170:171]
    v_pk_mul_f32 v[122:123], v[122:123], v[172:173]
.p2align 3
    s_waitcnt lgkmcnt(11)
    v_pk_add_f32 v[104:105], v[104:105], v[54:55]
    v_pk_add_f32 v[106:107], v[106:107], v[56:57]
    s_waitcnt lgkmcnt(10)
    v_pk_add_f32 v[104:105], v[104:105], v[58:59]
    v_pk_add_f32 v[106:107], v[106:107], v[60:61]
    s_waitcnt lgkmcnt(9)
    v_pk_add_f32 v[104:105], v[104:105], v[62:63]
    v_pk_add_f32 v[106:107], v[106:107], v[64:65]
    v_pk_mul_f32 v[170:171], v[104:105], v[124:125] op_sel_hi:[1,0]
    v_pk_mul_f32 v[172:173], v[106:107], v[124:125] op_sel_hi:[1,0]
    v_exp_f32 v170, v170
    v_exp_f32 v171, v171
    v_exp_f32 v172, v172
    v_exp_f32 v173, v173
    v_pk_add_f32 v[170:171], v[170:171], 1.0 op_sel_hi:[1,0]
    v_pk_add_f32 v[172:173], v[172:173], 1.0 op_sel_hi:[1,0]
    v_rcp_f32 v170, v170
    v_rcp_f32 v171, v171
    v_rcp_f32 v172, v172
    v_rcp_f32 v173, v173
    v_pk_mul_f32 v[104:105], v[104:105], v[170:171]
    v_pk_mul_f32 v[106:107], v[106:107], v[172:173]
    s_waitcnt vmcnt(4)
    v_lshlrev_b32 v12, 16, v16
    v_and_b32 v13, 0xffff0000, v16
    v_lshlrev_b32 v14, 16, v17
    v_and_b32 v15, 0xffff0000, v17
    v_pk_mul_f32 v[120:121], v[120:121], v[12:13]
    v_pk_mul_f32 v[122:123], v[122:123], v[14:15]
    v_cvt_pk_bf16_f32 v16, v120, v121
    v_cvt_pk_bf16_f32 v17, v122, v123
    ds_write_b64 v39, v[16:17] offset:2560
    ds_read_b128 v[126:129], v28 offset:2560
.p2align 3
    s_waitcnt lgkmcnt(10)
    v_pk_add_f32 v[108:109], v[108:109], v[66:67]
    v_pk_add_f32 v[110:111], v[110:111], v[68:69]
    s_waitcnt lgkmcnt(9)
    v_pk_add_f32 v[108:109], v[108:109], v[70:71]
    v_pk_add_f32 v[110:111], v[110:111], v[72:73]
    s_waitcnt lgkmcnt(8)
    v_pk_add_f32 v[108:109], v[108:109], v[74:75]
    v_pk_add_f32 v[110:111], v[110:111], v[76:77]
    v_pk_mul_f32 v[170:171], v[108:109], v[124:125] op_sel_hi:[1,0]
    v_pk_mul_f32 v[172:173], v[110:111], v[124:125] op_sel_hi:[1,0]
    v_exp_f32 v170, v170
    v_exp_f32 v171, v171
    v_exp_f32 v172, v172
    v_exp_f32 v173, v173
    v_pk_add_f32 v[170:171], v[170:171], 1.0 op_sel_hi:[1,0]
    v_pk_add_f32 v[172:173], v[172:173], 1.0 op_sel_hi:[1,0]
    v_rcp_f32 v170, v170
    v_rcp_f32 v171, v171
    v_rcp_f32 v172, v172
    v_rcp_f32 v173, v173
    v_pk_mul_f32 v[108:109], v[108:109], v[170:171]
    v_pk_mul_f32 v[110:111], v[110:111], v[172:173]
    s_waitcnt lgkmcnt(0)
    v_lshlrev_b32 v174, 16, v126
    v_and_b32 v175, 0xffff0000, v126
    v_lshlrev_b32 v176, 16, v127
    v_and_b32 v177, 0xffff0000, v127
    v_pk_add_f32 v[174:175], v[174:175], v[134:135]
    v_pk_add_f32 v[176:177], v[176:177], v[136:137]
    v_cvt_pk_bf16_f32 v126, v174, v175
    v_cvt_pk_bf16_f32 v127, v176, v177
    v_lshlrev_b32 v174, 16, v128
    v_and_b32 v175, 0xffff0000, v128
    v_lshlrev_b32 v176, 16, v129
    v_and_b32 v177, 0xffff0000, v129
    v_pk_add_f32 v[174:175], v[174:175], v[138:139]
    v_pk_add_f32 v[176:177], v[176:177], v[140:141]
    v_cvt_pk_bf16_f32 v128, v174, v175
    v_cvt_pk_bf16_f32 v129, v176, v177
    s_mov_b64 exec, 0xffffffff
    buffer_store_dwordx4 v[126:129], v29, s[68:71], s89 offen sc1
    s_mov_b64 exec, -1
    s_waitcnt vmcnt(4)
    v_lshlrev_b32 v20, 16, v18
    v_and_b32 v21, 0xffff0000, v18
    v_lshlrev_b32 v22, 16, v19
    v_and_b32 v23, 0xffff0000, v19
    v_pk_mul_f32 v[104:105], v[104:105], v[20:21]
    v_pk_mul_f32 v[106:107], v[106:107], v[22:23]
    v_cvt_pk_bf16_f32 v18, v104, v105
    v_cvt_pk_bf16_f32 v19, v106, v107
    ds_write_b64 v39, v[18:19] offset:0
    s_waitcnt vmcnt(3)
    v_lshlrev_b32 v142, 16, v24
    v_and_b32 v143, 0xffff0000, v24
    v_lshlrev_b32 v144, 16, v25
    v_and_b32 v145, 0xffff0000, v25
    v_pk_mul_f32 v[108:109], v[108:109], v[142:143]
    v_pk_mul_f32 v[110:111], v[110:111], v[144:145]
    v_cvt_pk_bf16_f32 v24, v108, v109
    v_cvt_pk_bf16_f32 v25, v110, v111
    ds_write_b64 v39, v[24:25] offset:32
    ds_read_b128 v[130:133], v30 offset:0
.p2align 3
    v_pk_add_f32 v[112:113], v[112:113], v[78:79]
    v_pk_add_f32 v[114:115], v[114:115], v[80:81]
    v_pk_add_f32 v[112:113], v[112:113], v[82:83]
    v_pk_add_f32 v[114:115], v[114:115], v[84:85]
    v_pk_add_f32 v[112:113], v[112:113], v[86:87]
    v_pk_add_f32 v[114:115], v[114:115], v[88:89]
    v_pk_mul_f32 v[170:171], v[112:113], v[124:125] op_sel_hi:[1,0]
    v_pk_mul_f32 v[172:173], v[114:115], v[124:125] op_sel_hi:[1,0]
    v_exp_f32 v170, v170
    v_exp_f32 v171, v171
    v_exp_f32 v172, v172
    v_exp_f32 v173, v173
    v_pk_add_f32 v[170:171], v[170:171], 1.0 op_sel_hi:[1,0]
    v_pk_add_f32 v[172:173], v[172:173], 1.0 op_sel_hi:[1,0]
    v_rcp_f32 v170, v170
    v_rcp_f32 v171, v171
    v_rcp_f32 v172, v172
    v_rcp_f32 v173, v173
    v_pk_mul_f32 v[112:113], v[112:113], v[170:171]
    v_pk_mul_f32 v[114:115], v[114:115], v[172:173]
    s_waitcnt lgkmcnt(0)
    v_lshlrev_b32 v174, 16, v130
    v_and_b32 v175, 0xffff0000, v130
    v_lshlrev_b32 v176, 16, v131
    v_and_b32 v177, 0xffff0000, v131
    v_pk_add_f32 v[174:175], v[174:175], v[154:155]
    v_pk_add_f32 v[176:177], v[176:177], v[156:157]
    v_cvt_pk_bf16_f32 v130, v174, v175
    v_cvt_pk_bf16_f32 v131, v176, v177
    v_lshlrev_b32 v174, 16, v132
    v_and_b32 v175, 0xffff0000, v132
    v_lshlrev_b32 v176, 16, v133
    v_and_b32 v177, 0xffff0000, v133
    v_pk_add_f32 v[174:175], v[174:175], v[158:159]
    v_pk_add_f32 v[176:177], v[176:177], v[160:161]
    v_cvt_pk_bf16_f32 v132, v174, v175
    v_cvt_pk_bf16_f32 v133, v176, v177
    buffer_store_dwordx4 v[130:133], v11, s[68:71], s88 offen offset:0 sc1
.p2align 3
    v_pk_add_f32 v[116:117], v[116:117], v[90:91]
    v_pk_add_f32 v[118:119], v[118:119], v[92:93]
    v_pk_add_f32 v[116:117], v[116:117], v[94:95]
    v_pk_add_f32 v[118:119], v[118:119], v[96:97]
    v_pk_add_f32 v[116:117], v[116:117], v[98:99]
    v_pk_add_f32 v[118:119], v[118:119], v[100:101]
    v_pk_mul_f32 v[170:171], v[116:117], v[124:125] op_sel_hi:[1,0]
    v_pk_mul_f32 v[172:173], v[118:119], v[124:125] op_sel_hi:[1,0]
    v_exp_f32 v170, v170
    v_exp_f32 v171, v171
    v_exp_f32 v172, v172
    v_exp_f32 v173, v173
    v_pk_add_f32 v[170:171], v[170:171], 1.0 op_sel_hi:[1,0]
    v_pk_add_f32 v[172:173], v[172:173], 1.0 op_sel_hi:[1,0]
    v_rcp_f32 v170, v170
    v_rcp_f32 v171, v171
    v_rcp_f32 v172, v172
    v_rcp_f32 v173, v173
    v_pk_mul_f32 v[116:117], v[116:117], v[170:171]
    v_pk_mul_f32 v[118:119], v[118:119], v[172:173]
    s_waitcnt vmcnt(3)
    v_lshlrev_b32 v146, 16, v26
    v_and_b32 v147, 0xffff0000, v26
    v_lshlrev_b32 v148, 16, v27
    v_and_b32 v149, 0xffff0000, v27
    v_pk_mul_f32 v[112:113], v[112:113], v[146:147]
    v_pk_mul_f32 v[114:115], v[114:115], v[148:149]
    v_cvt_pk_bf16_f32 v26, v112, v113
    v_cvt_pk_bf16_f32 v27, v114, v115
    ds_write_b64 v39, v[26:27] offset:1280
    s_waitcnt vmcnt(2)
    v_lshlrev_b32 v150, 16, v40
    v_and_b32 v151, 0xffff0000, v40
    v_lshlrev_b32 v152, 16, v41
    v_and_b32 v153, 0xffff0000, v41
    v_pk_mul_f32 v[116:117], v[116:117], v[150:151]
    v_pk_mul_f32 v[118:119], v[118:119], v[152:153]
    v_cvt_pk_bf16_f32 v40, v116, v117
    v_cvt_pk_bf16_f32 v41, v118, v119
    ds_write_b64 v39, v[40:41] offset:1312
    ds_read_b128 v[228:231], v30 offset:1280
    s_waitcnt lgkmcnt(0)
    v_lshlrev_b32 v174, 16, v228
    v_and_b32 v175, 0xffff0000, v228
    v_lshlrev_b32 v176, 16, v229
    v_and_b32 v177, 0xffff0000, v229
    v_pk_add_f32 v[174:175], v[174:175], v[162:163]
    v_pk_add_f32 v[176:177], v[176:177], v[164:165]
    v_cvt_pk_bf16_f32 v228, v174, v175
    v_cvt_pk_bf16_f32 v229, v176, v177
    v_lshlrev_b32 v174, 16, v230
    v_and_b32 v175, 0xffff0000, v230
    v_lshlrev_b32 v176, 16, v231
    v_and_b32 v177, 0xffff0000, v231
    v_pk_add_f32 v[174:175], v[174:175], v[166:167]
    v_pk_add_f32 v[176:177], v[176:177], v[168:169]
    v_cvt_pk_bf16_f32 v230, v174, v175
    v_cvt_pk_bf16_f32 v231, v176, v177
    buffer_store_dwordx4 v[228:231], v11, s[68:71], s88 offen offset:64 sc1
    s_endpgm
.p2align 6
L_H1:
    s_cmp_ge_u32 s73, 30
    s_cbranch_scc1 L_LDB
    v_mov_b32 v14, 0
    v_lshlrev_b32 v3, 3, v1
    buffer_store_dwordx4 v[210:213], v6, s[64:67], s88 offen sc1
    buffer_store_dwordx2 v[214:215], v3, s[64:67], s88 offen offset:1024 sc1
    global_load_dword v13, v14, s[44:45] sc1
    s_waitcnt vmcnt(17)
    s_setprio 1
    s_barrier
    s_add_u32 m0, s62, 40960
    s_add_u32 s4, s60, 256
    buffer_load_dwordx4 v7, s[48:51], s4 offen lds
    v_and_b32 v4, 3, v1
    v_mul_u32_u24 v5, 2592, v4
    v_lshrrev_b32 v3, 2, v1
    v_lshl_add_u32 v5, v3, 3, v5
    s_add_u32 m0, s62, 41984
    s_add_u32 s4, s60, 10496
    buffer_load_dwordx4 v8, s[48:51], s4 offen lds
    v_lshlrev_b32 v3, 14, v3
    v_lshl_add_u32 v160, v4, 4, v3
    s_lshl_b32 s8, s83, 7
    s_add_u32 s8, s8, 18432
    s_add_u32 m0, s62, 43008
    s_add_u32 s4, s60, 20736
    buffer_load_dwordx4 v7, s[48:51], s4 offen lds
    v_add_u32 v5, s8, v5
    ds_read2_b64 v[32:35], v5 offset0:0 offset1:162
    v_add_u32 v5, 512, v5
    ds_read2_b64 v[36:39], v5 offset0:0 offset1:162
    s_add_u32 m0, s62, 44032
    s_add_u32 s4, s60, 30976
    buffer_load_dwordx4 v8, s[48:51], s4 offen lds
    v_add_u32 v5, 512, v5
    ds_read2_b64 v[40:43], v5 offset0:0 offset1:162
    s_lshl_b32 s8, s83, 18
    s_lshl_b32 s5, s76, 3
    s_add_u32 m0, s62, 45056
    s_add_u32 s4, s60, 41216
    buffer_load_dwordx4 v7, s[48:51], s4 offen lds
    s_add_u32 s8, s8, s5
    s_add_u32 s8, s8, 1048576
    s_add_u32 s9, s8, 1048576
    s_add_u32 s10, s8, 2097152
    s_cmp_ge_u32 s83, 2
    s_cselect_b32 s10, 2130706432, s10
    ds_read_b128 v[54:57], v6 offset:0
    s_add_u32 m0, s62, 46080
    s_add_u32 s4, s60, 51456
    buffer_load_dwordx4 v8, s[48:51], s4 offen lds
    ds_read_b128 v[58:61], v6 offset:4608
    ds_read_b128 v[62:65], v6 offset:9216
    ds_read_b128 v[66:69], v6 offset:13824
    s_waitcnt lgkmcnt(6)
    buffer_store_dwordx4 v[32:35], v160, s[64:67], s8 offen sc1
    s_waitcnt vmcnt(14)
    s_barrier
    s_add_u32 m0, s62, 81920
    s_add_u32 s4, s90, 384
    buffer_load_dwordx4 v7, s[48:51], s4 offen lds
    s_waitcnt lgkmcnt(2)
    v_add_f32 v54, v54, v58
    s_waitcnt lgkmcnt(0)
    v_add_f32 v62, v62, v66
    v_add_f32 v54, v54, v62
    v_add_f32 v55, v55, v59
    s_add_u32 m0, s63, 106496
    s_add_u32 s4, s91, 589824
    buffer_load_dwordx4 v9, s[52:55], s4 offen lds
    v_add_f32 v63, v63, v67
    v_add_f32 v55, v55, v63
    v_add_f32 v56, v56, v60
    v_add_f32 v64, v64, v68
    v_add_f32 v56, v56, v64
    s_add_u32 m0, s62, 82944
    s_add_u32 s4, s90, 10624
    buffer_load_dwordx4 v8, s[48:51], s4 offen lds
    v_add_f32 v57, v57, v61
    v_add_f32 v65, v65, v69
    v_add_f32 v57, v57, v65
    v_cvt_pk_bf16_f32 v58, v54, v55
    v_lshlrev_b32 v3, 16, v58
    s_add_u32 m0, s63, 107520
    s_add_u32 s4, s91, 614400
    buffer_load_dwordx4 v10, s[52:55], s4 offen lds
    v_and_b32 v4, 0xffff0000, v58
    v_sub_f32 v3, v54, v3
    v_sub_f32 v4, v55, v4
    v_cvt_pk_bf16_f32 v60, v3, v4
    s_add_u32 m0, s62, 83968
    s_add_u32 s4, s90, 20864
    buffer_load_dwordx4 v7, s[48:51], s4 offen lds
    v_cvt_pk_bf16_f32 v59, v56, v57
    v_lshlrev_b32 v3, 16, v59
    v_and_b32 v4, 0xffff0000, v59
    v_sub_f32 v3, v56, v3
    v_sub_f32 v4, v57, v4
    s_add_u32 m0, s62, 84992
    s_add_u32 s4, s90, 31104
    buffer_load_dwordx4 v8, s[48:51], s4 offen lds
    v_cvt_pk_bf16_f32 v61, v3, v4
    v_and_b32 v3, 15, v1
    v_lshlrev_b32 v3, 4, v3
    v_lshrrev_b32 v4, 4, v1
    v_lshl_add_u32 v162, v4, 3, v3
    s_add_u32 m0, s63, 108544
    s_add_u32 s4, s91, 638976
    buffer_load_dwordx4 v9, s[52:55], s4 offen lds
    v_min_u32 v165, 31, v1
    v_lshlrev_b32 v165, 2, v165
    v_add_u32 v165, 145024, v165
    s_mul_i32 s98, s83, 4672
    s_add_u32 m0, s62, 86016
    s_add_u32 s4, s90, 41344
    buffer_load_dwordx4 v7, s[48:51], s4 offen lds
    s_add_u32 s98, s98, 145152
    s_mul_i32 s99, s83, 1600
    s_add_u32 s99, s99, 32
    s_mul_i32 s100, s83, 10496
    s_add_u32 s100, s100, 81920
    s_add_u32 m0, s63, 109568
    s_add_u32 s4, s91, 663552
    buffer_load_dwordx4 v10, s[52:55], s4 offen lds
    v_and_b32 v70, 15, v1
    v_lshrrev_b32 v71, 4, v1
    v_mov_b32 v80, 0
    v_mov_b32 v81, 0
    v_lshlrev_b32 v79, 5, v70
    s_add_u32 m0, s62, 87040
    s_add_u32 s4, s90, 51584
    buffer_load_dwordx4 v8, s[48:51], s4 offen lds
    buffer_store_dwordx4 v[36:39], v160, s[64:67], s9 offen sc1
    s_waitcnt vmcnt(12)
    s_barrier
    v_readfirstlane_b32 s78, v13
    s_nop 1
    s_cmp_lg_u32 s78, 0
    s_cbranch_scc1 NOND_24
    s_mov_b32 s4, 0
NON_23:
    global_load_dword v13, v14, s[44:45] sc1
    s_waitcnt vmcnt(0)
    v_readfirstlane_b32 s78, v13
    s_add_u32 s4, s4, 1
    s_cmp_ge_u32 s4, 0x20000
    s_cbranch_scc1 NOND_24
    s_cmp_eq_u32 s78, 0
    s_cbranch_scc1 NON_23
NOND_24:
    s_lshl_b32 s4, s2, 7
    s_add_u32 s4, s4, 32768
    s_cmp_lg_u32 s83, 1
    s_cselect_b32 s4, 2130706432, s4
    v_mov_b32 v158, s78
    v_mov_b32 v159, 0
    s_mov_b64 exec, 1
    buffer_store_dword v158, v159, s[64:67], s4 offen sc1
    s_mov_b64 exec, -1
    s_add_u32 m0, s62, 122880
    s_add_u32 s4, s60, 512
    buffer_load_dwordx4 v7, s[48:51], s4 offen lds
    v_lshl_add_u32 v79, v71, 3, v79
    v_add_u32 v79, s99, v79
    v_lshlrev_b32 v136, 4, v70
    v_lshl_add_u32 v136, v71, 3, v136
    s_add_u32 m0, s63, 147456
    s_add_u32 s4, s61, 786432
    buffer_load_dwordx4 v9, s[52:55], s4 offen lds
    v_lshlrev_b32 v137, 7, v71
    v_lshl_add_u32 v5, v70, 3, v137
    v_cmp_gt_u32 s[20:21], 32, v1
    s_nop 1
    v_cndmask_b32 v136, v5, v136, s[20:21]
    s_add_u32 m0, s62, 123904
    s_add_u32 s4, s60, 10752
    buffer_load_dwordx4 v8, s[48:51], s4 offen lds
    v_add_u32 v136, s99, v136
    v_lshl_add_u32 v137, v70, 2, v137
    v_add_u32 v137, s99, v137
    v_and_b32 v138, 3, v1
    v_lshl_add_u32 v138, v138, 3, s99
    s_add_u32 m0, s63, 148480
    s_add_u32 s4, s61, 811008
    buffer_load_dwordx4 v10, s[52:55], s4 offen lds
    v_subrev_u32 v138, 32, v138
    v_and_b32 v4, 3, v1
    v_lshl_add_u32 v3, v71, 2, v4
    v_bfe_u32 v5, v1, 2, 2
    s_add_u32 m0, s62, 124928
    s_add_u32 s4, s60, 20992
    buffer_load_dwordx4 v7, s[48:51], s4 offen lds
    v_lshl_add_u32 v3, v3, 2, v5
    v_sub_u32 v3, 63, v3
    v_lshlrev_b32 v3, 3, v3
    s_lshl_b32 s6, s83, 12
    s_add_u32 s5, s6, 20480
    s_add_u32 m0, s62, 125952
    s_add_u32 s4, s60, 31232
    buffer_load_dwordx4 v8, s[48:51], s4 offen lds
    v_add_u32 v72, s5, v3
    v_lshl_add_u32 v3, v4, 2, v5
    v_lshl_add_u32 v3, v3, 1, s99
    v_subrev_u32 v163, 32, v3
    s_add_u32 m0, s63, 149504
    s_add_u32 s4, s61, 835584
    buffer_load_dwordx4 v9, s[52:55], s4 offen lds
    v_mul_u32_u24 v3, 2624, v5
    v_lshl_add_u32 v3, v4, 3, v3
    v_add_u32 v75, s100, v3
    v_mul_u32_u24 v4, 4672, v4
    v_lshrrev_b32 v5, 2, v1
    s_add_u32 m0, s62, 126976
    s_add_u32 s4, s60, 41472
    buffer_load_dwordx4 v7, s[48:51], s4 offen lds
    v_lshl_add_u32 v4, v5, 3, v4
    s_lshl_b32 s5, s83, 10
    s_sub_u32 s5, 148224, s5
    v_add_u32 v73, s5, v4
    s_add_u32 m0, s63, 150528
    s_add_u32 s4, s61, 860160
    buffer_load_dwordx4 v10, s[52:55], s4 offen lds
    v_lshl_add_u32 v74, v1, 3, s98
    v_lshl_add_u32 v3, v70, 2, v71
    v_sub_u32 v3, 316, v3
    v_lshl_add_u32 v164, v3, 2, s99
    s_and_b32 s14, s79, 1
    s_add_u32 m0, s62, 128000
    s_add_u32 s4, s60, 51712
    buffer_load_dwordx4 v8, s[48:51], s4 offen lds
    buffer_store_dwordx4 v[40:43], v160, s[64:67], s10 offen sc1
    s_mov_b64 exec, 0xffffffff
    buffer_store_dwordx2 v[58:59], v162, s[64:67], s58 offen sc1
    buffer_store_dwordx2 v[60:61], v162, s[64:67], s58 offen offset:3072 sc1
    s_mov_b64 exec, -1
    s_waitcnt vmcnt(15)
    s_barrier
    s_add_u32 m0, s62, 40960
    s_add_u32 s4, s90, 640
    buffer_load_dwordx4 v7, s[48:51], s4 offen lds
    s_lshl_b32 s14, s14, 2
    s_bitcmp1_b32 s79, 2
    s_cselect_b32 s14, 8, s14
    s_add_u32 s14, s14, 6
    s_mul_i32 s5, s80, 48
    s_mul_i32 s6, s83, 12
    s_add_u32 m0, s63, 65536
    s_add_u32 s4, s91, 983040
    buffer_load_dwordx4 v9, s[52:55], s4 offen lds
    s_add_u32 s5, s5, s6
    s_mul_i32 s5, s5, 5120
    s_add_u32 s15, s5, 10485760
    s_cmp_ge_u32 s14, 12
    s_cselect_b32 s5, 12, 0
    s_sub_u32 s14, s14, s5
    s_cmp_ge_u32 s14, 12
    s_cselect_b32 s5, 12, 0
    s_sub_u32 s14, s14, s5
    s_add_u32 m0, s62, 41984
    s_add_u32 s4, s90, 10880
    buffer_load_dwordx4 v8, s[48:51], s4 offen lds
    s_mul_i32 s5, s14, 5120
    s_add_u32 s34, s5, s15
    s_add_u32 s14, s14, 1
    s_cmp_ge_u32 s14, 12
    s_cselect_b32 s5, 12, 0
    s_sub_u32 s14, s14, s5
    s_mul_i32 s5, s14, 5120
    s_add_u32 m0, s63, 66560
    s_add_u32 s4, s91, 1007616
    buffer_load_dwordx4 v10, s[52:55], s4 offen lds
    s_add_u32 s35, s5, s15
    s_add_u32 s14, s14, 1
    s_cmp_ge_u32 s14, 12
    s_cselect_b32 s5, 12, 0
    s_sub_u32 s14, s14, s5
    s_mul_i32 s5, s14, 5120
    s_add_u32 s36, s5, s15
    s_add_u32 m0, s62, 43008
    s_add_u32 s4, s90, 21120
    buffer_load_dwordx4 v7, s[48:51], s4 offen lds
    s_add_u32 s14, s14, 1
    s_cmp_ge_u32 s14, 12
    s_cselect_b32 s5, 12, 0
    s_sub_u32 s14, s14, s5
    s_mul_i32 s5, s14, 5120
    s_add_u32 s37, s5, s15
    s_add_u32 s14, s14, 1
    s_add_u32 m0, s62, 44032
    s_add_u32 s4, s90, 31360
    buffer_load_dwordx4 v8, s[48:51], s4 offen lds
    s_cmp_ge_u32 s14, 12
    s_cselect_b32 s5, 12, 0
    s_sub_u32 s14, s14, s5
    s_mul_i32 s5, s14, 5120
    s_add_u32 s38, s5, s15
    s_add_u32 s14, s14, 1
    s_mul_i32 s14, s83, 5120
    s_add_u32 m0, s63, 67584
    s_add_u32 s4, s91, 1032192
    buffer_load_dwordx4 v9, s[52:55], s4 offen lds
    s_add_u32 s14, s14, 123904
    s_mul_i32 s19, s83, 10240
    s_lshl_b32 s5, s83, 2
    s_add_u32 s5, s5, 145024
    v_mov_b32 v17, s5
    s_add_u32 m0, s62, 45056
    s_add_u32 s4, s90, 41600
    buffer_load_dwordx4 v7, s[48:51], s4 offen lds
    v_add_u32 v19, 4096, v6
    v_add_u32 v3, 1, v70
    v_and_b32 v4, 3, v3
    v_mul_u32_u24 v0, 2624, v4
    v_and_b32 v3, 28, v3
    s_add_u32 m0, s63, 68608
    s_add_u32 s4, s91, 1056768
    buffer_load_dwordx4 v10, s[52:55], s4 offen lds
    v_lshl_add_u32 v0, v3, 1, v0
    v_lshl_add_u32 v0, v71, 4, v0
    v_add_u32 v0, s100, v0
    v_lshlrev_b32 v3, 5, v70
    v_sub_u32 v2, 480, v3
    v_lshl_add_u32 v2, v71, 4, v2
    s_add_u32 m0, s62, 46080
    s_add_u32 s4, s90, 51840
    buffer_load_dwordx4 v8, s[48:51], s4 offen lds
    s_waitcnt vmcnt(10)
    s_barrier
    s_lshl_b32 s4, s2, 3
    s_add_u32 s4, s4, 0
    s_cmp_lg_u32 s83, 0
    s_cselect_b32 s4, 2130706432, s4
    v_mov_b32 v158, s78
    v_mov_b32 v159, 0
    s_mov_b64 exec, 1
    buffer_store_dword v158, v159, s[64:67], s4 offen sc1
    s_mov_b64 exec, -1
    s_mul_i32 s7, s97, 3
    v_and_b32 v159, 2, v1
    v_add_u32 v159, s7, v159
    v_lshrrev_b32 v159, 3, v159
    v_lshlrev_b32 v159, 7, v159
    s_mov_b32 s7, 32768
    s_cmp_ge_u32 s73, 20
    s_cselect_b32 s7, 2130706432, s7
    buffer_load_dword v158, v159, s[64:67], s7 offen sc1
    s_add_u32 m0, s62, 81920
    s_add_u32 s4, s60, 768
    buffer_load_dwordx4 v7, s[48:51], s4 offen lds
    v_add_u32 v2, s98, v2
    v_sub_u32 v3, 15, v70
    v_and_b32 v4, 3, v3
    v_mul_u32_u24 v16, 2624, v4
    s_add_u32 m0, s63, 106496
    s_add_u32 s4, s61, 1179648
    buffer_load_dwordx4 v9, s[52:55], s4 offen lds
    v_and_b32 v3, 12, v3
    v_lshl_add_u32 v16, v3, 1, v16
    v_lshl_add_u32 v16, v71, 3, v16
    v_add_u32 v16, s100, v16
    v_and_b32 v3, 1, v71
    s_add_u32 m0, s62, 82944
    s_add_u32 s4, s60, 11008
    buffer_load_dwordx4 v8, s[48:51], s4 offen lds
    v_lshlrev_b32 v3, 8, v3
    v_lshl_add_u32 v3, v70, 4, v3
    v_and_b32 v4, 2, v71
    v_lshl_add_u32 v15, v4, 2, v3
    s_lshl_b32 s5, s83, 6
    s_add_u32 m0, s63, 107520
    s_add_u32 s4, s61, 1204224
    buffer_load_dwordx4 v10, s[52:55], s4 offen lds
    s_add_u32 s5, s5, s100
    v_add_u32 v15, s5, v15
    v_bfe_u32 v3, v1, 2, 2
    v_mul_u32_u24 v3, 10560, v3
    v_lshl_add_u32 v3, v71, 5, v3
    s_add_u32 m0, s62, 83968
    s_add_u32 s4, s60, 21248
    buffer_load_dwordx4 v7, s[48:51], s4 offen lds
    v_and_b32 v4, 3, v1
    v_lshl_add_u32 v3, v4, 3, v3
    s_lshl_b32 s5, s83, 9
    s_add_u32 s5, s5, 81920
    v_add_u32 v18, s5, v3
    s_add_u32 m0, s62, 84992
    s_add_u32 s4, s60, 31488
    buffer_load_dwordx4 v8, s[48:51], s4 offen lds
    v_lshl_add_u32 v5, v71, 3, v70
    v_sub_u32 v3, 15, v5
    v_and_b32 v4, 1, v3
    v_lshlrev_b32 v4, 4, v4
    v_lshlrev_b32 v4, v4, v12
    s_add_u32 m0, s63, 108544
    s_add_u32 s4, s61, 1228800
    buffer_load_dwordx4 v9, s[52:55], s4 offen lds
    v_lshrrev_b32 v3, 1, v3
    v_cmp_eq_u32 s[20:21], 0, v3
    s_nop 1
    v_cndmask_b32 v20, 0, v4, s[20:21]
    v_cmp_eq_u32 s[20:21], 1, v3
    s_nop 1
    v_cndmask_b32 v21, 0, v4, s[20:21]
    s_add_u32 m0, s62, 86016
    s_add_u32 s4, s60, 41728
    buffer_load_dwordx4 v7, s[48:51], s4 offen lds
    v_cmp_eq_u32 s[20:21], 2, v3
    s_nop 1
    v_cndmask_b32 v22, 0, v4, s[20:21]
    v_cmp_eq_u32 s[20:21], 3, v3
    s_nop 1
    v_cndmask_b32 v23, 0, v4, s[20:21]
    v_min_u32 v5, 31, v5
    s_add_u32 m0, s63, 109568
    s_add_u32 s4, s61, 1253376
    buffer_load_dwordx4 v10, s[52:55], s4 offen lds
    s_mov_b32 s5, 0x7f00000
    s_mov_b32 s6, 0xff80000
    v_lshrrev_b32 v3, v5, s5
    v_bfe_u32 v24, v3, 0, 2
    v_lshl_or_b32 v24, v24, 15, v24
    s_add_u32 m0, s62, 87040
    s_add_u32 s4, s60, 51968
    buffer_load_dwordx4 v8, s[48:51], s4 offen lds
    s_waitcnt vmcnt(12)
    s_cmp_ge_u32 s73, 20
    s_cbranch_scc1 NK_25
    s_waitcnt vmcnt(10)
    v_cmp_ne_u32 vcc, s78, v158
    s_nop 1
    s_cbranch_vccz PDONE_27
    s_mov_b32 s4, 0
POLL_26:
    buffer_load_dword v158, v159, s[64:67], s7 offen sc1
    s_waitcnt vmcnt(0)
    v_cmp_ne_u32 vcc, s78, v158
    s_add_u32 s4, s4, 1
    s_nop 0
    s_cbranch_vccz PDONE_27
    s_cmp_lt_u32 s4, 0x20000
    s_cbranch_scc1 POLL_26
PDONE_27:
NK_25:
    s_barrier
    s_mul_i32 s7, s97, 4608
    s_add_u32 s7, s7, 4194304
    v_lshlrev_b32 v139, 3, v1
    s_cmp_ge_u32 s73, 20
    s_cselect_b32 s7, 2130706432, s7
    buffer_load_dwordx4 v[140:143], v6, s[64:67], s7 offen sc1
    buffer_load_dwordx2 v[144:145], v139, s[64:67], s7 offen offset:1024 sc1
    s_add_u32 s7, s7, 1536
    buffer_load_dwordx4 v[146:149], v6, s[64:67], s7 offen sc1
    buffer_load_dwordx2 v[150:151], v139, s[64:67], s7 offen offset:1024 sc1
    s_add_u32 s7, s7, 1536
    buffer_load_dwordx4 v[152:155], v6, s[64:67], s7 offen sc1
    buffer_load_dwordx2 v[156:157], v139, s[64:67], s7 offen offset:1024 sc1
    s_add_u32 s7, s7, 1536
    s_add_u32 m0, s62, 122880
    s_add_u32 s4, s90, 896
    buffer_load_dwordx4 v7, s[48:51], s4 offen lds
    v_and_b32 v24, 0x10001, v24
    v_mul_u32_u24 v24, 0x3f80, v24
    v_bfe_u32 v25, v3, 2, 2
    v_lshl_or_b32 v25, v25, 15, v25
    s_add_u32 m0, s63, 147456
    s_add_u32 s4, s91, 1376256
    buffer_load_dwordx4 v9, s[52:55], s4 offen lds
    v_and_b32 v25, 0x10001, v25
    v_mul_u32_u24 v25, 0x3f80, v25
    v_bfe_u32 v26, v3, 4, 2
    v_lshl_or_b32 v26, v26, 15, v26
    s_add_u32 m0, s62, 123904
    s_add_u32 s4, s90, 11136
    buffer_load_dwordx4 v8, s[48:51], s4 offen lds
    v_and_b32 v26, 0x10001, v26
    v_mul_u32_u24 v26, 0x3f80, v26
    v_bfe_u32 v27, v3, 6, 2
    v_lshl_or_b32 v27, v27, 15, v27
    v_and_b32 v27, 0x10001, v27
    s_add_u32 m0, s63, 148480
    s_add_u32 s4, s91, 1400832
    buffer_load_dwordx4 v10, s[52:55], s4 offen lds
    v_mul_u32_u24 v27, 0x3f80, v27
    v_lshrrev_b32 v3, v5, s6
    v_bfe_u32 v28, v3, 0, 2
    v_lshl_or_b32 v28, v28, 15, v28
    s_add_u32 m0, s62, 124928
    s_add_u32 s4, s90, 21376
    buffer_load_dwordx4 v7, s[48:51], s4 offen lds
    v_and_b32 v28, 0x10001, v28
    v_mul_u32_u24 v28, 0x3f80, v28
    v_bfe_u32 v29, v3, 2, 2
    v_lshl_or_b32 v29, v29, 15, v29
    v_and_b32 v29, 0x10001, v29
    s_add_u32 m0, s62, 125952
    s_add_u32 s4, s90, 31616
    buffer_load_dwordx4 v8, s[48:51], s4 offen lds
    v_mul_u32_u24 v29, 0x3f80, v29
    v_bfe_u32 v30, v3, 4, 2
    v_lshl_or_b32 v30, v30, 15, v30
    v_and_b32 v30, 0x10001, v30
    s_add_u32 m0, s63, 149504
    s_add_u32 s4, s91, 1425408
    buffer_load_dwordx4 v9, s[52:55], s4 offen lds
    v_mul_u32_u24 v30, 0x3f80, v30
    v_bfe_u32 v31, v3, 6, 2
    v_lshl_or_b32 v31, v31, 15, v31
    v_and_b32 v31, 0x10001, v31
    v_mul_u32_u24 v31, 0x3f80, v31
    s_add_u32 m0, s62, 126976
    s_add_u32 s4, s90, 41856
    buffer_load_dwordx4 v7, s[48:51], s4 offen lds
    v_lshl_add_u32 v76, v1, 3, s100
    v_lshl_add_u32 v77, v1, 4, s100
    s_mov_b32 s22, 0x1000100
    s_mov_b32 s23, 0x3020302
    s_add_u32 m0, s63, 150528
    s_add_u32 s4, s91, 1449984
    buffer_load_dwordx4 v10, s[52:55], s4 offen lds
    s_mov_b32 s24, 0x5040504
    s_mov_b32 s25, 0x5040302
    v_mul_u32_u24 v3, 2624, v71
    v_lshl_add_u32 v3, v70, 3, v3
    v_add_u32 v78, s100, v3
    s_add_u32 m0, s62, 128000
    s_add_u32 s4, s90, 52096
    buffer_load_dwordx4 v8, s[48:51], s4 offen lds
    s_waitcnt vmcnt(16)
    s_barrier
    s_add_u32 m0, s62, 40960
    s_add_u32 s4, s60, 1024
    buffer_load_dwordx4 v7, s[48:51], s4 offen lds
    v_mov_b32 v5, 0xffff
    v_lshl_add_u32 v4, v70, 2, v71
    v_sub_u32 v3, 64, v4
    v_cmp_le_i32 s[20:21], 1, v3
    s_nop 1
    v_cndmask_b32 v126, 0, v5, s[20:21]
    s_add_u32 m0, s63, 65536
    s_add_u32 s4, s61, 1572864
    buffer_load_dwordx4 v9, s[52:55], s4 offen lds
    v_cmp_le_i32 s[20:21], 2, v3
    s_nop 1
    v_cndmask_b32 v126, v126, -1, s[20:21]
    v_cmp_le_i32 s[20:21], 3, v3
    s_nop 1
    v_cndmask_b32 v127, 0, v5, s[20:21]
    v_cmp_le_i32 s[20:21], 4, v3
    s_add_u32 m0, s62, 41984
    s_add_u32 s4, s60, 11264
    buffer_load_dwordx4 v8, s[48:51], s4 offen lds
    v_cndmask_b32 v127, v127, -1, s[20:21]
    s_mov_b32 s26, 0x3020706
    s_mov_b32 s27, 0x1000504
    v_sub_u32 v3, 5, v4
    v_cmp_le_i32 s[20:21], 1, v3
    s_add_u32 m0, s63, 66560
    s_add_u32 s4, s61, 1597440
    buffer_load_dwordx4 v10, s[52:55], s4 offen lds
    v_cndmask_b32 v134, 0, v5, s[20:21]
    v_cmp_le_i32 s[20:21], 2, v3
    s_nop 1
    v_cndmask_b32 v134, v134, -1, s[20:21]
    v_cmp_le_i32 s[20:21], 3, v3
    s_nop 1
    v_cndmask_b32 v135, 0, v5, s[20:21]
    s_add_u32 m0, s62, 43008
    s_add_u32 s4, s60, 21504
    buffer_load_dwordx4 v7, s[48:51], s4 offen lds
    v_cmp_le_i32 s[20:21], 4, v3
    s_nop 1
    v_cndmask_b32 v135, v135, -1, s[20:21]
    s_waitcnt vmcnt(20)
    v_lshlrev_b32 v94, 16, v140
    v_and_b32 v95, 0xffff0000, v140
    s_waitcnt vmcnt(18)
    v_lshlrev_b32 v3, 16, v146
    s_add_u32 m0, s62, 44032
    s_add_u32 s4, s60, 31744
    buffer_load_dwordx4 v8, s[48:51], s4 offen lds
    v_and_b32 v4, 0xffff0000, v146
    v_add_f32 v94, v94, v3
    v_add_f32 v95, v95, v4
    s_waitcnt vmcnt(17)
    v_lshlrev_b32 v3, 16, v152
    v_and_b32 v4, 0xffff0000, v152
    s_add_u32 m0, s63, 67584
    s_add_u32 s4, s61, 1622016
    buffer_load_dwordx4 v9, s[52:55], s4 offen lds
    v_add_f32 v94, v94, v3
    v_add_f32 v95, v95, v4
    v_cvt_pk_bf16_f32 v140, v94, v95
    v_lshlrev_b32 v96, 16, v141
    v_and_b32 v97, 0xffff0000, v141
    s_add_u32 m0, s62, 45056
    s_add_u32 s4, s60, 41984
    buffer_load_dwordx4 v7, s[48:51], s4 offen lds
    v_lshlrev_b32 v3, 16, v147
    v_and_b32 v4, 0xffff0000, v147
    v_add_f32 v96, v96, v3
    v_add_f32 v97, v97, v4
    v_lshlrev_b32 v3, 16, v153
    s_add_u32 m0, s63, 68608
    s_add_u32 s4, s61, 1646592
    buffer_load_dwordx4 v10, s[52:55], s4 offen lds
    v_and_b32 v4, 0xffff0000, v153
    v_add_f32 v96, v96, v3
    v_add_f32 v97, v97, v4
    v_cvt_pk_bf16_f32 v141, v96, v97
    v_lshlrev_b32 v98, 16, v142
    v_and_b32 v99, 0xffff0000, v142
    s_add_u32 m0, s62, 46080
    s_add_u32 s4, s60, 52224
    buffer_load_dwordx4 v8, s[48:51], s4 offen lds
    s_waitcnt vmcnt(10)
    s_barrier
    v_lshlrev_b32 v159, 3, v1
    s_lshl_b32 s7, s83, 9
    s_add_u32 s7, s7, 0
    buffer_load_dword v158, v159, s[64:67], s7 offen sc1
    s_add_u32 m0, s62, 81920
    s_add_u32 s4, s90, 1152
    buffer_load_dwordx4 v7, s[48:51], s4 offen lds
    v_lshlrev_b32 v3, 16, v148
    v_and_b32 v4, 0xffff0000, v148
    v_add_f32 v98, v98, v3
    v_add_f32 v99, v99, v4
    s_add_u32 m0, s63, 106496
    s_add_u32 s4, s91, 1769472
    buffer_load_dwordx4 v9, s[52:55], s4 offen lds
    v_lshlrev_b32 v3, 16, v154
    v_and_b32 v4, 0xffff0000, v154
    v_add_f32 v98, v98, v3
    v_add_f32 v99, v99, v4
    v_cvt_pk_bf16_f32 v142, v98, v99
    s_add_u32 m0, s62, 82944
    s_add_u32 s4, s90, 11392
    buffer_load_dwordx4 v8, s[48:51], s4 offen lds
    v_lshlrev_b32 v100, 16, v143
    v_and_b32 v101, 0xffff0000, v143
    v_lshlrev_b32 v3, 16, v149
    v_and_b32 v4, 0xffff0000, v149
    v_add_f32 v100, v100, v3
    s_add_u32 m0, s63, 107520
    s_add_u32 s4, s91, 1794048
    buffer_load_dwordx4 v10, s[52:55], s4 offen lds
    v_add_f32 v101, v101, v4
    v_lshlrev_b32 v3, 16, v155
    v_and_b32 v4, 0xffff0000, v155
    v_add_f32 v100, v100, v3
    v_add_f32 v101, v101, v4
    s_add_u32 m0, s62, 83968
    s_add_u32 s4, s90, 21632
    buffer_load_dwordx4 v7, s[48:51], s4 offen lds
    v_cvt_pk_bf16_f32 v143, v100, v101
    v_lshlrev_b32 v102, 16, v144
    v_and_b32 v103, 0xffff0000, v144
    v_lshlrev_b32 v3, 16, v150
    v_and_b32 v4, 0xffff0000, v150
    s_add_u32 m0, s62, 84992
    s_add_u32 s4, s90, 31872
    buffer_load_dwordx4 v8, s[48:51], s4 offen lds
    v_add_f32 v102, v102, v3
    v_add_f32 v103, v103, v4
    v_lshlrev_b32 v3, 16, v156
    v_and_b32 v4, 0xffff0000, v156
    v_add_f32 v102, v102, v3
    s_add_u32 m0, s63, 108544
    s_add_u32 s4, s91, 1818624
    buffer_load_dwordx4 v9, s[52:55], s4 offen lds
    v_add_f32 v103, v103, v4
    v_cvt_pk_bf16_f32 v144, v102, v103
    v_lshlrev_b32 v104, 16, v145
    v_and_b32 v105, 0xffff0000, v145
    v_lshlrev_b32 v3, 16, v151
    s_add_u32 m0, s62, 86016
    s_add_u32 s4, s90, 42112
    buffer_load_dwordx4 v7, s[48:51], s4 offen lds
    v_and_b32 v4, 0xffff0000, v151
    v_add_f32 v104, v104, v3
    v_add_f32 v105, v105, v4
    v_lshlrev_b32 v3, 16, v157
    v_and_b32 v4, 0xffff0000, v157
    s_add_u32 m0, s63, 109568
    s_add_u32 s4, s91, 1843200
    buffer_load_dwordx4 v10, s[52:55], s4 offen lds
    v_add_f32 v104, v104, v3
    v_add_f32 v105, v105, v4
    v_cvt_pk_bf16_f32 v145, v104, v105
    v_lshl_add_u32 v3, v1, 2, s99
    v_mov_b32 v4, s99
    s_add_u32 m0, s62, 87040
    s_add_u32 s4, s90, 52352
    buffer_load_dwordx4 v8, s[48:51], s4 offen lds
    s_waitcnt vmcnt(11)
    s_waitcnt vmcnt(10)
    v_cmp_ne_u32 vcc, s78, v158
    s_nop 1
    s_cbranch_vccz PDONE_29
    s_mov_b32 s4, 0
POLL_28:
    buffer_load_dword v158, v159, s[64:67], s7 offen sc1
    s_waitcnt vmcnt(0)
    v_cmp_ne_u32 vcc, s78, v158
    s_add_u32 s4, s4, 1
    s_nop 0
    s_cbranch_vccz PDONE_29
    s_cmp_lt_u32 s4, 0x20000
    s_cbranch_scc1 POLL_28
PDONE_29:
    s_barrier
    s_add_u32 m0, s59, 0
    s_add_u32 s4, s82, 0
    buffer_load_dwordx4 v9, s[64:67], s4 offen sc1 lds
    s_add_u32 m0, s59, 1024
    s_add_u32 s4, s82, 24576
    buffer_load_dwordx4 v10, s[64:67], s4 offen sc1 lds
L_LDJ:
    ds_write_b32 v165, v80
    s_cmp_ge_u32 s73, 20
    s_cbranch_scc1 L_NOCONV
    s_lshl_b32 s4, s96, 14
    s_lshl_b32 s7, s83, 12
    s_add_u32 s4, s4, s7
    s_add_u32 s4, s4, 1048576
    s_add_u32 m0, s7, 20480
    s_nop 0
    buffer_load_dwordx4 v6, s[64:67], s4 offen offset:0 sc1 lds
    buffer_load_dwordx4 v6, s[64:67], s4 offen offset:1024 sc1 lds
    buffer_load_dwordx4 v6, s[64:67], s4 offen offset:2048 sc1 lds
    buffer_load_dwordx4 v6, s[64:67], s4 offen offset:3072 sc1 lds
    v_lshl_add_u32 v5, v1, 3, s99
    s_waitcnt vmcnt(6) lgkmcnt(0)
    s_barrier
    s_waitcnt vmcnt(4)
    ds_write_b32 v17, v17 offset:96
    s_waitcnt vmcnt(0)
    ds_read_b64_tr_b16 v[32:33], v72 offset:0
    ds_read_b64_tr_b16 v[34:35], v72 offset:512
    ds_read_b64_tr_b16 v[36:37], v72 offset:1024
    ds_read_b64_tr_b16 v[38:39], v72 offset:1536
    ds_read_b64_tr_b16 v[40:41], v72 offset:2048
    ds_read_b64_tr_b16 v[42:43], v72 offset:2560
    ds_read_b64_tr_b16 v[44:45], v72 offset:3072
    ds_read_b64_tr_b16 v[46:47], v72 offset:3584
    ds_write_b64 v138, v[80:81]
    ds_write_b64 v79, v[140:141]
    ds_write_b64 v136, v[142:143] offset:512
    ds_write_b32 v137, v144 offset:1024
    ds_write_b32 v137, v145 offset:1088
    ds_read_b32 v90, v4 offset:1024
    ds_read2_b32 v[88:89], v3 offset0:192 offset1:193
    ds_read2_b32 v[86:87], v3 offset0:128 offset1:129
    ds_read_b64 v[82:83], v5
    ds_read_b64 v[84:85], v5 offset:8
    ds_read2_b32 v[166:167], v164 offset0:0 offset1:1
    ds_read2_b32 v[168:169], v164 offset0:2 offset1:3
    ds_read_b32 v170, v164 offset:16
    s_mov_b64 exec, 0xffff
    ds_read_b64 v[92:93], v163
    s_mov_b64 exec, -1
    s_waitcnt lgkmcnt(7)
    v_perm_b32 v94, v89, v88, s22
    v_mov_b32 v95, v88
    v_perm_b32 v96, v89, v88, s23
    v_perm_b32 v97, v89, v88, s24
    v_perm_b32 v98, v89, v88, s22
    v_perm_b32 v99, v89, v88, s23
    v_perm_b32 v100, v89, v88, s25
    v_perm_b32 v101, v89, v88, s24
    v_mov_b32 v102, v88
    v_perm_b32 v103, v89, v88, s23
    v_perm_b32 v104, v89, v88, s24
    v_perm_b32 v105, v89, v88, s24
    v_perm_b32 v106, v89, v88, s23
    v_perm_b32 v107, v89, v88, s25
    v_perm_b32 v108, v89, v88, s24
    v_perm_b32 v109, v89, v88, s24
    s_mov_b32 exec_lo, 0
    s_mov_b32 exec_hi, 0x80000000
    s_waitcnt lgkmcnt(4)
    v_perm_b32 v85, v84, v84, s23
    v_perm_b32 v84, v84, v84, s22
    v_perm_b32 v87, v87, v87, s22
    s_mov_b64 exec, -1
    v_perm_b32 v110, v87, v86, s22
    v_perm_b32 v111, v87, v86, s25
    v_mov_b32 v112, v86
    v_perm_b32 v113, v87, v86, s24
    v_perm_b32 v114, v87, v86, s25
    v_perm_b32 v115, v87, v86, s24
    v_perm_b32 v116, v87, v86, s24
    v_mov_b32 v117, v87
    v_mov_b32 v118, v82
    v_mov_b32 v119, v83
    v_perm_b32 v120, v83, v82, s25
    v_perm_b32 v121, v84, v83, s25
    v_mov_b32 v122, v83
    v_mov_b32 v123, v84
    v_perm_b32 v124, v84, v83, s25
    v_perm_b32 v125, v85, v84, s25
    s_waitcnt lgkmcnt(2)
    v_perm_b32 v128, v169, v168, s26
    v_perm_b32 v129, v167, v166, s26
    s_waitcnt lgkmcnt(1)
    v_perm_b32 v130, v170, v169, s27
    v_perm_b32 v131, v168, v167, s27
    v_and_b32 v128, v128, v126
    v_and_b32 v129, v129, v127
    v_and_b32 v130, v130, v126
    v_and_b32 v131, v131, v127
    v_perm_b32 v3, v90, v90, s22
    v_and_b32 v132, v3, v134
    v_and_b32 v133, v3, v135
    ds_write_b64 v73, v[32:33] offset:896
    ds_write_b64 v73, v[34:35] offset:768
    ds_write_b64 v73, v[36:37] offset:640
    ds_write_b64 v73, v[38:39] offset:512
    ds_write_b64 v73, v[40:41] offset:384
    ds_write_b64 v73, v[42:43] offset:256
    ds_write_b64 v73, v[44:45] offset:128
    ds_write_b64 v73, v[46:47] offset:0
    ds_write_b64 v74, v[80:81] offset:4096
    ds_write_b32 v17, v17 offset:80
    s_setprio 3
    s_add_u32 m0, s14, 0
    s_nop 0
    buffer_load_dwordx4 v6, s[64:67], s34 offen offset:0 sc1 lds
    buffer_load_dwordx4 v6, s[64:67], s34 offen offset:1024 sc1 lds
    buffer_load_dwordx4 v6, s[64:67], s34 offen offset:2048 sc1 lds
    buffer_load_dwordx4 v6, s[64:67], s34 offen offset:3072 sc1 lds
    s_add_u32 m0, s14, 4096
    s_nop 0
    buffer_load_dwordx4 v19, s[64:67], s34 offen offset:0 sc1 lds
    s_add_u32 m0, s19, 40960
    s_nop 0
    buffer_load_dwordx4 v6, s[64:67], s35 offen offset:0 sc1 lds
    buffer_load_dwordx4 v6, s[64:67], s35 offen offset:1024 sc1 lds
    buffer_load_dwordx4 v6, s[64:67], s35 offen offset:2048 sc1 lds
    buffer_load_dwordx4 v6, s[64:67], s35 offen offset:3072 sc1 lds
    s_add_u32 m0, s19, 45056
    s_nop 0
    buffer_load_dwordx4 v19, s[64:67], s35 offen offset:0 sc1 lds
    s_add_u32 m0, s19, 46080
    s_nop 0
    buffer_load_dwordx4 v6, s[64:67], s36 offen offset:0 sc1 lds
    buffer_load_dwordx4 v6, s[64:67], s36 offen offset:1024 sc1 lds
    buffer_load_dwordx4 v6, s[64:67], s36 offen offset:2048 sc1 lds
    buffer_load_dwordx4 v6, s[64:67], s36 offen offset:3072 sc1 lds
    s_add_u32 m0, s19, 50176
    s_nop 0
    buffer_load_dwordx4 v19, s[64:67], s36 offen offset:0 sc1 lds
    s_setprio 0
    v_mov_b32 v5, 145024
    s_mov_b32 s4, 0
LW_34:
    ds_read_b128 v[32:35], v5 offset:64
    s_waitcnt lgkmcnt(0)
    v_min_u32 v32, v32, v33
    v_min_u32 v32, v32, v34
    v_min_u32 v32, v32, v35
    v_cmp_eq_u32 vcc, 0, v32
    s_add_u32 s4, s4, 1
    s_nop 0
    s_cbranch_vccz LWD_35
    s_sleep 1
    s_cmp_lt_u32 s4, 0x80000
    s_cbranch_scc1 LW_34
LWD_35:
    ds_write_b128 v77, v[94:97] offset:1056
    ds_write_b128 v77, v[98:101] offset:3680
    ds_write_b128 v77, v[102:105] offset:6304
    ds_write_b128 v77, v[106:109] offset:8928
    ds_write_b64 v76, v[110:111] offset:544
    ds_write_b64 v76, v[112:113] offset:3168
    ds_write_b64 v76, v[114:115] offset:5792
    ds_write_b64 v76, v[116:117] offset:8416
    ds_write_b64 v76, v[118:119] offset:32
    ds_write_b64 v76, v[120:121] offset:2656
    ds_write_b64 v76, v[122:123] offset:5280
    ds_write_b64 v76, v[124:125] offset:7904
    ds_write_b64 v78, v[132:133] offset:2080
    ds_write_b64 v78, v[80:81] offset:2208
    ds_write_b64 v78, v[80:81] offset:2400
    ds_write_b64 v78, v[128:129] offset:2144
    ds_write_b64 v78, v[130:131] offset:2336
    s_mov_b64 exec, 0xffff
    ds_write_b64 v75, v[92:93]
    s_mov_b64 exec, -1
    s_mov_b32 s4, 0
LW_36:
    ds_read_b128 v[32:35], v5 offset:80
    s_waitcnt lgkmcnt(0)
    v_min_u32 v32, v32, v33
    v_min_u32 v32, v32, v34
    v_min_u32 v32, v32, v35
    v_cmp_eq_u32 vcc, 0, v32
    s_add_u32 s4, s4, 1
    s_nop 0
    s_cbranch_vccz LWD_37
    s_sleep 1
    s_cmp_lt_u32 s4, 0x80000
    s_cbranch_scc1 LW_36
LWD_37:
    ds_read_b128 v[96:99], v2 offset:3584
    ds_read_b64 v[64:65], v0 offset:0
    ds_read_b64 v[66:67], v0 offset:8
    ds_read_b128 v[100:103], v2 offset:3072
    ds_read_b64 v[68:69], v0 offset:512
    ds_read_b64 v[70:71], v0 offset:520
    ds_read_b128 v[104:107], v2 offset:2560
    ds_read_b64 v[72:73], v0 offset:1024
    ds_read_b64 v[74:75], v0 offset:1032
    ds_read_b128 v[108:111], v2 offset:2048
    ds_read_b64 v[76:77], v0 offset:1536
    ds_read_b64 v[78:79], v0 offset:1544
    ds_read_b128 v[112:115], v2 offset:1536
    ds_read_b128 v[116:119], v2 offset:1024
    ds_read_b128 v[120:123], v2 offset:512
    ds_read_b128 v[124:127], v2 offset:0
    ds_read_b64 v[8:9], v0 offset:2048
    ds_read_b64 v[10:11], v0 offset:2056
    ds_read_b128 v[160:163], v2 offset:3600
    ds_read_b128 v[164:167], v2 offset:3088
    ds_read_b128 v[168:171], v2 offset:2576
    ds_read_b128 v[172:175], v2 offset:2064
    ds_read_b64 v[208:209], v16 offset:2144
    ds_read_b64 v[210:211], v16 offset:2176
    ds_read_b64 v[212:213], v16 offset:2208
    ds_read_b64 v[214:215], v16 offset:2240
    ds_read_b64 v[216:217], v16 offset:2272
    ds_read_b64 v[218:219], v16 offset:2336
    ds_read_b64 v[220:221], v16 offset:2368
    ds_read_b64 v[222:223], v16 offset:2400
    ds_read_b64 v[224:225], v16 offset:2432
    ds_read_b64 v[226:227], v16 offset:2464
    s_mov_b32 s4, 0
LW_38:
    ds_read_b32 v3, v17 offset:0
    s_waitcnt lgkmcnt(0)
    v_cmp_eq_u32 vcc, 0, v3
    s_add_u32 s4, s4, 1
    s_nop 0
    s_cbranch_vccz LWD_39
    s_sleep 1
    s_cmp_lt_u32 s4, 0x80000
    s_cbranch_scc1 LW_38
LWD_39:
    s_setprio 1
    v_mfma_f32_16x16x32_bf16 v[176:179], v[96:99], v[24:27], 0
    ds_read_b128 v[128:131], v2 offset:3648
    v_mfma_f32_16x16x32_bf16 v[180:183], v[100:103], v[24:27], 0
    ds_read_b64 v[80:81], v0 offset:64
    v_mfma_f32_16x16x32_bf16 v[184:187], v[104:107], v[24:27], 0
    ds_read_b64 v[82:83], v0 offset:72
    v_mfma_f32_16x16x32_bf16 v[188:191], v[108:111], v[24:27], 0
    ds_read_b128 v[132:135], v2 offset:3136
    v_mfma_f32_16x16x32_bf16 v[192:195], v[160:163], v[28:31], 0
    ds_read_b64 v[84:85], v0 offset:576
    v_mfma_f32_16x16x32_bf16 v[196:199], v[164:167], v[28:31], 0
    ds_read_b64 v[86:87], v0 offset:584
    v_mfma_f32_16x16x32_bf16 v[200:203], v[168:171], v[28:31], 0
    ds_read_b128 v[136:139], v2 offset:2624
    v_mfma_f32_16x16x32_bf16 v[204:207], v[172:175], v[28:31], 0
    ds_read_b64 v[88:89], v0 offset:1088
    v_mfma_f32_16x16x32_bf16 v[32:35], v[20:23], v[96:99], 0
    ds_read_b64 v[90:91], v0 offset:1096
    v_mfma_f32_16x16x32_bf16 v[36:39], v[20:23], v[100:103], 0
    ds_read_b128 v[140:143], v2 offset:2112
    v_mfma_f32_16x16x32_bf16 v[40:43], v[20:23], v[104:107], 0
    ds_read_b64 v[92:93], v0 offset:1600
    v_mfma_f32_16x16x32_bf16 v[44:47], v[20:23], v[108:111], 0
    ds_read_b64 v[94:95], v0 offset:1608
    v_mfma_f32_16x16x32_bf16 v[48:51], v[20:23], v[112:115], 0
    ds_read_b128 v[144:147], v2 offset:1600
    v_mfma_f32_16x16x32_bf16 v[52:55], v[20:23], v[116:119], 0
    ds_read_b128 v[148:151], v2 offset:1088
    v_mfma_f32_16x16x32_bf16 v[56:59], v[20:23], v[120:123], 0
    ds_read_b128 v[152:155], v2 offset:576
    v_mfma_f32_16x16x32_bf16 v[60:63], v[20:23], v[124:127], 0
    ds_read_b128 v[156:159], v2 offset:64
    v_mfma_f32_16x16x32_bf16 v[48:51], v[8:11], v[96:99], v[48:51]
    v_cvt_pk_bf16_f32 v160, v176, v177
    v_mfma_f32_16x16x32_bf16 v[52:55], v[8:11], v[100:103], v[52:55]
    v_cvt_pk_bf16_f32 v161, v178, v179
    v_mfma_f32_16x16x32_bf16 v[56:59], v[8:11], v[104:107], v[56:59]
    v_cvt_pk_bf16_f32 v162, v180, v181
    v_mfma_f32_16x16x32_bf16 v[60:63], v[8:11], v[108:111], v[60:63]
    v_cvt_pk_bf16_f32 v163, v182, v183
    v_mfma_f32_16x16x32_bf16 v[32:35], v[64:67], v[96:99], v[32:35]
    v_cvt_pk_bf16_f32 v164, v184, v185
    v_mfma_f32_16x16x32_bf16 v[36:39], v[64:67], v[100:103], v[36:39]
    v_cvt_pk_bf16_f32 v165, v186, v187
    v_mfma_f32_16x16x32_bf16 v[40:43], v[64:67], v[104:107], v[40:43]
    v_cvt_pk_bf16_f32 v166, v188, v189
    v_mfma_f32_16x16x32_bf16 v[44:47], v[64:67], v[108:111], v[44:47]
    v_cvt_pk_bf16_f32 v167, v190, v191
    v_mfma_f32_16x16x32_bf16 v[48:51], v[64:67], v[112:115], v[48:51]
    v_cvt_pk_bf16_f32 v168, v192, v193
    v_mfma_f32_16x16x32_bf16 v[52:55], v[64:67], v[116:119], v[52:55]
    v_cvt_pk_bf16_f32 v169, v194, v195
    v_mfma_f32_16x16x32_bf16 v[56:59], v[64:67], v[120:123], v[56:59]
    v_cvt_pk_bf16_f32 v170, v196, v197
    v_mfma_f32_16x16x32_bf16 v[60:63], v[64:67], v[124:127], v[60:63]
    v_cvt_pk_bf16_f32 v171, v198, v199
    v_mfma_f32_16x16x32_bf16 v[36:39], v[68:71], v[96:99], v[36:39]
    v_cvt_pk_bf16_f32 v172, v200, v201
    v_mfma_f32_16x16x32_bf16 v[40:43], v[68:71], v[100:103], v[40:43]
    v_cvt_pk_bf16_f32 v173, v202, v203
    v_mfma_f32_16x16x32_bf16 v[44:47], v[68:71], v[104:107], v[44:47]
    v_cvt_pk_bf16_f32 v174, v204, v205
    v_mfma_f32_16x16x32_bf16 v[48:51], v[68:71], v[108:111], v[48:51]
    v_cvt_pk_bf16_f32 v175, v206, v207
    v_mfma_f32_16x16x32_bf16 v[52:55], v[68:71], v[112:115], v[52:55]
    v_mfma_f32_16x16x32_bf16 v[56:59], v[68:71], v[116:119], v[56:59]
    v_mfma_f32_16x16x32_bf16 v[60:63], v[68:71], v[120:123], v[60:63]
    v_mfma_f32_16x16x32_bf16 v[40:43], v[72:75], v[96:99], v[40:43]
    v_mfma_f32_16x16x32_bf16 v[44:47], v[72:75], v[100:103], v[44:47]
    v_mfma_f32_16x16x32_bf16 v[48:51], v[72:75], v[104:107], v[48:51]
    v_mfma_f32_16x16x32_bf16 v[52:55], v[72:75], v[108:111], v[52:55]
    v_mfma_f32_16x16x32_bf16 v[56:59], v[72:75], v[112:115], v[56:59]
    v_mfma_f32_16x16x32_bf16 v[60:63], v[72:75], v[116:119], v[60:63]
    v_mfma_f32_16x16x32_bf16 v[44:47], v[76:79], v[96:99], v[44:47]
    v_mfma_f32_16x16x32_bf16 v[48:51], v[76:79], v[100:103], v[48:51]
    v_mfma_f32_16x16x32_bf16 v[52:55], v[76:79], v[104:107], v[52:55]
    v_mfma_f32_16x16x32_bf16 v[56:59], v[76:79], v[108:111], v[56:59]
    v_mfma_f32_16x16x32_bf16 v[60:63], v[76:79], v[112:115], v[60:63]
    s_waitcnt lgkmcnt(0)
    v_mfma_f32_16x16x32_bf16 v[48:51], v[160:163], v[214:217], v[48:51]
    ds_read_b128 v[96:99], v2 offset:3712
    v_mfma_f32_16x16x32_bf16 v[52:55], v[160:163], v[212:215], v[52:55]
    ds_read_b64 v[64:65], v0 offset:128
    v_mfma_f32_16x16x32_bf16 v[56:59], v[160:163], v[210:213], v[56:59]
    ds_read_b64 v[66:67], v0 offset:136
    v_mfma_f32_16x16x32_bf16 v[60:63], v[160:163], v[208:211], v[60:63]
    ds_read_b128 v[100:103], v2 offset:3200
    v_mfma_f32_16x16x32_bf16 v[56:59], v[164:167], v[214:217], v[56:59]
    ds_read_b64 v[68:69], v0 offset:640
    v_mfma_f32_16x16x32_bf16 v[60:63], v[164:167], v[212:215], v[60:63]
    ds_read_b64 v[70:71], v0 offset:648
    v_mfma_f32_16x16x32_bf16 v[48:51], v[168:171], v[224:227], v[48:51]
    ds_read_b128 v[104:107], v2 offset:2688
    v_mfma_f32_16x16x32_bf16 v[52:55], v[168:171], v[222:225], v[52:55]
    ds_read_b64 v[72:73], v0 offset:1152
    v_mfma_f32_16x16x32_bf16 v[56:59], v[168:171], v[220:223], v[56:59]
    ds_read_b64 v[74:75], v0 offset:1160
    v_mfma_f32_16x16x32_bf16 v[60:63], v[168:171], v[218:221], v[60:63]
    ds_read_b128 v[108:111], v2 offset:2176
    v_mfma_f32_16x16x32_bf16 v[56:59], v[172:175], v[224:227], v[56:59]
    ds_read_b64 v[76:77], v0 offset:1664
    v_mfma_f32_16x16x32_bf16 v[60:63], v[172:175], v[222:225], v[60:63]
    ds_read_b64 v[78:79], v0 offset:1672
    v_mfma_f32_16x16x32_bf16 v[32:35], v[80:83], v[128:131], v[32:35]
    ds_read_b128 v[112:115], v2 offset:1664
    v_mfma_f32_16x16x32_bf16 v[36:39], v[80:83], v[132:135], v[36:39]
    ds_read_b128 v[116:119], v2 offset:1152
    v_mfma_f32_16x16x32_bf16 v[40:43], v[80:83], v[136:139], v[40:43]
    ds_read_b128 v[120:123], v2 offset:640
    v_mfma_f32_16x16x32_bf16 v[44:47], v[80:83], v[140:143], v[44:47]
    ds_read_b128 v[124:127], v2 offset:128
    v_mfma_f32_16x16x32_bf16 v[48:51], v[80:83], v[144:147], v[48:51]
    v_mfma_f32_16x16x32_bf16 v[52:55], v[80:83], v[148:151], v[52:55]
    v_mfma_f32_16x16x32_bf16 v[56:59], v[80:83], v[152:155], v[56:59]
    v_mfma_f32_16x16x32_bf16 v[60:63], v[80:83], v[156:159], v[60:63]
    v_mfma_f32_16x16x32_bf16 v[36:39], v[84:87], v[128:131], v[36:39]
    v_mfma_f32_16x16x32_bf16 v[40:43], v[84:87], v[132:135], v[40:43]
    v_mfma_f32_16x16x32_bf16 v[44:47], v[84:87], v[136:139], v[44:47]
    v_mfma_f32_16x16x32_bf16 v[48:51], v[84:87], v[140:143], v[48:51]
    v_mfma_f32_16x16x32_bf16 v[52:55], v[84:87], v[144:147], v[52:55]
    v_mfma_f32_16x16x32_bf16 v[56:59], v[84:87], v[148:151], v[56:59]
    v_mfma_f32_16x16x32_bf16 v[60:63], v[84:87], v[152:155], v[60:63]
    v_mfma_f32_16x16x32_bf16 v[40:43], v[88:91], v[128:131], v[40:43]
    v_mfma_f32_16x16x32_bf16 v[44:47], v[88:91], v[132:135], v[44:47]
    v_mfma_f32_16x16x32_bf16 v[48:51], v[88:91], v[136:139], v[48:51]
    v_mfma_f32_16x16x32_bf16 v[52:55], v[88:91], v[140:143], v[52:55]
    v_mfma_f32_16x16x32_bf16 v[56:59], v[88:91], v[144:147], v[56:59]
    v_mfma_f32_16x16x32_bf16 v[60:63], v[88:91], v[148:151], v[60:63]
    v_mfma_f32_16x16x32_bf16 v[44:47], v[92:95], v[128:131], v[44:47]
    v_mfma_f32_16x16x32_bf16 v[48:51], v[92:95], v[132:135], v[48:51]
    v_mfma_f32_16x16x32_bf16 v[52:55], v[92:95], v[136:139], v[52:55]
    v_mfma_f32_16x16x32_bf16 v[56:59], v[92:95], v[140:143], v[56:59]
    v_mfma_f32_16x16x32_bf16 v[60:63], v[92:95], v[144:147], v[60:63]
    s_waitcnt lgkmcnt(0)
    s_waitcnt vmcnt(0)
    ds_write_b32 v17, v17 offset:16
    v_mfma_f32_16x16x32_bf16 v[32:35], v[64:67], v[96:99], v[32:35]
    ds_read_b128 v[128:131], v2 offset:3776
    v_mfma_f32_16x16x32_bf16 v[36:39], v[64:67], v[100:103], v[36:39]
    ds_read_b64 v[80:81], v0 offset:192
    v_mfma_f32_16x16x32_bf16 v[40:43], v[64:67], v[104:107], v[40:43]
    ds_read_b64 v[82:83], v0 offset:200
    v_mfma_f32_16x16x32_bf16 v[44:47], v[64:67], v[108:111], v[44:47]
    ds_read_b128 v[132:135], v2 offset:3264
    v_mfma_f32_16x16x32_bf16 v[48:51], v[64:67], v[112:115], v[48:51]
    ds_read_b64 v[84:85], v0 offset:704
    v_mfma_f32_16x16x32_bf16 v[52:55], v[64:67], v[116:119], v[52:55]
    ds_read_b64 v[86:87], v0 offset:712
    v_mfma_f32_16x16x32_bf16 v[56:59], v[64:67], v[120:123], v[56:59]
    ds_read_b128 v[136:139], v2 offset:2752
    v_mfma_f32_16x16x32_bf16 v[60:63], v[64:67], v[124:127], v[60:63]
    ds_read_b64 v[88:89], v0 offset:1216
    v_mfma_f32_16x16x32_bf16 v[36:39], v[68:71], v[96:99], v[36:39]
    ds_read_b64 v[90:91], v0 offset:1224
    v_mfma_f32_16x16x32_bf16 v[40:43], v[68:71], v[100:103], v[40:43]
    ds_read_b128 v[140:143], v2 offset:2240
    v_mfma_f32_16x16x32_bf16 v[44:47], v[68:71], v[104:107], v[44:47]
    ds_read_b64 v[92:93], v0 offset:1728
    v_mfma_f32_16x16x32_bf16 v[48:51], v[68:71], v[108:111], v[48:51]
    ds_read_b64 v[94:95], v0 offset:1736
    v_mfma_f32_16x16x32_bf16 v[52:55], v[68:71], v[112:115], v[52:55]
    ds_read_b128 v[144:147], v2 offset:1728
    v_mfma_f32_16x16x32_bf16 v[56:59], v[68:71], v[116:119], v[56:59]
    ds_read_b128 v[148:151], v2 offset:1216
    v_mfma_f32_16x16x32_bf16 v[60:63], v[68:71], v[120:123], v[60:63]
    ds_read_b128 v[152:155], v2 offset:704
    v_mfma_f32_16x16x32_bf16 v[40:43], v[72:75], v[96:99], v[40:43]
    ds_read_b128 v[156:159], v2 offset:192
    v_mfma_f32_16x16x32_bf16 v[44:47], v[72:75], v[100:103], v[44:47]
    v_mfma_f32_16x16x32_bf16 v[48:51], v[72:75], v[104:107], v[48:51]
    v_mfma_f32_16x16x32_bf16 v[52:55], v[72:75], v[108:111], v[52:55]
    v_mfma_f32_16x16x32_bf16 v[56:59], v[72:75], v[112:115], v[56:59]
    v_mfma_f32_16x16x32_bf16 v[60:63], v[72:75], v[116:119], v[60:63]
    v_mfma_f32_16x16x32_bf16 v[44:47], v[76:79], v[96:99], v[44:47]
    v_mfma_f32_16x16x32_bf16 v[48:51], v[76:79], v[100:103], v[48:51]
    v_mfma_f32_16x16x32_bf16 v[52:55], v[76:79], v[104:107], v[52:55]
    v_mfma_f32_16x16x32_bf16 v[56:59], v[76:79], v[108:111], v[56:59]
    v_mfma_f32_16x16x32_bf16 v[60:63], v[76:79], v[112:115], v[60:63]
    s_waitcnt lgkmcnt(0)
    v_mfma_f32_16x16x32_bf16 v[32:35], v[80:83], v[128:131], v[32:35]
    ds_read_b128 v[96:99], v2 offset:3840
    v_mfma_f32_16x16x32_bf16 v[36:39], v[80:83], v[132:135], v[36:39]
    ds_read_b64 v[64:65], v0 offset:256
    v_mfma_f32_16x16x32_bf16 v[40:43], v[80:83], v[136:139], v[40:43]
    ds_read_b64 v[66:67], v0 offset:264
    v_mfma_f32_16x16x32_bf16 v[44:47], v[80:83], v[140:143], v[44:47]
    ds_read_b128 v[100:103], v2 offset:3328
    v_mfma_f32_16x16x32_bf16 v[48:51], v[80:83], v[144:147], v[48:51]
    ds_read_b64 v[68:69], v0 offset:768
    v_mfma_f32_16x16x32_bf16 v[52:55], v[80:83], v[148:151], v[52:55]
    ds_read_b64 v[70:71], v0 offset:776
    v_mfma_f32_16x16x32_bf16 v[56:59], v[80:83], v[152:155], v[56:59]
    ds_read_b128 v[104:107], v2 offset:2816
    v_mfma_f32_16x16x32_bf16 v[60:63], v[80:83], v[156:159], v[60:63]
    ds_read_b64 v[72:73], v0 offset:1280
    v_mfma_f32_16x16x32_bf16 v[36:39], v[84:87], v[128:131], v[36:39]
    ds_read_b64 v[74:75], v0 offset:1288
    v_mfma_f32_16x16x32_bf16 v[40:43], v[84:87], v[132:135], v[40:43]
    ds_read_b128 v[108:111], v2 offset:2304
    v_mfma_f32_16x16x32_bf16 v[44:47], v[84:87], v[136:139], v[44:47]
    ds_read_b64 v[76:77], v0 offset:1792
    v_mfma_f32_16x16x32_bf16 v[48:51], v[84:87], v[140:143], v[48:51]
    ds_read_b64 v[78:79], v0 offset:1800
    v_mfma_f32_16x16x32_bf16 v[52:55], v[84:87], v[144:147], v[52:55]
    ds_read_b128 v[112:115], v2 offset:1792
    v_mfma_f32_16x16x32_bf16 v[56:59], v[84:87], v[148:151], v[56:59]
    ds_read_b128 v[116:119], v2 offset:1280
    v_mfma_f32_16x16x32_bf16 v[60:63], v[84:87], v[152:155], v[60:63]
    ds_read_b128 v[120:123], v2 offset:768
    v_mfma_f32_16x16x32_bf16 v[40:43], v[88:91], v[128:131], v[40:43]
    ds_read_b128 v[124:127], v2 offset:256
    v_mfma_f32_16x16x32_bf16 v[44:47], v[88:91], v[132:135], v[44:47]
    v_mfma_f32_16x16x32_bf16 v[48:51], v[88:91], v[136:139], v[48:51]
    v_mfma_f32_16x16x32_bf16 v[52:55], v[88:91], v[140:143], v[52:55]
    v_mfma_f32_16x16x32_bf16 v[56:59], v[88:91], v[144:147], v[56:59]
    v_mfma_f32_16x16x32_bf16 v[60:63], v[88:91], v[148:151], v[60:63]
    v_mfma_f32_16x16x32_bf16 v[44:47], v[92:95], v[128:131], v[44:47]
    v_mfma_f32_16x16x32_bf16 v[48:51], v[92:95], v[132:135], v[48:51]
    v_mfma_f32_16x16x32_bf16 v[52:55], v[92:95], v[136:139], v[52:55]
    v_mfma_f32_16x16x32_bf16 v[56:59], v[92:95], v[140:143], v[56:59]
    v_mfma_f32_16x16x32_bf16 v[60:63], v[92:95], v[144:147], v[60:63]
    s_waitcnt lgkmcnt(0)
    v_mfma_f32_16x16x32_bf16 v[32:35], v[64:67], v[96:99], v[32:35]
    ds_read_b128 v[128:131], v2 offset:3904
    v_mfma_f32_16x16x32_bf16 v[36:39], v[64:67], v[100:103], v[36:39]
    ds_read_b64 v[80:81], v0 offset:320
    v_mfma_f32_16x16x32_bf16 v[40:43], v[64:67], v[104:107], v[40:43]
    ds_read_b64 v[82:83], v0 offset:328
    v_mfma_f32_16x16x32_bf16 v[44:47], v[64:67], v[108:111], v[44:47]
    ds_read_b128 v[132:135], v2 offset:3392
    v_mfma_f32_16x16x32_bf16 v[48:51], v[64:67], v[112:115], v[48:51]
    ds_read_b64 v[84:85], v0 offset:832
    v_mfma_f32_16x16x32_bf16 v[52:55], v[64:67], v[116:119], v[52:55]
    ds_read_b64 v[86:87], v0 offset:840
    v_mfma_f32_16x16x32_bf16 v[56:59], v[64:67], v[120:123], v[56:59]
    ds_read_b128 v[136:139], v2 offset:2880
    v_mfma_f32_16x16x32_bf16 v[60:63], v[64:67], v[124:127], v[60:63]
    ds_read_b64 v[88:89], v0 offset:1344
    v_mfma_f32_16x16x32_bf16 v[36:39], v[68:71], v[96:99], v[36:39]
    ds_read_b64 v[90:91], v0 offset:1352
    v_mfma_f32_16x16x32_bf16 v[40:43], v[68:71], v[100:103], v[40:43]
    ds_read_b128 v[140:143], v2 offset:2368
    v_mfma_f32_16x16x32_bf16 v[44:47], v[68:71], v[104:107], v[44:47]
    ds_read_b64 v[92:93], v0 offset:1856
    v_mfma_f32_16x16x32_bf16 v[48:51], v[68:71], v[108:111], v[48:51]
    ds_read_b64 v[94:95], v0 offset:1864
    v_mfma_f32_16x16x32_bf16 v[52:55], v[68:71], v[112:115], v[52:55]
    ds_read_b128 v[144:147], v2 offset:1856
    v_mfma_f32_16x16x32_bf16 v[56:59], v[68:71], v[116:119], v[56:59]
    ds_read_b128 v[148:151], v2 offset:1344
    v_mfma_f32_16x16x32_bf16 v[60:63], v[68:71], v[120:123], v[60:63]
    ds_read_b128 v[152:155], v2 offset:832
    v_mfma_f32_16x16x32_bf16 v[40:43], v[72:75], v[96:99], v[40:43]
    ds_read_b128 v[156:159], v2 offset:320
    v_mfma_f32_16x16x32_bf16 v[44:47], v[72:75], v[100:103], v[44:47]
    v_mfma_f32_16x16x32_bf16 v[48:51], v[72:75], v[104:107], v[48:51]
    v_mfma_f32_16x16x32_bf16 v[52:55], v[72:75], v[108:111], v[52:55]
    v_mfma_f32_16x16x32_bf16 v[56:59], v[72:75], v[112:115], v[56:59]
    v_mfma_f32_16x16x32_bf16 v[60:63], v[72:75], v[116:119], v[60:63]
    v_mfma_f32_16x16x32_bf16 v[44:47], v[76:79], v[96:99], v[44:47]
    v_mfma_f32_16x16x32_bf16 v[48:51], v[76:79], v[100:103], v[48:51]
    v_mfma_f32_16x16x32_bf16 v[52:55], v[76:79], v[104:107], v[52:55]
    v_mfma_f32_16x16x32_bf16 v[56:59], v[76:79], v[108:111], v[56:59]
    v_mfma_f32_16x16x32_bf16 v[60:63], v[76:79], v[112:115], v[60:63]
    s_waitcnt lgkmcnt(0)
    v_mfma_f32_16x16x32_bf16 v[32:35], v[80:83], v[128:131], v[32:35]
    ds_read_b128 v[96:99], v2 offset:3968
    v_mfma_f32_16x16x32_bf16 v[36:39], v[80:83], v[132:135], v[36:39]
    ds_read_b64 v[64:65], v0 offset:384
    v_mfma_f32_16x16x32_bf16 v[40:43], v[80:83], v[136:139], v[40:43]
    ds_read_b64 v[66:67], v0 offset:392
    v_mfma_f32_16x16x32_bf16 v[44:47], v[80:83], v[140:143], v[44:47]
    ds_read_b128 v[100:103], v2 offset:3456
    v_mfma_f32_16x16x32_bf16 v[48:51], v[80:83], v[144:147], v[48:51]
    ds_read_b64 v[68:69], v0 offset:896
    v_mfma_f32_16x16x32_bf16 v[52:55], v[80:83], v[148:151], v[52:55]
    ds_read_b64 v[70:71], v0 offset:904
    v_mfma_f32_16x16x32_bf16 v[56:59], v[80:83], v[152:155], v[56:59]
    ds_read_b128 v[104:107], v2 offset:2944
    v_mfma_f32_16x16x32_bf16 v[60:63], v[80:83], v[156:159], v[60:63]
    ds_read_b64 v[72:73], v0 offset:1408
    v_mfma_f32_16x16x32_bf16 v[36:39], v[84:87], v[128:131], v[36:39]
    ds_read_b64 v[74:75], v0 offset:1416
    v_mfma_f32_16x16x32_bf16 v[40:43], v[84:87], v[132:135], v[40:43]
    ds_read_b128 v[108:111], v2 offset:2432
    v_mfma_f32_16x16x32_bf16 v[44:47], v[84:87], v[136:139], v[44:47]
    ds_read_b64 v[76:77], v0 offset:1920
    v_mfma_f32_16x16x32_bf16 v[48:51], v[84:87], v[140:143], v[48:51]
    ds_read_b64 v[78:79], v0 offset:1928
    v_mfma_f32_16x16x32_bf16 v[52:55], v[84:87], v[144:147], v[52:55]
    ds_read_b128 v[112:115], v2 offset:1920
    v_mfma_f32_16x16x32_bf16 v[56:59], v[84:87], v[148:151], v[56:59]
    ds_read_b128 v[116:119], v2 offset:1408
    v_mfma_f32_16x16x32_bf16 v[60:63], v[84:87], v[152:155], v[60:63]
    ds_read_b128 v[120:123], v2 offset:896
    v_mfma_f32_16x16x32_bf16 v[40:43], v[88:91], v[128:131], v[40:43]
    ds_read_b128 v[124:127], v2 offset:384
    v_mfma_f32_16x16x32_bf16 v[44:47], v[88:91], v[132:135], v[44:47]
    v_mfma_f32_16x16x32_bf16 v[48:51], v[88:91], v[136:139], v[48:51]
    v_mfma_f32_16x16x32_bf16 v[52:55], v[88:91], v[140:143], v[52:55]
    v_mfma_f32_16x16x32_bf16 v[56:59], v[88:91], v[144:147], v[56:59]
    v_mfma_f32_16x16x32_bf16 v[60:63], v[88:91], v[148:151], v[60:63]
    v_mfma_f32_16x16x32_bf16 v[44:47], v[92:95], v[128:131], v[44:47]
    v_mfma_f32_16x16x32_bf16 v[48:51], v[92:95], v[132:135], v[48:51]
    v_mfma_f32_16x16x32_bf16 v[52:55], v[92:95], v[136:139], v[52:55]
    v_mfma_f32_16x16x32_bf16 v[56:59], v[92:95], v[140:143], v[56:59]
    v_mfma_f32_16x16x32_bf16 v[60:63], v[92:95], v[144:147], v[60:63]
    s_waitcnt lgkmcnt(0)
    v_mfma_f32_16x16x32_bf16 v[32:35], v[64:67], v[96:99], v[32:35]
    ds_read_b128 v[128:131], v2 offset:4032
    v_mfma_f32_16x16x32_bf16 v[36:39], v[64:67], v[100:103], v[36:39]
    ds_read_b64 v[80:81], v0 offset:448
    v_mfma_f32_16x16x32_bf16 v[40:43], v[64:67], v[104:107], v[40:43]
    ds_read_b64 v[82:83], v0 offset:456
    v_mfma_f32_16x16x32_bf16 v[44:47], v[64:67], v[108:111], v[44:47]
    ds_read_b128 v[132:135], v2 offset:3520
    v_mfma_f32_16x16x32_bf16 v[48:51], v[64:67], v[112:115], v[48:51]
    ds_read_b64 v[84:85], v0 offset:960
    v_mfma_f32_16x16x32_bf16 v[52:55], v[64:67], v[116:119], v[52:55]
    ds_read_b64 v[86:87], v0 offset:968
    v_mfma_f32_16x16x32_bf16 v[56:59], v[64:67], v[120:123], v[56:59]
    ds_read_b128 v[136:139], v2 offset:3008
    v_mfma_f32_16x16x32_bf16 v[60:63], v[64:67], v[124:127], v[60:63]
    ds_read_b64 v[88:89], v0 offset:1472
    v_mfma_f32_16x16x32_bf16 v[36:39], v[68:71], v[96:99], v[36:39]
    ds_read_b64 v[90:91], v0 offset:1480
    v_mfma_f32_16x16x32_bf16 v[40:43], v[68:71], v[100:103], v[40:43]
    ds_read_b128 v[140:143], v2 offset:2496
    v_mfma_f32_16x16x32_bf16 v[44:47], v[68:71], v[104:107], v[44:47]
    ds_read_b64 v[92:93], v0 offset:1984
    v_mfma_f32_16x16x32_bf16 v[48:51], v[68:71], v[108:111], v[48:51]
    ds_read_b64 v[94:95], v0 offset:1992
    v_mfma_f32_16x16x32_bf16 v[52:55], v[68:71], v[112:115], v[52:55]
    ds_read_b128 v[144:147], v2 offset:1984
    v_mfma_f32_16x16x32_bf16 v[56:59], v[68:71], v[116:119], v[56:59]
    ds_read_b128 v[148:151], v2 offset:1472
    v_mfma_f32_16x16x32_bf16 v[60:63], v[68:71], v[120:123], v[60:63]
    ds_read_b128 v[152:155], v2 offset:960
    v_mfma_f32_16x16x32_bf16 v[40:43], v[72:75], v[96:99], v[40:43]
    ds_read_b128 v[156:159], v2 offset:448
    v_mfma_f32_16x16x32_bf16 v[44:47], v[72:75], v[100:103], v[44:47]
    v_mfma_f32_16x16x32_bf16 v[48:51], v[72:75], v[104:107], v[48:51]
    v_mfma_f32_16x16x32_bf16 v[52:55], v[72:75], v[108:111], v[52:55]
    v_mfma_f32_16x16x32_bf16 v[56:59], v[72:75], v[112:115], v[56:59]
    v_mfma_f32_16x16x32_bf16 v[60:63], v[72:75], v[116:119], v[60:63]
    v_mfma_f32_16x16x32_bf16 v[44:47], v[76:79], v[96:99], v[44:47]
    v_mfma_f32_16x16x32_bf16 v[48:51], v[76:79], v[100:103], v[48:51]
    v_mfma_f32_16x16x32_bf16 v[52:55], v[76:79], v[104:107], v[52:55]
    v_mfma_f32_16x16x32_bf16 v[56:59], v[76:79], v[108:111], v[56:59]
    v_mfma_f32_16x16x32_bf16 v[60:63], v[76:79], v[112:115], v[60:63]
    s_waitcnt lgkmcnt(0)
    v_mfma_f32_16x16x32_bf16 v[32:35], v[80:83], v[128:131], v[32:35]
    v_mov_b32 v5, 145024
    s_lshl_b32 s7, s96, 14
    s_lshl_b32 s5, s83, 12
    v_mfma_f32_16x16x32_bf16 v[36:39], v[80:83], v[132:135], v[36:39]
    s_add_u32 s7, s7, s5
    s_add_u32 s7, s7, 19922944
    v_mfma_f32_16x16x32_bf16 v[36:39], v[84:87], v[128:131], v[36:39]
    v_mfma_f32_16x16x32_bf16 v[40:43], v[80:83], v[136:139], v[40:43]
    v_mfma_f32_16x16x32_bf16 v[40:43], v[84:87], v[132:135], v[40:43]
    v_mfma_f32_16x16x32_bf16 v[40:43], v[88:91], v[128:131], v[40:43]
    v_cvt_pk_bf16_f32 v176, v32, v34
    v_cvt_pk_bf16_f32 v178, v33, v35
    v_mfma_f32_16x16x32_bf16 v[44:47], v[80:83], v[140:143], v[44:47]
    s_nop 1
    v_cvt_pk_bf16_f32 v177, v36, v38
    v_cvt_pk_bf16_f32 v179, v37, v39
    v_mfma_f32_16x16x32_bf16 v[44:47], v[84:87], v[136:139], v[44:47]
    v_permlane16_swap_b32 v176, v177
    v_permlane16_swap_b32 v178, v179
    v_mfma_f32_16x16x32_bf16 v[44:47], v[88:91], v[132:135], v[44:47]
    ds_write_b64 v15, v[176:177] offset:0
    ds_write_b64 v15, v[178:179] offset:2048
    v_mfma_f32_16x16x32_bf16 v[44:47], v[92:95], v[128:131], v[44:47]
    v_mfma_f32_16x16x32_bf16 v[48:51], v[80:83], v[144:147], v[48:51]
    v_mfma_f32_16x16x32_bf16 v[48:51], v[84:87], v[140:143], v[48:51]
    v_mfma_f32_16x16x32_bf16 v[48:51], v[88:91], v[136:139], v[48:51]
    v_cvt_pk_bf16_f32 v180, v40, v42
    v_cvt_pk_bf16_f32 v182, v41, v43
    v_mfma_f32_16x16x32_bf16 v[48:51], v[92:95], v[132:135], v[48:51]
    s_nop 1
    v_cvt_pk_bf16_f32 v181, v44, v46
    v_cvt_pk_bf16_f32 v183, v45, v47
    v_mfma_f32_16x16x32_bf16 v[52:55], v[80:83], v[148:151], v[52:55]
    v_permlane16_swap_b32 v180, v181
    v_permlane16_swap_b32 v182, v183
    v_mfma_f32_16x16x32_bf16 v[52:55], v[84:87], v[144:147], v[52:55]
    ds_write_b64 v15, v[180:181] offset:512
    ds_write_b64 v15, v[182:183] offset:2560
    v_mfma_f32_16x16x32_bf16 v[52:55], v[88:91], v[140:143], v[52:55]
    v_mfma_f32_16x16x32_bf16 v[52:55], v[92:95], v[136:139], v[52:55]
    v_mfma_f32_16x16x32_bf16 v[56:59], v[80:83], v[152:155], v[56:59]
    v_mfma_f32_16x16x32_bf16 v[56:59], v[84:87], v[148:151], v[56:59]
    v_mfma_f32_16x16x32_bf16 v[56:59], v[88:91], v[144:147], v[56:59]
    v_cvt_pk_bf16_f32 v184, v48, v50
    v_cvt_pk_bf16_f32 v186, v49, v51
    v_mfma_f32_16x16x32_bf16 v[56:59], v[92:95], v[140:143], v[56:59]
    s_nop 1
    v_cvt_pk_bf16_f32 v185, v52, v54
    v_cvt_pk_bf16_f32 v187, v53, v55
    v_mfma_f32_16x16x32_bf16 v[60:63], v[80:83], v[156:159], v[60:63]
    v_permlane16_swap_b32 v184, v185
    v_permlane16_swap_b32 v186, v187
    v_mfma_f32_16x16x32_bf16 v[60:63], v[84:87], v[152:155], v[60:63]
    ds_write_b64 v15, v[184:185] offset:1024
    ds_write_b64 v15, v[186:187] offset:3072
    v_mfma_f32_16x16x32_bf16 v[60:63], v[88:91], v[148:151], v[60:63]
    v_mfma_f32_16x16x32_bf16 v[60:63], v[92:95], v[144:147], v[60:63]
    v_cvt_pk_bf16_f32 v188, v56, v58
    v_cvt_pk_bf16_f32 v190, v57, v59
    s_nop 5
    v_cvt_pk_bf16_f32 v189, v60, v62
    v_cvt_pk_bf16_f32 v191, v61, v63
    s_nop 0
    v_permlane16_swap_b32 v188, v189
    v_permlane16_swap_b32 v190, v191
    ds_write_b64 v15, v[188:189] offset:1536
    ds_write_b64 v15, v[190:191] offset:3584
    ds_write_b32 v17, v17 offset:32
    s_mov_b32 s4, 0
LW_40:
    ds_read_b128 v[64:67], v5 offset:32
    s_waitcnt lgkmcnt(0)
    v_min_u32 v64, v64, v65
    v_min_u32 v64, v64, v66
    v_min_u32 v64, v64, v67
    v_cmp_eq_u32 vcc, 0, v64
    s_add_u32 s4, s4, 1
    s_nop 0
    s_cbranch_vccz LWD_41
    s_sleep 0
    s_cmp_lt_u32 s4, 0x80000
    s_cbranch_scc1 LW_40
LWD_41:
    ds_read_b64_tr_b16 v[192:193], v18 offset:0
    ds_read_b64_tr_b16 v[194:195], v18 offset:2048
    ds_read_b64_tr_b16 v[196:197], v18 offset:128
    ds_read_b64_tr_b16 v[198:199], v18 offset:2176
    ds_read_b64_tr_b16 v[200:201], v18 offset:256
    ds_read_b64_tr_b16 v[202:203], v18 offset:2304
    ds_read_b64_tr_b16 v[204:205], v18 offset:384
    ds_read_b64_tr_b16 v[206:207], v18 offset:2432
    s_waitcnt lgkmcnt(6)
    buffer_store_dwordx4 v[192:195], v6, s[64:67], s7 offen offset:0 sc1
    s_waitcnt lgkmcnt(4)
    buffer_store_dwordx4 v[196:199], v6, s[64:67], s7 offen offset:1024 sc1
    s_waitcnt lgkmcnt(2)
    buffer_store_dwordx4 v[200:203], v6, s[64:67], s7 offen offset:2048 sc1
    s_waitcnt lgkmcnt(0)
    buffer_store_dwordx4 v[204:207], v6, s[64:67], s7 offen offset:3072 sc1
    s_lshl_b32 s5, s96, 7
    s_add_u32 s5, s5, 131072
    v_mov_b32 v3, 1
    v_mov_b32 v4, 145072
    s_waitcnt vmcnt(0)
    s_mov_b64 exec, 1
    ds_add_rtn_u32 v5, v4, v3
    s_mov_b64 exec, -1
    s_waitcnt lgkmcnt(0)
    v_readfirstlane_b32 s4, v5
    s_nop 1
    s_cmp_lg_u32 s4, 3
    s_cselect_b32 s5, 2130706432, s5
    v_mov_b32 v3, s78
    v_mov_b32 v4, 0
    s_mov_b64 exec, 1
    buffer_store_dword v3, v4, s[64:67], s5 offen sc1
    s_mov_b64 exec, -1
    s_branch L_HTAIL
L_NOCONV:
    v_min_u32 v3, 39, v1
    v_lshlrev_b32 v3, 7, v3
    s_waitcnt vmcnt(2) lgkmcnt(0)
    s_add_u32 m0, s14, 0
    s_nop 0
    buffer_load_dwordx4 v6, s[64:67], s34 offen offset:0 sc1 lds
    buffer_load_dwordx4 v6, s[64:67], s34 offen offset:1024 sc1 lds
    buffer_load_dwordx4 v6, s[64:67], s34 offen offset:2048 sc1 lds
    buffer_load_dwordx4 v6, s[64:67], s34 offen offset:3072 sc1 lds
    s_add_u32 m0, s14, 4096
    s_nop 0
    buffer_load_dwordx4 v19, s[64:67], s34 offen offset:0 sc1 lds
    s_barrier
    s_waitcnt vmcnt(5)
    ds_write_b32 v17, v17 offset:96
    ds_write_b32 v17, v17 offset:80
    s_add_u32 m0, s19, 40960
    s_nop 0
    buffer_load_dwordx4 v6, s[64:67], s35 offen offset:0 sc1 lds
    buffer_load_dwordx4 v6, s[64:67], s35 offen offset:1024 sc1 lds
    buffer_load_dwordx4 v6, s[64:67], s35 offen offset:2048 sc1 lds
    buffer_load_dwordx4 v6, s[64:67], s35 offen offset:3072 sc1 lds
    s_add_u32 m0, s19, 45056
    s_nop 0
    buffer_load_dwordx4 v19, s[64:67], s35 offen offset:0 sc1 lds
    s_add_u32 m0, s19, 46080
    s_nop 0
    buffer_load_dwordx4 v6, s[64:67], s36 offen offset:0 sc1 lds
    buffer_load_dwordx4 v6, s[64:67], s36 offen offset:1024 sc1 lds
    buffer_load_dwordx4 v6, s[64:67], s36 offen offset:2048 sc1 lds
    buffer_load_dwordx4 v6, s[64:67], s36 offen offset:3072 sc1 lds
    s_add_u32 m0, s19, 50176
    s_nop 0
    buffer_load_dwordx4 v19, s[64:67], s36 offen offset:0 sc1 lds
    buffer_load_dword v4, v3, s[64:67], s37 offen sc1
    s_waitcnt vmcnt(0)
    ds_write_b32 v17, v17 offset:16
    s_waitcnt lgkmcnt(0)
L_HTAIL:
    s_endpgm
L_EAB:
    v_lshrrev_b32 v3, 3, v1
    v_mul_u32_u24 v7, 1280, v3
    v_and_b32 v4, 7, v1
    v_lshrrev_b32 v5, 4, v1
    v_xor_b32 v5, v4, v5
    v_lshl_add_u32 v7, v5, 4, v7
    v_xor_b32 v8, 64, v7
    v_add_u32 v3, 0, v1
    v_mul_u32_u24 v4, 43691, v3
    v_lshrrev_b32 v4, 19, v4
    v_mul_u32_u24 v5, 12, v4
    v_sub_u32 v3, v3, v5
    v_lshrrev_b32 v5, 2, v4
    v_and_b32 v5, 2, v5
    v_xor_b32 v3, v3, v5
    v_mul_u32_u24 v4, 3072, v4
    v_lshl_add_u32 v9, v3, 4, v4
    v_add_u32 v3, 64, v1
    v_mul_u32_u24 v4, 43691, v3
    v_lshrrev_b32 v4, 19, v4
    v_mul_u32_u24 v5, 12, v4
    v_sub_u32 v3, v3, v5
    v_lshrrev_b32 v5, 2, v4
    v_and_b32 v5, 2, v5
    v_xor_b32 v3, v3, v5
    v_mul_u32_u24 v4, 3072, v4
    v_lshl_add_u32 v10, v3, 4, v4
    v_add_u32 v3, 128, v1
    v_mul_u32_u24 v4, 43691, v3
    v_lshrrev_b32 v4, 19, v4
    v_mul_u32_u24 v5, 12, v4
    v_sub_u32 v3, v3, v5
    v_lshrrev_b32 v5, 2, v4
    v_and_b32 v5, 2, v5
    v_xor_b32 v3, v3, v5
    v_mul_u32_u24 v4, 3072, v4
    v_lshl_add_u32 v11, v3, 4, v4
    s_mul_i32 s5, s83, 32
    s_add_u32 s4, s74, s5
    s_mul_i32 s60, s4, 1280
    s_lshl_b32 s62, s5, 7
    s_and_b32 s4, s83, 1
    s_mul_i32 s61, s4, 98304
    s_lshl_b32 s5, s75, 1
    s_add_u32 s61, s61, s5
    s_mul_i32 s63, s83, 6144
    s_lshr_b32 s6, s74, 6
    s_and_b32 s6, s6, 0
    s_lshl_b32 s7, s6, 7
    s_sub_u32 s90, s60, s7
    s_add_u32 s60, s60, s7
    s_mul_i32 s7, s6, 196608
    s_sub_u32 s91, s61, s7
    s_add_u32 s61, s61, s7
    s_waitcnt lgkmcnt(0)
    global_load_short_d16_hi v96, v108, s[18:19]
    global_load_short_d16_hi v97, v108, s[20:21]
    global_load_short_d16_hi v98, v108, s[22:23]
    global_load_short_d16_hi v99, v108, s[24:25]
    global_load_short_d16_hi v100, v108, s[26:27]
    global_load_short_d16_hi v101, v108, s[28:29]
    global_load_short_d16_hi v102, v109, s[30:31]
    s_setprio 0
    s_mov_b64 s[48:49], s[16:17]
    s_cmp_ge_u32 s83, 2
    s_cselect_b64 s[52:53], s[38:39], s[36:37]
    s_branch L_EAJ
L_MAB:
    v_and_b32 v3, 15, v1
    v_lshrrev_b32 v5, 4, v1
    v_bfe_u32 v4, v1, 1, 3
    v_xor_b32 v4, v4, v5
    v_lshlrev_b32 v3, 7, v3
    v_lshl_add_u32 v3, v4, 4, v3
    v_xor_b32 v4, 64, v3
    s_mul_i32 s4, s83, 8192
    s_add_u32 s5, s4, 40960
    v_add_u32 v46, s5, v3
    v_add_u32 v47, s5, v4
    s_add_u32 s5, s4, 81920
    v_add_u32 v48, s5, v3
    v_add_u32 v49, s5, v4
    s_add_u32 s5, s4, 122880
    v_add_u32 v50, s5, v3
    v_add_u32 v51, s5, v4
    v_bfe_u32 v3, v1, 2, 2
    v_lshl_add_u32 v3, v5, 3, v3
    v_mul_u32_u24 v3, 192, v3
    v_and_b32 v4, 3, v1
    v_lshl_add_u32 v3, v4, 3, v3
    v_bfe_u32 v5, v1, 4, 1
    s_mul_i32 s4, s84, 3
    s_add_u32 s5, s4, 1
    v_xor_b32 v4, s4, v5
    v_lshl_add_u32 v4, v4, 5, v3
    v_xor_b32 v5, s5, v5
    v_lshl_add_u32 v5, v5, 5, v3
    v_add_u32 v52, 57344, v4
    v_add_u32 v53, 57344, v5
    v_add_u32 v54, 98304, v4
    v_add_u32 v55, 98304, v5
    v_add_u32 v56, 139264, v4
    v_add_u32 v57, 139264, v5
    v_add_u32 v58, 8192, v4
    v_add_u32 v59, 8192, v5
    s_branch L_MAJ
FC_7:
    s_mov_b32 s101, 0
FC_7_l:
    s_sleep 1
    ds_read_b32 v8, v7
    s_waitcnt lgkmcnt(0)
    v_cmp_eq_u32 vcc, 0, v8
    s_add_u32 s101, s101, 1
    s_nop 1
    s_cbranch_vccz FCB_8
    s_cmp_lt_u32 s101, 0x80000
    s_cbranch_scc1 FC_7_l
    s_branch FCB_8
FC_11:
    s_mov_b32 s101, 0
FC_11_l:
    s_sleep 1
    ds_read_b32 v8, v7
    s_waitcnt lgkmcnt(0)
    v_cmp_eq_u32 vcc, 0, v8
    s_add_u32 s101, s101, 1
    s_nop 1
    s_cbranch_vccz FCB_12
    s_cmp_lt_u32 s101, 0x80000
    s_cbranch_scc1 FC_11_l
    s_branch FCB_12
L_G1B:
    s_barrier
    ds_read_b128 v[156:159], v48 offset:0
    ds_read_b64_tr_b16 v[172:173], v54 offset:0
    ds_read_b64_tr_b16 v[174:175], v54 offset:768
    ds_read_b64_tr_b16 v[184:185], v54 offset:12288
    ds_read_b64_tr_b16 v[186:187], v54 offset:13056
    ds_read_b64_tr_b16 v[176:177], v55 offset:0
    ds_read_b64_tr_b16 v[178:179], v55 offset:768
    ds_read_b64_tr_b16 v[188:189], v55 offset:12288
    ds_read_b64_tr_b16 v[190:191], v55 offset:13056
    ds_read_b64_tr_b16 v[180:181], v54 offset:64
    ds_read_b64_tr_b16 v[182:183], v54 offset:832
    ds_read_b64_tr_b16 v[192:193], v54 offset:12352
    ds_read_b64_tr_b16 v[194:195], v54 offset:13120
    ds_read_b128 v[160:163], v48 offset:2048
    ds_read_b128 v[164:167], v48 offset:4096
    ds_read_b128 v[168:171], v48 offset:6144
    s_waitcnt lgkmcnt(13)
    v_mfma_f32_16x16x32_bf16 v[60:63], v[172:175], v[156:159], 0
    ds_read_b128 v[196:199], v49 offset:0
    s_waitcnt lgkmcnt(12)
    v_mfma_f32_16x16x32_bf16 v[72:75], v[184:187], v[156:159], 0
    ds_read_b64_tr_b16 v[212:213], v54 offset:6144
    s_waitcnt lgkmcnt(11)
    v_mfma_f32_16x16x32_bf16 v[64:67], v[176:179], v[156:159], 0
    ds_read_b64_tr_b16 v[214:215], v54 offset:6912
    s_waitcnt lgkmcnt(10)
    v_mfma_f32_16x16x32_bf16 v[76:79], v[188:191], v[156:159], 0
    ds_read_b64_tr_b16 v[224:225], v54 offset:18432
    s_waitcnt lgkmcnt(9)
    v_mfma_f32_16x16x32_bf16 v[68:71], v[180:183], v[156:159], 0
    ds_read_b64_tr_b16 v[226:227], v54 offset:19200
    s_waitcnt lgkmcnt(8)
    v_mfma_f32_16x16x32_bf16 v[80:83], v[192:195], v[156:159], 0
    ds_read_b64_tr_b16 v[216:217], v55 offset:6144
    s_waitcnt lgkmcnt(8)
    v_mfma_f32_16x16x32_bf16 v[104:107], v[192:195], v[160:163], 0
    ds_read_b64_tr_b16 v[218:219], v55 offset:6912
    v_mfma_f32_16x16x32_bf16 v[92:95], v[180:183], v[160:163], 0
    ds_read_b64_tr_b16 v[228:229], v55 offset:18432
    v_mfma_f32_16x16x32_bf16 v[100:103], v[188:191], v[160:163], 0
    ds_read_b64_tr_b16 v[230:231], v55 offset:19200
    v_mfma_f32_16x16x32_bf16 v[88:91], v[176:179], v[160:163], 0
    ds_read_b64_tr_b16 v[220:221], v54 offset:6208
    v_mfma_f32_16x16x32_bf16 v[96:99], v[184:187], v[160:163], 0
    ds_read_b64_tr_b16 v[222:223], v54 offset:6976
    v_mfma_f32_16x16x32_bf16 v[84:87], v[172:175], v[160:163], 0
    ds_read_b64_tr_b16 v[232:233], v54 offset:18496
    s_waitcnt lgkmcnt(13)
    v_mfma_f32_16x16x32_bf16 v[108:111], v[172:175], v[164:167], 0
    ds_read_b64_tr_b16 v[234:235], v54 offset:19264
    v_mfma_f32_16x16x32_bf16 v[120:123], v[184:187], v[164:167], 0
    ds_read_b128 v[200:203], v49 offset:2048
    v_mfma_f32_16x16x32_bf16 v[112:115], v[176:179], v[164:167], 0
    ds_read_b128 v[204:207], v49 offset:4096
    v_mfma_f32_16x16x32_bf16 v[124:127], v[188:191], v[164:167], 0
    ds_read_b128 v[208:211], v49 offset:6144
    v_mfma_f32_16x16x32_bf16 v[116:119], v[180:183], v[164:167], 0
    v_mov_b32 v8, 0
    global_load_dword v7, v8, s[44:45] sc1
    v_mfma_f32_16x16x32_bf16 v[128:131], v[192:195], v[164:167], 0
    s_mov_b64 s[68:69], s[42:43]
    s_mov_b32 s70, 2621440
    s_waitcnt lgkmcnt(15)
    v_mfma_f32_16x16x32_bf16 v[152:155], v[192:195], v[168:171], 0
    s_mov_b32 s71, 0x20000
    v_and_b32 v3, 15, v1
    v_mfma_f32_16x16x32_bf16 v[140:143], v[180:183], v[168:171], 0
    v_lshlrev_b32 v0, 4, v3
    v_lshlrev_b32 v5, 3, v3
    v_mfma_f32_16x16x32_bf16 v[148:151], v[188:191], v[168:171], 0
    v_lshrrev_b32 v3, 5, v1
    v_lshl_add_u32 v0, v3, 8, v0
    v_mfma_f32_16x16x32_bf16 v[136:139], v[176:179], v[168:171], 0
    v_bfe_u32 v3, v1, 4, 1
    v_lshl_add_u32 v0, v3, 10, v0
    v_mfma_f32_16x16x32_bf16 v[144:147], v[184:187], v[168:171], 0
    s_lshr_b32 s6, s74, 4
    s_mul_i32 s4, s83, 4
    v_mfma_f32_16x16x32_bf16 v[132:135], v[172:175], v[168:171], 0
    s_add_u32 s6, s6, s4
    s_lshr_b32 s7, s75, 4
    s_waitcnt lgkmcnt(0)
    s_barrier
    v_mfma_f32_16x16x32_bf16 v[60:63], v[212:215], v[196:199], v[60:63]
    ds_read_b128 v[156:159], v50 offset:0
    v_mfma_f32_16x16x32_bf16 v[72:75], v[224:227], v[196:199], v[72:75]
    ds_read_b64_tr_b16 v[172:173], v56 offset:0
    v_mfma_f32_16x16x32_bf16 v[64:67], v[216:219], v[196:199], v[64:67]
    ds_read_b64_tr_b16 v[174:175], v56 offset:768
    v_mfma_f32_16x16x32_bf16 v[76:79], v[228:231], v[196:199], v[76:79]
    ds_read_b64_tr_b16 v[184:185], v56 offset:12288
    v_mfma_f32_16x16x32_bf16 v[68:71], v[220:223], v[196:199], v[68:71]
    ds_read_b64_tr_b16 v[186:187], v56 offset:13056
    v_mfma_f32_16x16x32_bf16 v[80:83], v[232:235], v[196:199], v[80:83]
    ds_read_b64_tr_b16 v[176:177], v57 offset:0
    v_mfma_f32_16x16x32_bf16 v[104:107], v[232:235], v[200:203], v[104:107]
    ds_read_b64_tr_b16 v[178:179], v57 offset:768
    v_mfma_f32_16x16x32_bf16 v[92:95], v[220:223], v[200:203], v[92:95]
    ds_read_b64_tr_b16 v[188:189], v57 offset:12288
    v_mfma_f32_16x16x32_bf16 v[100:103], v[228:231], v[200:203], v[100:103]
    ds_read_b64_tr_b16 v[190:191], v57 offset:13056
    v_mfma_f32_16x16x32_bf16 v[88:91], v[216:219], v[200:203], v[88:91]
    ds_read_b64_tr_b16 v[180:181], v56 offset:64
    v_mfma_f32_16x16x32_bf16 v[96:99], v[224:227], v[200:203], v[96:99]
    ds_read_b64_tr_b16 v[182:183], v56 offset:832
    v_mfma_f32_16x16x32_bf16 v[84:87], v[212:215], v[200:203], v[84:87]
    ds_read_b64_tr_b16 v[192:193], v56 offset:12352
    v_mfma_f32_16x16x32_bf16 v[108:111], v[212:215], v[204:207], v[108:111]
    ds_read_b64_tr_b16 v[194:195], v56 offset:13120
    v_mfma_f32_16x16x32_bf16 v[120:123], v[224:227], v[204:207], v[120:123]
    ds_read_b128 v[160:163], v50 offset:2048
    v_mfma_f32_16x16x32_bf16 v[112:115], v[216:219], v[204:207], v[112:115]
    ds_read_b128 v[164:167], v50 offset:4096
    v_mfma_f32_16x16x32_bf16 v[124:127], v[228:231], v[204:207], v[124:127]
    ds_read_b128 v[168:171], v50 offset:6144
    v_mfma_f32_16x16x32_bf16 v[116:119], v[220:223], v[204:207], v[116:119]
    s_mul_i32 s4, s84, 3
    s_add_u32 s7, s7, s4
    v_mfma_f32_16x16x32_bf16 v[128:131], v[232:235], v[204:207], v[128:131]
    s_lshl_b32 s4, s6, 7
    s_add_u32 s12, s4, 196608
    v_mfma_f32_16x16x32_bf16 v[152:155], v[232:235], v[208:211], v[152:155]
    s_add_u32 s4, s7, 0
    s_lshr_b32 s5, s4, 1
    v_mfma_f32_16x16x32_bf16 v[140:143], v[220:223], v[208:211], v[140:143]
    s_lshl_b32 s5, s5, 12
    s_and_b32 s4, s4, 1
    v_mfma_f32_16x16x32_bf16 v[148:151], v[228:231], v[208:211], v[148:151]
    buffer_store_dwordx4 v[12:15], v6, s[64:67], s96 offen sc1
    v_mfma_f32_16x16x32_bf16 v[136:139], v[216:219], v[208:211], v[136:139]
    s_lshl_b32 s4, s4, 9
    s_add_u32 s8, s4, s5
    v_mfma_f32_16x16x32_bf16 v[144:147], v[224:227], v[208:211], v[144:147]
    s_add_u32 s4, s7, 1
    s_lshr_b32 s5, s4, 1
    v_mfma_f32_16x16x32_bf16 v[132:135], v[212:215], v[208:211], v[132:135]
    s_lshl_b32 s5, s5, 12
    s_and_b32 s4, s4, 1
    s_waitcnt lgkmcnt(13)
    v_mfma_f32_16x16x32_bf16 v[60:63], v[172:175], v[156:159], v[60:63]
    ds_read_b128 v[196:199], v51 offset:0
    s_waitcnt lgkmcnt(12)
    v_mfma_f32_16x16x32_bf16 v[72:75], v[184:187], v[156:159], v[72:75]
    ds_read_b64_tr_b16 v[212:213], v56 offset:6144
    s_waitcnt lgkmcnt(11)
    v_mfma_f32_16x16x32_bf16 v[64:67], v[176:179], v[156:159], v[64:67]
    ds_read_b64_tr_b16 v[214:215], v56 offset:6912
    s_waitcnt lgkmcnt(10)
    v_mfma_f32_16x16x32_bf16 v[76:79], v[188:191], v[156:159], v[76:79]
    ds_read_b64_tr_b16 v[224:225], v56 offset:18432
    s_waitcnt lgkmcnt(9)
    v_mfma_f32_16x16x32_bf16 v[68:71], v[180:183], v[156:159], v[68:71]
    ds_read_b64_tr_b16 v[226:227], v56 offset:19200
    s_waitcnt lgkmcnt(8)
    v_mfma_f32_16x16x32_bf16 v[80:83], v[192:195], v[156:159], v[80:83]
    ds_read_b64_tr_b16 v[216:217], v57 offset:6144
    s_waitcnt lgkmcnt(8)
    v_mfma_f32_16x16x32_bf16 v[104:107], v[192:195], v[160:163], v[104:107]
    ds_read_b64_tr_b16 v[218:219], v57 offset:6912
    v_mfma_f32_16x16x32_bf16 v[92:95], v[180:183], v[160:163], v[92:95]
    ds_read_b64_tr_b16 v[228:229], v57 offset:18432
    v_mfma_f32_16x16x32_bf16 v[100:103], v[188:191], v[160:163], v[100:103]
    ds_read_b64_tr_b16 v[230:231], v57 offset:19200
    v_mfma_f32_16x16x32_bf16 v[88:91], v[176:179], v[160:163], v[88:91]
    ds_read_b64_tr_b16 v[220:221], v56 offset:6208
    v_mfma_f32_16x16x32_bf16 v[96:99], v[184:187], v[160:163], v[96:99]
    ds_read_b64_tr_b16 v[222:223], v56 offset:6976
    v_mfma_f32_16x16x32_bf16 v[84:87], v[172:175], v[160:163], v[84:87]
    ds_read_b64_tr_b16 v[232:233], v56 offset:18496
    s_waitcnt lgkmcnt(13)
    v_mfma_f32_16x16x32_bf16 v[108:111], v[172:175], v[164:167], v[108:111]
    ds_read_b64_tr_b16 v[234:235], v56 offset:19264
    v_mfma_f32_16x16x32_bf16 v[120:123], v[184:187], v[164:167], v[120:123]
    ds_read_b128 v[200:203], v51 offset:2048
    v_mfma_f32_16x16x32_bf16 v[112:115], v[176:179], v[164:167], v[112:115]
    ds_read_b128 v[204:207], v51 offset:4096
    v_mfma_f32_16x16x32_bf16 v[124:127], v[188:191], v[164:167], v[124:127]
    ds_read_b128 v[208:211], v51 offset:6144
    v_mfma_f32_16x16x32_bf16 v[116:119], v[180:183], v[164:167], v[116:119]
    s_lshl_b32 s4, s4, 9
    s_add_u32 s9, s4, s5
    v_mfma_f32_16x16x32_bf16 v[128:131], v[192:195], v[164:167], v[128:131]
    s_add_u32 s4, s7, 2
    s_lshr_b32 s5, s4, 1
    s_waitcnt lgkmcnt(15)
    v_mfma_f32_16x16x32_bf16 v[152:155], v[192:195], v[168:171], v[152:155]
    s_lshl_b32 s5, s5, 12
    s_and_b32 s4, s4, 1
    v_mfma_f32_16x16x32_bf16 v[140:143], v[180:183], v[168:171], v[140:143]
    s_lshl_b32 s4, s4, 9
    s_add_u32 s10, s4, s5
    v_mfma_f32_16x16x32_bf16 v[148:151], v[188:191], v[168:171], v[148:151]
    s_add_u32 s4, s6, 0
    s_lshr_b32 s5, s4, 2
    v_mfma_f32_16x16x32_bf16 v[136:139], v[176:179], v[168:171], v[136:139]
    s_mul_i32 s5, s5, 196608
    s_and_b32 s4, s4, 3
    v_mfma_f32_16x16x32_bf16 v[144:147], v[184:187], v[168:171], v[144:147]
    s_lshl_b32 s4, s4, 10
    s_add_u32 s4, s4, s5
    v_mfma_f32_16x16x32_bf16 v[132:135], v[172:175], v[168:171], v[132:135]
    s_add_u32 s4, s4, 12582912
    s_add_u32 s52, s4, s8
    s_waitcnt vmcnt(2)
    s_waitcnt lgkmcnt(0)
    s_barrier
    v_mfma_f32_16x16x32_bf16 v[60:63], v[212:215], v[196:199], v[60:63]
    ds_read_b128 v[156:159], v46 offset:0
    v_mfma_f32_16x16x32_bf16 v[72:75], v[224:227], v[196:199], v[72:75]
    ds_read_b64_tr_b16 v[172:173], v52 offset:0
    v_mfma_f32_16x16x32_bf16 v[64:67], v[216:219], v[196:199], v[64:67]
    ds_read_b64_tr_b16 v[174:175], v52 offset:768
    v_mfma_f32_16x16x32_bf16 v[76:79], v[228:231], v[196:199], v[76:79]
    ds_read_b64_tr_b16 v[184:185], v52 offset:12288
    v_mfma_f32_16x16x32_bf16 v[68:71], v[220:223], v[196:199], v[68:71]
    ds_read_b64_tr_b16 v[186:187], v52 offset:13056
    v_mfma_f32_16x16x32_bf16 v[80:83], v[232:235], v[196:199], v[80:83]
    ds_read_b64_tr_b16 v[176:177], v53 offset:0
    v_mfma_f32_16x16x32_bf16 v[104:107], v[232:235], v[200:203], v[104:107]
    ds_read_b64_tr_b16 v[178:179], v53 offset:768
    v_mfma_f32_16x16x32_bf16 v[92:95], v[220:223], v[200:203], v[92:95]
    ds_read_b64_tr_b16 v[188:189], v53 offset:12288
    v_mfma_f32_16x16x32_bf16 v[100:103], v[228:231], v[200:203], v[100:103]
    ds_read_b64_tr_b16 v[190:191], v53 offset:13056
    v_mfma_f32_16x16x32_bf16 v[88:91], v[216:219], v[200:203], v[88:91]
    ds_read_b64_tr_b16 v[180:181], v52 offset:64
    v_mfma_f32_16x16x32_bf16 v[96:99], v[224:227], v[200:203], v[96:99]
    ds_read_b64_tr_b16 v[182:183], v52 offset:832
    v_mfma_f32_16x16x32_bf16 v[84:87], v[212:215], v[200:203], v[84:87]
    ds_read_b64_tr_b16 v[192:193], v52 offset:12352
    v_mfma_f32_16x16x32_bf16 v[108:111], v[212:215], v[204:207], v[108:111]
    ds_read_b64_tr_b16 v[194:195], v52 offset:13120
    v_mfma_f32_16x16x32_bf16 v[120:123], v[224:227], v[204:207], v[120:123]
    ds_read_b128 v[160:163], v46 offset:2048
    v_mfma_f32_16x16x32_bf16 v[112:115], v[216:219], v[204:207], v[112:115]
    ds_read_b128 v[164:167], v46 offset:4096
    v_mfma_f32_16x16x32_bf16 v[124:127], v[228:231], v[204:207], v[124:127]
    ds_read_b128 v[168:171], v46 offset:6144
    v_mfma_f32_16x16x32_bf16 v[116:119], v[220:223], v[204:207], v[116:119]
    s_add_u32 s53, s4, s9
    s_add_u32 s54, s4, s10
    v_mfma_f32_16x16x32_bf16 v[128:131], v[232:235], v[204:207], v[128:131]
    s_add_u32 s4, s6, 2
    s_lshr_b32 s5, s4, 2
    v_mfma_f32_16x16x32_bf16 v[152:155], v[232:235], v[208:211], v[152:155]
    s_mul_i32 s5, s5, 196608
    s_and_b32 s4, s4, 3
    v_mfma_f32_16x16x32_bf16 v[140:143], v[220:223], v[208:211], v[140:143]
    s_lshl_b32 s4, s4, 10
    s_add_u32 s4, s4, s5
    v_mfma_f32_16x16x32_bf16 v[148:151], v[228:231], v[208:211], v[148:151]
    buffer_store_dwordx4 v[16:19], v6, s[64:67], s97 offen sc1
    v_mfma_f32_16x16x32_bf16 v[136:139], v[216:219], v[208:211], v[136:139]
    s_add_u32 s4, s4, 12582912
    s_add_u32 s55, s4, s8
    v_mfma_f32_16x16x32_bf16 v[144:147], v[224:227], v[208:211], v[144:147]
    s_add_u32 s56, s4, s9
    s_add_u32 s57, s4, s10
    v_mfma_f32_16x16x32_bf16 v[132:135], v[212:215], v[208:211], v[132:135]
    s_and_b32 s4, s79, 1
    s_lshl_b32 s4, s4, 2
    s_waitcnt lgkmcnt(13)
    v_mfma_f32_16x16x32_bf16 v[60:63], v[172:175], v[156:159], v[60:63]
    ds_read_b128 v[196:199], v47 offset:0
    s_waitcnt lgkmcnt(12)
    v_mfma_f32_16x16x32_bf16 v[72:75], v[184:187], v[156:159], v[72:75]
    ds_read_b64_tr_b16 v[212:213], v52 offset:6144
    s_waitcnt lgkmcnt(11)
    v_mfma_f32_16x16x32_bf16 v[64:67], v[176:179], v[156:159], v[64:67]
    ds_read_b64_tr_b16 v[214:215], v52 offset:6912
    s_waitcnt lgkmcnt(10)
    v_mfma_f32_16x16x32_bf16 v[76:79], v[188:191], v[156:159], v[76:79]
    ds_read_b64_tr_b16 v[224:225], v52 offset:18432
    s_waitcnt lgkmcnt(9)
    v_mfma_f32_16x16x32_bf16 v[68:71], v[180:183], v[156:159], v[68:71]
    ds_read_b64_tr_b16 v[226:227], v52 offset:19200
    s_waitcnt lgkmcnt(8)
    v_mfma_f32_16x16x32_bf16 v[80:83], v[192:195], v[156:159], v[80:83]
    ds_read_b64_tr_b16 v[216:217], v53 offset:6144
    s_waitcnt lgkmcnt(8)
    v_mfma_f32_16x16x32_bf16 v[104:107], v[192:195], v[160:163], v[104:107]
    ds_read_b64_tr_b16 v[218:219], v53 offset:6912
    v_mfma_f32_16x16x32_bf16 v[92:95], v[180:183], v[160:163], v[92:95]
    ds_read_b64_tr_b16 v[228:229], v53 offset:18432
    v_mfma_f32_16x16x32_bf16 v[100:103], v[188:191], v[160:163], v[100:103]
    ds_read_b64_tr_b16 v[230:231], v53 offset:19200
    v_mfma_f32_16x16x32_bf16 v[88:91], v[176:179], v[160:163], v[88:91]
    ds_read_b64_tr_b16 v[220:221], v52 offset:6208
    v_mfma_f32_16x16x32_bf16 v[96:99], v[184:187], v[160:163], v[96:99]
    ds_read_b64_tr_b16 v[222:223], v52 offset:6976
    v_mfma_f32_16x16x32_bf16 v[84:87], v[172:175], v[160:163], v[84:87]
    ds_read_b64_tr_b16 v[232:233], v52 offset:18496
    s_waitcnt lgkmcnt(13)
    v_mfma_f32_16x16x32_bf16 v[108:111], v[172:175], v[164:167], v[108:111]
    ds_read_b64_tr_b16 v[234:235], v52 offset:19264
    v_mfma_f32_16x16x32_bf16 v[120:123], v[184:187], v[164:167], v[120:123]
    ds_read_b128 v[200:203], v47 offset:2048
    v_mfma_f32_16x16x32_bf16 v[112:115], v[176:179], v[164:167], v[112:115]
    ds_read_b128 v[204:207], v47 offset:4096
    v_mfma_f32_16x16x32_bf16 v[124:127], v[188:191], v[164:167], v[124:127]
    ds_read_b128 v[208:211], v47 offset:6144
    v_mfma_f32_16x16x32_bf16 v[116:119], v[180:183], v[164:167], v[116:119]
    s_bitcmp1_b32 s79, 2
    s_cselect_b32 s4, 8, s4
    s_cmp_ge_u32 s4, 12
    s_cselect_b32 s5, 12, 0
    v_mfma_f32_16x16x32_bf16 v[128:131], v[192:195], v[164:167], v[128:131]
    s_sub_u32 s85, s4, s5
    s_mul_i32 s4, s80, 48
    s_waitcnt lgkmcnt(15)
    v_mfma_f32_16x16x32_bf16 v[152:155], v[192:195], v[168:171], v[152:155]
    s_mul_i32 s5, s3, 12
    s_add_u32 s4, s4, s5
    v_mfma_f32_16x16x32_bf16 v[140:143], v[180:183], v[168:171], v[140:143]
    s_mul_i32 s4, s4, 5120
    s_add_u32 s86, s4, 10485760
    v_mfma_f32_16x16x32_bf16 v[148:151], v[188:191], v[168:171], v[148:151]
    s_mul_i32 s4, s79, 196608
    s_lshl_b32 s5, s5, 12
    v_mfma_f32_16x16x32_bf16 v[136:139], v[176:179], v[168:171], v[136:139]
    s_add_u32 s4, s4, s5
    s_add_u32 s87, s4, 12582912
    v_mfma_f32_16x16x32_bf16 v[144:147], v[184:187], v[168:171], v[144:147]
    s_lshl_b32 s4, s85, 12
    s_add_u32 s16, s4, s87
    v_mfma_f32_16x16x32_bf16 v[132:135], v[172:175], v[168:171], v[132:135]
    s_mul_i32 s4, s85, 5120
    s_add_u32 s28, s4, s86
    s_waitcnt lgkmcnt(0)
    s_barrier
    v_mfma_f32_16x16x32_bf16 v[60:63], v[212:215], v[196:199], v[60:63]
    ds_read_b128 v[156:159], v48 offset:0
    v_mfma_f32_16x16x32_bf16 v[72:75], v[224:227], v[196:199], v[72:75]
    ds_read_b64_tr_b16 v[172:173], v54 offset:0
    v_mfma_f32_16x16x32_bf16 v[64:67], v[216:219], v[196:199], v[64:67]
    ds_read_b64_tr_b16 v[174:175], v54 offset:768
    v_mfma_f32_16x16x32_bf16 v[76:79], v[228:231], v[196:199], v[76:79]
    ds_read_b64_tr_b16 v[184:185], v54 offset:12288
    v_mfma_f32_16x16x32_bf16 v[68:71], v[220:223], v[196:199], v[68:71]
    ds_read_b64_tr_b16 v[186:187], v54 offset:13056
    v_mfma_f32_16x16x32_bf16 v[80:83], v[232:235], v[196:199], v[80:83]
    ds_read_b64_tr_b16 v[176:177], v55 offset:0
    v_mfma_f32_16x16x32_bf16 v[104:107], v[232:235], v[200:203], v[104:107]
    ds_read_b64_tr_b16 v[178:179], v55 offset:768
    v_mfma_f32_16x16x32_bf16 v[92:95], v[220:223], v[200:203], v[92:95]
    ds_read_b64_tr_b16 v[188:189], v55 offset:12288
    v_mfma_f32_16x16x32_bf16 v[100:103], v[228:231], v[200:203], v[100:103]
    ds_read_b64_tr_b16 v[190:191], v55 offset:13056
    v_mfma_f32_16x16x32_bf16 v[88:91], v[216:219], v[200:203], v[88:91]
    ds_read_b64_tr_b16 v[180:181], v54 offset:64
    v_mfma_f32_16x16x32_bf16 v[96:99], v[224:227], v[200:203], v[96:99]
    ds_read_b64_tr_b16 v[182:183], v54 offset:832
    v_mfma_f32_16x16x32_bf16 v[84:87], v[212:215], v[200:203], v[84:87]
    ds_read_b64_tr_b16 v[192:193], v54 offset:12352
    v_mfma_f32_16x16x32_bf16 v[108:111], v[212:215], v[204:207], v[108:111]
    ds_read_b64_tr_b16 v[194:195], v54 offset:13120
    v_mfma_f32_16x16x32_bf16 v[120:123], v[224:227], v[204:207], v[120:123]
    ds_read_b128 v[160:163], v48 offset:2048
    v_mfma_f32_16x16x32_bf16 v[112:115], v[216:219], v[204:207], v[112:115]
    ds_read_b128 v[164:167], v48 offset:4096
    v_mfma_f32_16x16x32_bf16 v[124:127], v[228:231], v[204:207], v[124:127]
    ds_read_b128 v[168:171], v48 offset:6144
    v_mfma_f32_16x16x32_bf16 v[116:119], v[220:223], v[204:207], v[116:119]
    s_add_u32 s85, s85, 1
    s_cmp_eq_u32 s85, 12
    s_cselect_b32 s85, 0, s85
    v_mfma_f32_16x16x32_bf16 v[128:131], v[232:235], v[204:207], v[128:131]
    s_lshl_b32 s4, s85, 12
    s_add_u32 s17, s4, s87
    v_mfma_f32_16x16x32_bf16 v[152:155], v[232:235], v[208:211], v[152:155]
    s_mul_i32 s4, s85, 5120
    s_add_u32 s29, s4, s86
    v_mfma_f32_16x16x32_bf16 v[140:143], v[220:223], v[208:211], v[140:143]
    s_add_u32 s85, s85, 1
    s_cmp_eq_u32 s85, 12
    s_cselect_b32 s85, 0, s85
    v_mfma_f32_16x16x32_bf16 v[148:151], v[228:231], v[208:211], v[148:151]
    s_lshl_b32 s4, s85, 12
    s_add_u32 s18, s4, s87
    v_mfma_f32_16x16x32_bf16 v[136:139], v[216:219], v[208:211], v[136:139]
    s_mul_i32 s4, s85, 5120
    s_add_u32 s30, s4, s86
    v_mfma_f32_16x16x32_bf16 v[144:147], v[224:227], v[208:211], v[144:147]
    s_add_u32 s85, s85, 1
    s_cmp_eq_u32 s85, 12
    s_cselect_b32 s85, 0, s85
    v_mfma_f32_16x16x32_bf16 v[132:135], v[212:215], v[208:211], v[132:135]
    s_lshl_b32 s4, s85, 12
    s_add_u32 s19, s4, s87
    s_waitcnt lgkmcnt(13)
    v_mfma_f32_16x16x32_bf16 v[60:63], v[172:175], v[156:159], v[60:63]
    ds_read_b128 v[196:199], v49 offset:0
    s_waitcnt lgkmcnt(12)
    v_mfma_f32_16x16x32_bf16 v[72:75], v[184:187], v[156:159], v[72:75]
    ds_read_b64_tr_b16 v[212:213], v54 offset:6144
    s_waitcnt lgkmcnt(11)
    v_mfma_f32_16x16x32_bf16 v[64:67], v[176:179], v[156:159], v[64:67]
    ds_read_b64_tr_b16 v[214:215], v54 offset:6912
    s_waitcnt lgkmcnt(10)
    v_mfma_f32_16x16x32_bf16 v[76:79], v[188:191], v[156:159], v[76:79]
    ds_read_b64_tr_b16 v[224:225], v54 offset:18432
    s_waitcnt lgkmcnt(9)
    v_mfma_f32_16x16x32_bf16 v[68:71], v[180:183], v[156:159], v[68:71]
    ds_read_b64_tr_b16 v[226:227], v54 offset:19200
    s_waitcnt lgkmcnt(8)
    v_mfma_f32_16x16x32_bf16 v[80:83], v[192:195], v[156:159], v[80:83]
    ds_read_b64_tr_b16 v[216:217], v55 offset:6144
    s_waitcnt lgkmcnt(8)
    v_mfma_f32_16x16x32_bf16 v[104:107], v[192:195], v[160:163], v[104:107]
    ds_read_b64_tr_b16 v[218:219], v55 offset:6912
    v_mfma_f32_16x16x32_bf16 v[92:95], v[180:183], v[160:163], v[92:95]
    ds_read_b64_tr_b16 v[228:229], v55 offset:18432
    v_mfma_f32_16x16x32_bf16 v[100:103], v[188:191], v[160:163], v[100:103]
    ds_read_b64_tr_b16 v[230:231], v55 offset:19200
    v_mfma_f32_16x16x32_bf16 v[88:91], v[176:179], v[160:163], v[88:91]
    ds_read_b64_tr_b16 v[220:221], v54 offset:6208
    v_mfma_f32_16x16x32_bf16 v[96:99], v[184:187], v[160:163], v[96:99]
    ds_read_b64_tr_b16 v[222:223], v54 offset:6976
    v_mfma_f32_16x16x32_bf16 v[84:87], v[172:175], v[160:163], v[84:87]
    ds_read_b64_tr_b16 v[232:233], v54 offset:18496
    s_waitcnt lgkmcnt(13)
    v_mfma_f32_16x16x32_bf16 v[108:111], v[172:175], v[164:167], v[108:111]
    ds_read_b64_tr_b16 v[234:235], v54 offset:19264
    v_mfma_f32_16x16x32_bf16 v[120:123], v[184:187], v[164:167], v[120:123]
    ds_read_b128 v[200:203], v49 offset:2048
    v_mfma_f32_16x16x32_bf16 v[112:115], v[176:179], v[164:167], v[112:115]
    ds_read_b128 v[204:207], v49 offset:4096
    v_mfma_f32_16x16x32_bf16 v[124:127], v[188:191], v[164:167], v[124:127]
    ds_read_b128 v[208:211], v49 offset:6144
    v_mfma_f32_16x16x32_bf16 v[116:119], v[180:183], v[164:167], v[116:119]
    s_mul_i32 s4, s85, 5120
    s_add_u32 s31, s4, s86
    v_mfma_f32_16x16x32_bf16 v[128:131], v[192:195], v[164:167], v[128:131]
    s_add_u32 s85, s85, 1
    s_cmp_eq_u32 s85, 12
    s_cselect_b32 s85, 0, s85
    s_waitcnt lgkmcnt(15)
    v_mfma_f32_16x16x32_bf16 v[152:155], v[192:195], v[168:171], v[152:155]
    s_lshl_b32 s4, s85, 12
    s_add_u32 s20, s4, s87
    v_mfma_f32_16x16x32_bf16 v[140:143], v[180:183], v[168:171], v[140:143]
    s_mul_i32 s4, s85, 5120
    s_add_u32 s32, s4, s86
    v_mfma_f32_16x16x32_bf16 v[148:151], v[188:191], v[168:171], v[148:151]
    s_add_u32 s85, s85, 1
    s_cmp_eq_u32 s85, 12
    s_cselect_b32 s85, 0, s85
    v_mfma_f32_16x16x32_bf16 v[136:139], v[176:179], v[168:171], v[136:139]
    s_lshl_b32 s4, s85, 12
    s_add_u32 s21, s4, s87
    v_mfma_f32_16x16x32_bf16 v[144:147], v[184:187], v[168:171], v[144:147]
    s_mul_i32 s4, s85, 5120
    s_add_u32 s33, s4, s86
    v_mfma_f32_16x16x32_bf16 v[132:135], v[172:175], v[168:171], v[132:135]
    s_add_u32 s85, s85, 1
    s_cmp_eq_u32 s85, 12
    s_cselect_b32 s85, 0, s85
    s_waitcnt vmcnt(0)
    s_waitcnt lgkmcnt(0)
    s_barrier
    v_mfma_f32_16x16x32_bf16 v[60:63], v[212:215], v[196:199], v[60:63]
    ds_read_b128 v[156:159], v50 offset:0
    v_mfma_f32_16x16x32_bf16 v[72:75], v[224:227], v[196:199], v[72:75]
    ds_read_b64_tr_b16 v[172:173], v56 offset:0
    v_mfma_f32_16x16x32_bf16 v[64:67], v[216:219], v[196:199], v[64:67]
    ds_read_b64_tr_b16 v[174:175], v56 offset:768
    v_mfma_f32_16x16x32_bf16 v[76:79], v[228:231], v[196:199], v[76:79]
    ds_read_b64_tr_b16 v[184:185], v56 offset:12288
    v_mfma_f32_16x16x32_bf16 v[68:71], v[220:223], v[196:199], v[68:71]
    ds_read_b64_tr_b16 v[186:187], v56 offset:13056
    v_mfma_f32_16x16x32_bf16 v[80:83], v[232:235], v[196:199], v[80:83]
    ds_read_b64_tr_b16 v[176:177], v57 offset:0
    v_mfma_f32_16x16x32_bf16 v[104:107], v[232:235], v[200:203], v[104:107]
    ds_read_b64_tr_b16 v[178:179], v57 offset:768
    v_mfma_f32_16x16x32_bf16 v[92:95], v[220:223], v[200:203], v[92:95]
    ds_read_b64_tr_b16 v[188:189], v57 offset:12288
    v_mfma_f32_16x16x32_bf16 v[100:103], v[228:231], v[200:203], v[100:103]
    ds_read_b64_tr_b16 v[190:191], v57 offset:13056
    v_mfma_f32_16x16x32_bf16 v[88:91], v[216:219], v[200:203], v[88:91]
    ds_read_b64_tr_b16 v[180:181], v56 offset:64
    v_mfma_f32_16x16x32_bf16 v[96:99], v[224:227], v[200:203], v[96:99]
    ds_read_b64_tr_b16 v[182:183], v56 offset:832
    v_mfma_f32_16x16x32_bf16 v[84:87], v[212:215], v[200:203], v[84:87]
    ds_read_b64_tr_b16 v[192:193], v56 offset:12352
    v_mfma_f32_16x16x32_bf16 v[108:111], v[212:215], v[204:207], v[108:111]
    ds_read_b64_tr_b16 v[194:195], v56 offset:13120
    v_mfma_f32_16x16x32_bf16 v[120:123], v[224:227], v[204:207], v[120:123]
    ds_read_b128 v[160:163], v50 offset:2048
    v_mfma_f32_16x16x32_bf16 v[112:115], v[216:219], v[204:207], v[112:115]
    ds_read_b128 v[164:167], v50 offset:4096
    v_mfma_f32_16x16x32_bf16 v[124:127], v[228:231], v[204:207], v[124:127]
    ds_read_b128 v[168:171], v50 offset:6144
    v_mfma_f32_16x16x32_bf16 v[116:119], v[220:223], v[204:207], v[116:119]
    s_lshl_b32 s4, s85, 12
    s_add_u32 s22, s4, s87
    v_mfma_f32_16x16x32_bf16 v[128:131], v[232:235], v[204:207], v[128:131]
    s_mul_i32 s4, s85, 5120
    s_add_u32 s34, s4, s86
    v_mfma_f32_16x16x32_bf16 v[152:155], v[232:235], v[208:211], v[152:155]
    s_add_u32 s85, s85, 1
    s_cmp_eq_u32 s85, 12
    s_cselect_b32 s85, 0, s85
    v_mfma_f32_16x16x32_bf16 v[140:143], v[220:223], v[208:211], v[140:143]
    s_lshl_b32 s4, s85, 12
    s_add_u32 s23, s4, s87
    v_mfma_f32_16x16x32_bf16 v[148:151], v[228:231], v[208:211], v[148:151]
    s_mul_i32 s4, s85, 5120
    s_add_u32 s35, s4, s86
    v_mfma_f32_16x16x32_bf16 v[136:139], v[216:219], v[208:211], v[136:139]
    s_add_u32 s85, s85, 1
    s_cmp_eq_u32 s85, 12
    s_cselect_b32 s85, 0, s85
    v_mfma_f32_16x16x32_bf16 v[144:147], v[224:227], v[208:211], v[144:147]
    s_lshl_b32 s4, s85, 12
    s_add_u32 s24, s4, s87
    v_mfma_f32_16x16x32_bf16 v[132:135], v[212:215], v[208:211], v[132:135]
    s_mul_i32 s4, s85, 5120
    s_add_u32 s36, s4, s86
    s_waitcnt lgkmcnt(13)
    v_mfma_f32_16x16x32_bf16 v[60:63], v[172:175], v[156:159], v[60:63]
    ds_read_b128 v[196:199], v51 offset:0
    s_waitcnt lgkmcnt(12)
    v_mfma_f32_16x16x32_bf16 v[72:75], v[184:187], v[156:159], v[72:75]
    ds_read_b64_tr_b16 v[212:213], v56 offset:6144
    s_waitcnt lgkmcnt(11)
    v_mfma_f32_16x16x32_bf16 v[64:67], v[176:179], v[156:159], v[64:67]
    ds_read_b64_tr_b16 v[214:215], v56 offset:6912
    s_waitcnt lgkmcnt(10)
    v_mfma_f32_16x16x32_bf16 v[76:79], v[188:191], v[156:159], v[76:79]
    ds_read_b64_tr_b16 v[224:225], v56 offset:18432
    s_waitcnt lgkmcnt(9)
    v_mfma_f32_16x16x32_bf16 v[68:71], v[180:183], v[156:159], v[68:71]
    ds_read_b64_tr_b16 v[226:227], v56 offset:19200
    s_waitcnt lgkmcnt(8)
    v_mfma_f32_16x16x32_bf16 v[80:83], v[192:195], v[156:159], v[80:83]
    ds_read_b64_tr_b16 v[216:217], v57 offset:6144
    s_waitcnt lgkmcnt(8)
    v_mfma_f32_16x16x32_bf16 v[104:107], v[192:195], v[160:163], v[104:107]
    ds_read_b64_tr_b16 v[218:219], v57 offset:6912
    v_mfma_f32_16x16x32_bf16 v[92:95], v[180:183], v[160:163], v[92:95]
    ds_read_b64_tr_b16 v[228:229], v57 offset:18432
    v_mfma_f32_16x16x32_bf16 v[100:103], v[188:191], v[160:163], v[100:103]
    ds_read_b64_tr_b16 v[230:231], v57 offset:19200
    v_mfma_f32_16x16x32_bf16 v[88:91], v[176:179], v[160:163], v[88:91]
    ds_read_b64_tr_b16 v[220:221], v56 offset:6208
    v_mfma_f32_16x16x32_bf16 v[96:99], v[184:187], v[160:163], v[96:99]
    ds_read_b64_tr_b16 v[222:223], v56 offset:6976
    v_mfma_f32_16x16x32_bf16 v[84:87], v[172:175], v[160:163], v[84:87]
    ds_read_b64_tr_b16 v[232:233], v56 offset:18496
    s_waitcnt lgkmcnt(13)
    v_mfma_f32_16x16x32_bf16 v[108:111], v[172:175], v[164:167], v[108:111]
    ds_read_b64_tr_b16 v[234:235], v56 offset:19264
    v_mfma_f32_16x16x32_bf16 v[120:123], v[184:187], v[164:167], v[120:123]
    ds_read_b128 v[200:203], v51 offset:2048
    v_mfma_f32_16x16x32_bf16 v[112:115], v[176:179], v[164:167], v[112:115]
    ds_read_b128 v[204:207], v51 offset:4096
    v_mfma_f32_16x16x32_bf16 v[124:127], v[188:191], v[164:167], v[124:127]
    ds_read_b128 v[208:211], v51 offset:6144
    v_mfma_f32_16x16x32_bf16 v[116:119], v[180:183], v[164:167], v[116:119]
    s_add_u32 s85, s85, 1
    s_cmp_eq_u32 s85, 12
    s_cselect_b32 s85, 0, s85
    v_mfma_f32_16x16x32_bf16 v[128:131], v[192:195], v[164:167], v[128:131]
    s_lshl_b32 s4, s85, 12
    s_add_u32 s25, s4, s87
    s_waitcnt lgkmcnt(15)
    v_mfma_f32_16x16x32_bf16 v[152:155], v[192:195], v[168:171], v[152:155]
    s_mul_i32 s4, s85, 5120
    s_add_u32 s37, s4, s86
    v_mfma_f32_16x16x32_bf16 v[140:143], v[180:183], v[168:171], v[140:143]
    s_add_u32 s85, s85, 1
    s_cmp_eq_u32 s85, 12
    s_cselect_b32 s85, 0, s85
    v_mfma_f32_16x16x32_bf16 v[148:151], v[188:191], v[168:171], v[148:151]
    s_lshl_b32 s4, s85, 12
    s_add_u32 s26, s4, s87
    v_mfma_f32_16x16x32_bf16 v[136:139], v[176:179], v[168:171], v[136:139]
    s_mul_i32 s4, s85, 5120
    s_add_u32 s38, s4, s86
    v_mfma_f32_16x16x32_bf16 v[144:147], v[184:187], v[168:171], v[144:147]
    s_add_u32 s85, s85, 1
    s_cmp_eq_u32 s85, 12
    s_cselect_b32 s85, 0, s85
    v_mfma_f32_16x16x32_bf16 v[132:135], v[172:175], v[168:171], v[132:135]
    s_lshl_b32 s4, s85, 12
    s_add_u32 s27, s4, s87
    s_waitcnt lgkmcnt(0)
    s_barrier
    v_mfma_f32_16x16x32_bf16 v[60:63], v[212:215], v[196:199], v[60:63]
    ds_read_b128 v[156:159], v46 offset:0
    v_mfma_f32_16x16x32_bf16 v[72:75], v[224:227], v[196:199], v[72:75]
    ds_read_b64_tr_b16 v[172:173], v52 offset:0
    v_mfma_f32_16x16x32_bf16 v[64:67], v[216:219], v[196:199], v[64:67]
    ds_read_b64_tr_b16 v[174:175], v52 offset:768
    v_mfma_f32_16x16x32_bf16 v[76:79], v[228:231], v[196:199], v[76:79]
    ds_read_b64_tr_b16 v[184:185], v52 offset:12288
    v_mfma_f32_16x16x32_bf16 v[68:71], v[220:223], v[196:199], v[68:71]
    ds_read_b64_tr_b16 v[186:187], v52 offset:13056
    v_mfma_f32_16x16x32_bf16 v[80:83], v[232:235], v[196:199], v[80:83]
    ds_read_b64_tr_b16 v[176:177], v53 offset:0
    v_mfma_f32_16x16x32_bf16 v[104:107], v[232:235], v[200:203], v[104:107]
    ds_read_b64_tr_b16 v[178:179], v53 offset:768
    v_mfma_f32_16x16x32_bf16 v[92:95], v[220:223], v[200:203], v[92:95]
    ds_read_b64_tr_b16 v[188:189], v53 offset:12288
    v_mfma_f32_16x16x32_bf16 v[100:103], v[228:231], v[200:203], v[100:103]
    ds_read_b64_tr_b16 v[190:191], v53 offset:13056
    v_mfma_f32_16x16x32_bf16 v[88:91], v[216:219], v[200:203], v[88:91]
    ds_read_b64_tr_b16 v[180:181], v52 offset:64
    v_mfma_f32_16x16x32_bf16 v[96:99], v[224:227], v[200:203], v[96:99]
    ds_read_b64_tr_b16 v[182:183], v52 offset:832
    v_mfma_f32_16x16x32_bf16 v[84:87], v[212:215], v[200:203], v[84:87]
    ds_read_b64_tr_b16 v[192:193], v52 offset:12352
    v_mfma_f32_16x16x32_bf16 v[108:111], v[212:215], v[204:207], v[108:111]
    ds_read_b64_tr_b16 v[194:195], v52 offset:13120
    v_mfma_f32_16x16x32_bf16 v[120:123], v[224:227], v[204:207], v[120:123]
    ds_read_b128 v[160:163], v46 offset:2048
    v_mfma_f32_16x16x32_bf16 v[112:115], v[216:219], v[204:207], v[112:115]
    ds_read_b128 v[164:167], v46 offset:4096
    v_mfma_f32_16x16x32_bf16 v[124:127], v[228:231], v[204:207], v[124:127]
    ds_read_b128 v[168:171], v46 offset:6144
    v_mfma_f32_16x16x32_bf16 v[116:119], v[220:223], v[204:207], v[116:119]
    s_mul_i32 s4, s85, 5120
    s_add_u32 s39, s4, s86
    v_mfma_f32_16x16x32_bf16 v[128:131], v[232:235], v[204:207], v[128:131]
    v_add_u32 v9, 4096, v6
    s_lshl_b32 s5, s3, 2
    v_mfma_f32_16x16x32_bf16 v[152:155], v[232:235], v[208:211], v[152:155]
    s_add_u32 s4, s5, 145024
    v_mov_b32 v10, s4
    v_mfma_f32_16x16x32_bf16 v[140:143], v[220:223], v[208:211], v[140:143]
    s_lshl_b32 s4, s81, 7
    s_add_u32 s59, s4, 65536
    v_mfma_f32_16x16x32_bf16 v[148:151], v[228:231], v[208:211], v[148:151]
    s_lshl_b32 s4, s79, 2
    s_add_u32 s4, s4, s3
    v_mfma_f32_16x16x32_bf16 v[136:139], v[216:219], v[208:211], v[136:139]
    s_mul_i32 s4, s4, 20480
    s_mul_i32 s5, s80, 160
    v_mfma_f32_16x16x32_bf16 v[144:147], v[224:227], v[208:211], v[144:147]
    s_add_u32 s88, s4, s5
    s_mul_i32 s13, s3, 10240
    v_mfma_f32_16x16x32_bf16 v[132:135], v[212:215], v[208:211], v[132:135]
    s_mul_i32 s4, s79, 43
    s_lshr_b32 s4, s4, 7
    s_waitcnt lgkmcnt(13)
    v_mfma_f32_16x16x32_bf16 v[60:63], v[172:175], v[156:159], v[60:63]
    ds_read_b128 v[196:199], v47 offset:0
    s_waitcnt lgkmcnt(12)
    v_mfma_f32_16x16x32_bf16 v[72:75], v[184:187], v[156:159], v[72:75]
    ds_read_b64_tr_b16 v[212:213], v52 offset:6144
    s_waitcnt lgkmcnt(11)
    v_mfma_f32_16x16x32_bf16 v[64:67], v[176:179], v[156:159], v[64:67]
    ds_read_b64_tr_b16 v[214:215], v52 offset:6912
    s_waitcnt lgkmcnt(10)
    v_mfma_f32_16x16x32_bf16 v[76:79], v[188:191], v[156:159], v[76:79]
    ds_read_b64_tr_b16 v[224:225], v52 offset:18432
    s_waitcnt lgkmcnt(9)
    v_mfma_f32_16x16x32_bf16 v[68:71], v[180:183], v[156:159], v[68:71]
    ds_read_b64_tr_b16 v[226:227], v52 offset:19200
    s_waitcnt lgkmcnt(8)
    v_mfma_f32_16x16x32_bf16 v[80:83], v[192:195], v[156:159], v[80:83]
    ds_read_b64_tr_b16 v[216:217], v53 offset:6144
    s_waitcnt lgkmcnt(8)
    v_mfma_f32_16x16x32_bf16 v[104:107], v[192:195], v[160:163], v[104:107]
    ds_read_b64_tr_b16 v[218:219], v53 offset:6912
    v_mfma_f32_16x16x32_bf16 v[92:95], v[180:183], v[160:163], v[92:95]
    ds_read_b64_tr_b16 v[228:229], v53 offset:18432
    v_mfma_f32_16x16x32_bf16 v[100:103], v[188:191], v[160:163], v[100:103]
    ds_read_b64_tr_b16 v[230:231], v53 offset:19200
    v_mfma_f32_16x16x32_bf16 v[88:91], v[176:179], v[160:163], v[88:91]
    ds_read_b64_tr_b16 v[220:221], v52 offset:6208
    v_mfma_f32_16x16x32_bf16 v[96:99], v[184:187], v[160:163], v[96:99]
    ds_read_b64_tr_b16 v[222:223], v52 offset:6976
    v_mfma_f32_16x16x32_bf16 v[84:87], v[172:175], v[160:163], v[84:87]
    ds_read_b64_tr_b16 v[232:233], v52 offset:18496
    s_waitcnt lgkmcnt(13)
    v_mfma_f32_16x16x32_bf16 v[108:111], v[172:175], v[164:167], v[108:111]
    ds_read_b64_tr_b16 v[234:235], v52 offset:19264
    v_mfma_f32_16x16x32_bf16 v[120:123], v[184:187], v[164:167], v[120:123]
    ds_read_b128 v[200:203], v47 offset:2048
    v_mfma_f32_16x16x32_bf16 v[112:115], v[176:179], v[164:167], v[112:115]
    ds_read_b128 v[204:207], v47 offset:4096
    v_mfma_f32_16x16x32_bf16 v[124:127], v[188:191], v[164:167], v[124:127]
    ds_read_b128 v[208:211], v47 offset:6144
    v_mfma_f32_16x16x32_bf16 v[116:119], v[180:183], v[164:167], v[116:119]
    s_mul_i32 s5, s4, 3
    s_sub_u32 s5, s79, s5
    v_mfma_f32_16x16x32_bf16 v[128:131], v[192:195], v[164:167], v[128:131]
    s_lshl_b32 s6, s5, 1
    s_cmp_ge_u32 s79, 30
    s_cselect_b32 s5, s6, s5
    s_cselect_b32 s7, 3, 5
    s_waitcnt lgkmcnt(15)
    v_mfma_f32_16x16x32_bf16 v[152:155], v[192:195], v[168:171], v[152:155]
    s_mul_i32 s4, s4, 24
    s_mul_i32 s6, s3, 6
    v_mfma_f32_16x16x32_bf16 v[140:143], v[180:183], v[168:171], v[140:143]
    s_add_u32 s4, s4, s6
    s_lshl_b32 s4, s4, 7
    v_mfma_f32_16x16x32_bf16 v[148:151], v[188:191], v[168:171], v[148:151]
    s_add_u32 s14, s4, 65536
    v_and_b32 v3, 7, v1
    v_mfma_f32_16x16x32_bf16 v[136:139], v[176:179], v[168:171], v[136:139]
    v_min_u32 v3, s7, v3
    v_lshlrev_b32 v11, 7, v3
    v_mfma_f32_16x16x32_bf16 v[144:147], v[184:187], v[168:171], v[144:147]
    v_mfma_f32_16x16x32_bf16 v[132:135], v[172:175], v[168:171], v[132:135]
    s_waitcnt lgkmcnt(0)
    s_barrier
    v_mfma_f32_16x16x32_bf16 v[60:63], v[212:215], v[196:199], v[60:63]
    ds_read_b128 v[156:159], v48 offset:0
    v_mfma_f32_16x16x32_bf16 v[72:75], v[224:227], v[196:199], v[72:75]
    ds_read_b64_tr_b16 v[172:173], v54 offset:0
    v_mfma_f32_16x16x32_bf16 v[64:67], v[216:219], v[196:199], v[64:67]
    ds_read_b64_tr_b16 v[174:175], v54 offset:768
    v_mfma_f32_16x16x32_bf16 v[76:79], v[228:231], v[196:199], v[76:79]
    ds_read_b64_tr_b16 v[184:185], v54 offset:12288
    v_mfma_f32_16x16x32_bf16 v[68:71], v[220:223], v[196:199], v[68:71]
    ds_read_b64_tr_b16 v[186:187], v54 offset:13056
    v_mfma_f32_16x16x32_bf16 v[80:83], v[232:235], v[196:199], v[80:83]
    ds_read_b64_tr_b16 v[176:177], v55 offset:0
    v_mfma_f32_16x16x32_bf16 v[104:107], v[232:235], v[200:203], v[104:107]
    ds_read_b64_tr_b16 v[178:179], v55 offset:768
    v_mfma_f32_16x16x32_bf16 v[92:95], v[220:223], v[200:203], v[92:95]
    ds_read_b64_tr_b16 v[188:189], v55 offset:12288
    v_mfma_f32_16x16x32_bf16 v[100:103], v[228:231], v[200:203], v[100:103]
    ds_read_b64_tr_b16 v[190:191], v55 offset:13056
    v_mfma_f32_16x16x32_bf16 v[88:91], v[216:219], v[200:203], v[88:91]
    ds_read_b64_tr_b16 v[180:181], v54 offset:64
    v_mfma_f32_16x16x32_bf16 v[96:99], v[224:227], v[200:203], v[96:99]
    ds_read_b64_tr_b16 v[182:183], v54 offset:832
    v_mfma_f32_16x16x32_bf16 v[84:87], v[212:215], v[200:203], v[84:87]
    ds_read_b64_tr_b16 v[192:193], v54 offset:12352
    v_mfma_f32_16x16x32_bf16 v[108:111], v[212:215], v[204:207], v[108:111]
    ds_read_b64_tr_b16 v[194:195], v54 offset:13120
    v_mfma_f32_16x16x32_bf16 v[120:123], v[224:227], v[204:207], v[120:123]
    ds_read_b128 v[160:163], v48 offset:2048
    v_mfma_f32_16x16x32_bf16 v[112:115], v[216:219], v[204:207], v[112:115]
    ds_read_b128 v[164:167], v48 offset:4096
    v_mfma_f32_16x16x32_bf16 v[124:127], v[228:231], v[204:207], v[124:127]
    ds_read_b128 v[168:171], v48 offset:6144
    v_mfma_f32_16x16x32_bf16 v[116:119], v[220:223], v[204:207], v[116:119]
    v_mfma_f32_16x16x32_bf16 v[128:131], v[232:235], v[204:207], v[128:131]
    v_mfma_f32_16x16x32_bf16 v[152:155], v[232:235], v[208:211], v[152:155]
    v_mfma_f32_16x16x32_bf16 v[140:143], v[220:223], v[208:211], v[140:143]
    v_mfma_f32_16x16x32_bf16 v[148:151], v[228:231], v[208:211], v[148:151]
    v_mfma_f32_16x16x32_bf16 v[136:139], v[216:219], v[208:211], v[136:139]
    v_mfma_f32_16x16x32_bf16 v[144:147], v[224:227], v[208:211], v[144:147]
    v_mfma_f32_16x16x32_bf16 v[132:135], v[212:215], v[208:211], v[132:135]
    s_waitcnt lgkmcnt(13)
    v_mfma_f32_16x16x32_bf16 v[60:63], v[172:175], v[156:159], v[60:63]
    ds_read_b128 v[196:199], v49 offset:0
    s_waitcnt lgkmcnt(12)
    v_mfma_f32_16x16x32_bf16 v[72:75], v[184:187], v[156:159], v[72:75]
    ds_read_b64_tr_b16 v[212:213], v54 offset:6144
    s_waitcnt lgkmcnt(11)
    v_mfma_f32_16x16x32_bf16 v[64:67], v[176:179], v[156:159], v[64:67]
    ds_read_b64_tr_b16 v[214:215], v54 offset:6912
    s_waitcnt lgkmcnt(10)
    v_mfma_f32_16x16x32_bf16 v[76:79], v[188:191], v[156:159], v[76:79]
    ds_read_b64_tr_b16 v[224:225], v54 offset:18432
    s_waitcnt lgkmcnt(9)
    v_mfma_f32_16x16x32_bf16 v[68:71], v[180:183], v[156:159], v[68:71]
    ds_read_b64_tr_b16 v[226:227], v54 offset:19200
    s_waitcnt lgkmcnt(8)
    v_mfma_f32_16x16x32_bf16 v[80:83], v[192:195], v[156:159], v[80:83]
    ds_read_b64_tr_b16 v[216:217], v55 offset:6144
    s_waitcnt lgkmcnt(8)
    v_mfma_f32_16x16x32_bf16 v[104:107], v[192:195], v[160:163], v[104:107]
    ds_read_b64_tr_b16 v[218:219], v55 offset:6912
    v_mfma_f32_16x16x32_bf16 v[92:95], v[180:183], v[160:163], v[92:95]
    ds_read_b64_tr_b16 v[228:229], v55 offset:18432
    v_mfma_f32_16x16x32_bf16 v[100:103], v[188:191], v[160:163], v[100:103]
    ds_read_b64_tr_b16 v[230:231], v55 offset:19200
    v_mfma_f32_16x16x32_bf16 v[88:91], v[176:179], v[160:163], v[88:91]
    ds_read_b64_tr_b16 v[220:221], v54 offset:6208
    v_mfma_f32_16x16x32_bf16 v[96:99], v[184:187], v[160:163], v[96:99]
    ds_read_b64_tr_b16 v[222:223], v54 offset:6976
    v_mfma_f32_16x16x32_bf16 v[84:87], v[172:175], v[160:163], v[84:87]
    ds_read_b64_tr_b16 v[232:233], v54 offset:18496
    s_waitcnt lgkmcnt(13)
    v_mfma_f32_16x16x32_bf16 v[108:111], v[172:175], v[164:167], v[108:111]
    ds_read_b64_tr_b16 v[234:235], v54 offset:19264
    v_mfma_f32_16x16x32_bf16 v[120:123], v[184:187], v[164:167], v[120:123]
    ds_read_b128 v[200:203], v49 offset:2048
    v_mfma_f32_16x16x32_bf16 v[112:115], v[176:179], v[164:167], v[112:115]
    ds_read_b128 v[204:207], v49 offset:4096
    v_mfma_f32_16x16x32_bf16 v[124:127], v[188:191], v[164:167], v[124:127]
    ds_read_b128 v[208:211], v49 offset:6144
    v_mfma_f32_16x16x32_bf16 v[116:119], v[180:183], v[164:167], v[116:119]
    v_mfma_f32_16x16x32_bf16 v[128:131], v[192:195], v[164:167], v[128:131]
    s_waitcnt lgkmcnt(15)
    v_mfma_f32_16x16x32_bf16 v[152:155], v[192:195], v[168:171], v[152:155]
    v_mfma_f32_16x16x32_bf16 v[140:143], v[180:183], v[168:171], v[140:143]
    v_mfma_f32_16x16x32_bf16 v[148:151], v[188:191], v[168:171], v[148:151]
    v_mfma_f32_16x16x32_bf16 v[136:139], v[176:179], v[168:171], v[136:139]
    v_mfma_f32_16x16x32_bf16 v[144:147], v[184:187], v[168:171], v[144:147]
    v_mfma_f32_16x16x32_bf16 v[132:135], v[172:175], v[168:171], v[132:135]
    s_waitcnt lgkmcnt(0)
    s_barrier
    v_mfma_f32_16x16x32_bf16 v[60:63], v[212:215], v[196:199], v[60:63]
    ds_read_b128 v[156:159], v50 offset:0
    v_mfma_f32_16x16x32_bf16 v[72:75], v[224:227], v[196:199], v[72:75]
    ds_read_b64_tr_b16 v[172:173], v56 offset:0
    v_mfma_f32_16x16x32_bf16 v[64:67], v[216:219], v[196:199], v[64:67]
    ds_read_b64_tr_b16 v[174:175], v56 offset:768
    v_mfma_f32_16x16x32_bf16 v[76:79], v[228:231], v[196:199], v[76:79]
    ds_read_b64_tr_b16 v[184:185], v56 offset:12288
    v_mfma_f32_16x16x32_bf16 v[68:71], v[220:223], v[196:199], v[68:71]
    ds_read_b64_tr_b16 v[186:187], v56 offset:13056
    v_mfma_f32_16x16x32_bf16 v[80:83], v[232:235], v[196:199], v[80:83]
    ds_read_b64_tr_b16 v[176:177], v57 offset:0
    v_mfma_f32_16x16x32_bf16 v[104:107], v[232:235], v[200:203], v[104:107]
    ds_read_b64_tr_b16 v[178:179], v57 offset:768
    v_mfma_f32_16x16x32_bf16 v[92:95], v[220:223], v[200:203], v[92:95]
    ds_read_b64_tr_b16 v[188:189], v57 offset:12288
    v_mfma_f32_16x16x32_bf16 v[100:103], v[228:231], v[200:203], v[100:103]
    ds_read_b64_tr_b16 v[190:191], v57 offset:13056
    v_mfma_f32_16x16x32_bf16 v[88:91], v[216:219], v[200:203], v[88:91]
    ds_read_b64_tr_b16 v[180:181], v56 offset:64
    v_mfma_f32_16x16x32_bf16 v[96:99], v[224:227], v[200:203], v[96:99]
    ds_read_b64_tr_b16 v[182:183], v56 offset:832
    v_mfma_f32_16x16x32_bf16 v[84:87], v[212:215], v[200:203], v[84:87]
    ds_read_b64_tr_b16 v[192:193], v56 offset:12352
    v_mfma_f32_16x16x32_bf16 v[108:111], v[212:215], v[204:207], v[108:111]
    ds_read_b64_tr_b16 v[194:195], v56 offset:13120
    v_mfma_f32_16x16x32_bf16 v[120:123], v[224:227], v[204:207], v[120:123]
    ds_read_b128 v[160:163], v50 offset:2048
    v_mfma_f32_16x16x32_bf16 v[112:115], v[216:219], v[204:207], v[112:115]
    ds_read_b128 v[164:167], v50 offset:4096
    v_mfma_f32_16x16x32_bf16 v[124:127], v[228:231], v[204:207], v[124:127]
    ds_read_b128 v[168:171], v50 offset:6144
    v_mfma_f32_16x16x32_bf16 v[116:119], v[220:223], v[204:207], v[116:119]
    v_mfma_f32_16x16x32_bf16 v[128:131], v[232:235], v[204:207], v[128:131]
    v_mfma_f32_16x16x32_bf16 v[152:155], v[232:235], v[208:211], v[152:155]
    v_mfma_f32_16x16x32_bf16 v[140:143], v[220:223], v[208:211], v[140:143]
    v_mfma_f32_16x16x32_bf16 v[148:151], v[228:231], v[208:211], v[148:151]
    v_mfma_f32_16x16x32_bf16 v[136:139], v[216:219], v[208:211], v[136:139]
    v_mfma_f32_16x16x32_bf16 v[144:147], v[224:227], v[208:211], v[144:147]
    v_mfma_f32_16x16x32_bf16 v[132:135], v[212:215], v[208:211], v[132:135]
    s_waitcnt lgkmcnt(13)
    v_mfma_f32_16x16x32_bf16 v[60:63], v[172:175], v[156:159], v[60:63]
    ds_read_b128 v[196:199], v51 offset:0
    s_waitcnt lgkmcnt(12)
    v_mfma_f32_16x16x32_bf16 v[72:75], v[184:187], v[156:159], v[72:75]
    ds_read_b64_tr_b16 v[212:213], v56 offset:6144
    s_waitcnt lgkmcnt(11)
    v_mfma_f32_16x16x32_bf16 v[64:67], v[176:179], v[156:159], v[64:67]
    ds_read_b64_tr_b16 v[214:215], v56 offset:6912
    s_waitcnt lgkmcnt(10)
    v_mfma_f32_16x16x32_bf16 v[76:79], v[188:191], v[156:159], v[76:79]
    ds_read_b64_tr_b16 v[224:225], v56 offset:18432
    s_waitcnt lgkmcnt(9)
    v_mfma_f32_16x16x32_bf16 v[68:71], v[180:183], v[156:159], v[68:71]
    ds_read_b64_tr_b16 v[226:227], v56 offset:19200
    s_waitcnt lgkmcnt(8)
    v_mfma_f32_16x16x32_bf16 v[80:83], v[192:195], v[156:159], v[80:83]
    ds_read_b64_tr_b16 v[216:217], v57 offset:6144
    s_waitcnt lgkmcnt(8)
    v_mfma_f32_16x16x32_bf16 v[104:107], v[192:195], v[160:163], v[104:107]
    ds_read_b64_tr_b16 v[218:219], v57 offset:6912
    v_mfma_f32_16x16x32_bf16 v[92:95], v[180:183], v[160:163], v[92:95]
    ds_read_b64_tr_b16 v[228:229], v57 offset:18432
    v_mfma_f32_16x16x32_bf16 v[100:103], v[188:191], v[160:163], v[100:103]
    ds_read_b64_tr_b16 v[230:231], v57 offset:19200
    v_mfma_f32_16x16x32_bf16 v[88:91], v[176:179], v[160:163], v[88:91]
    ds_read_b64_tr_b16 v[220:221], v56 offset:6208
    v_mfma_f32_16x16x32_bf16 v[96:99], v[184:187], v[160:163], v[96:99]
    ds_read_b64_tr_b16 v[222:223], v56 offset:6976
    v_mfma_f32_16x16x32_bf16 v[84:87], v[172:175], v[160:163], v[84:87]
    ds_read_b64_tr_b16 v[232:233], v56 offset:18496
    s_waitcnt lgkmcnt(13)
    v_mfma_f32_16x16x32_bf16 v[108:111], v[172:175], v[164:167], v[108:111]
    ds_read_b64_tr_b16 v[234:235], v56 offset:19264
    v_mfma_f32_16x16x32_bf16 v[120:123], v[184:187], v[164:167], v[120:123]
    ds_read_b128 v[200:203], v51 offset:2048
    v_mfma_f32_16x16x32_bf16 v[112:115], v[176:179], v[164:167], v[112:115]
    ds_read_b128 v[204:207], v51 offset:4096
    v_mfma_f32_16x16x32_bf16 v[124:127], v[188:191], v[164:167], v[124:127]
    ds_read_b128 v[208:211], v51 offset:6144
    v_mfma_f32_16x16x32_bf16 v[116:119], v[180:183], v[164:167], v[116:119]
    v_mfma_f32_16x16x32_bf16 v[128:131], v[192:195], v[164:167], v[128:131]
    s_waitcnt lgkmcnt(15)
    v_mfma_f32_16x16x32_bf16 v[152:155], v[192:195], v[168:171], v[152:155]
    v_mfma_f32_16x16x32_bf16 v[140:143], v[180:183], v[168:171], v[140:143]
    v_mfma_f32_16x16x32_bf16 v[148:151], v[188:191], v[168:171], v[148:151]
    v_mfma_f32_16x16x32_bf16 v[136:139], v[176:179], v[168:171], v[136:139]
    v_mfma_f32_16x16x32_bf16 v[144:147], v[184:187], v[168:171], v[144:147]
    v_mfma_f32_16x16x32_bf16 v[132:135], v[172:175], v[168:171], v[132:135]
    v_readfirstlane_b32 s78, v7
    s_nop 1
    s_cmp_lg_u32 s78, 0
    s_cbranch_scc1 NOND_10
    s_mov_b32 s4, 0
NON_9:
    global_load_dword v7, v8, s[44:45] sc1
    s_waitcnt vmcnt(0)
    v_readfirstlane_b32 s78, v7
    s_add_u32 s4, s4, 1
    s_cmp_ge_u32 s4, 0x20000
    s_cbranch_scc1 NOND_10
    s_cmp_eq_u32 s78, 0
    s_cbranch_scc1 NON_9
NOND_10:
    s_waitcnt lgkmcnt(0)
    s_barrier
    v_mfma_f32_16x16x32_bf16 v[60:63], v[212:215], v[196:199], v[60:63]
    ds_read_b128 v[156:159], v46 offset:0
    v_mfma_f32_16x16x32_bf16 v[72:75], v[224:227], v[196:199], v[72:75]
    ds_read_b64_tr_b16 v[172:173], v52 offset:0
    v_mfma_f32_16x16x32_bf16 v[64:67], v[216:219], v[196:199], v[64:67]
    ds_read_b64_tr_b16 v[174:175], v52 offset:768
    v_mfma_f32_16x16x32_bf16 v[76:79], v[228:231], v[196:199], v[76:79]
    ds_read_b64_tr_b16 v[184:185], v52 offset:12288
    v_mfma_f32_16x16x32_bf16 v[68:71], v[220:223], v[196:199], v[68:71]
    ds_read_b64_tr_b16 v[186:187], v52 offset:13056
    v_mfma_f32_16x16x32_bf16 v[80:83], v[232:235], v[196:199], v[80:83]
    ds_read_b64_tr_b16 v[176:177], v53 offset:0
    v_mfma_f32_16x16x32_bf16 v[104:107], v[232:235], v[200:203], v[104:107]
    ds_read_b64_tr_b16 v[178:179], v53 offset:768
    v_mfma_f32_16x16x32_bf16 v[92:95], v[220:223], v[200:203], v[92:95]
    ds_read_b64_tr_b16 v[188:189], v53 offset:12288
    v_mfma_f32_16x16x32_bf16 v[100:103], v[228:231], v[200:203], v[100:103]
    ds_read_b64_tr_b16 v[190:191], v53 offset:13056
    v_mfma_f32_16x16x32_bf16 v[88:91], v[216:219], v[200:203], v[88:91]
    ds_read_b64_tr_b16 v[180:181], v52 offset:64
    v_mfma_f32_16x16x32_bf16 v[96:99], v[224:227], v[200:203], v[96:99]
    ds_read_b64_tr_b16 v[182:183], v52 offset:832
    v_mfma_f32_16x16x32_bf16 v[84:87], v[212:215], v[200:203], v[84:87]
    ds_read_b64_tr_b16 v[192:193], v52 offset:12352
    v_mfma_f32_16x16x32_bf16 v[108:111], v[212:215], v[204:207], v[108:111]
    ds_read_b64_tr_b16 v[194:195], v52 offset:13120
    v_mfma_f32_16x16x32_bf16 v[120:123], v[224:227], v[204:207], v[120:123]
    ds_read_b128 v[160:163], v46 offset:2048
    v_mfma_f32_16x16x32_bf16 v[112:115], v[216:219], v[204:207], v[112:115]
    ds_read_b128 v[164:167], v46 offset:4096
    v_mfma_f32_16x16x32_bf16 v[124:127], v[228:231], v[204:207], v[124:127]
    ds_read_b128 v[168:171], v46 offset:6144
    v_mfma_f32_16x16x32_bf16 v[116:119], v[220:223], v[204:207], v[116:119]
    buffer_load_dwordx2 v[20:21], v5, s[64:67], s12 offen offset:0 sc1
    v_mfma_f32_16x16x32_bf16 v[128:131], v[232:235], v[204:207], v[128:131]
    v_mfma_f32_16x16x32_bf16 v[152:155], v[232:235], v[208:211], v[152:155]
    buffer_load_dwordx2 v[22:23], v5, s[64:67], s12 offen offset:128 sc1
    v_mfma_f32_16x16x32_bf16 v[140:143], v[220:223], v[208:211], v[140:143]
    v_mfma_f32_16x16x32_bf16 v[148:151], v[228:231], v[208:211], v[148:151]
    buffer_load_dwordx2 v[24:25], v5, s[64:67], s12 offen offset:256 sc1
    v_mfma_f32_16x16x32_bf16 v[136:139], v[216:219], v[208:211], v[136:139]
    v_mfma_f32_16x16x32_bf16 v[144:147], v[224:227], v[208:211], v[144:147]
    buffer_load_dwordx2 v[26:27], v5, s[64:67], s12 offen offset:384 sc1
    v_mfma_f32_16x16x32_bf16 v[132:135], v[212:215], v[208:211], v[132:135]
    s_waitcnt lgkmcnt(13)
    v_mfma_f32_16x16x32_bf16 v[60:63], v[172:175], v[156:159], v[60:63]
    ds_read_b128 v[196:199], v47 offset:0
    s_waitcnt lgkmcnt(12)
    v_mfma_f32_16x16x32_bf16 v[72:75], v[184:187], v[156:159], v[72:75]
    ds_read_b64_tr_b16 v[212:213], v52 offset:6144
    s_waitcnt lgkmcnt(11)
    v_mfma_f32_16x16x32_bf16 v[64:67], v[176:179], v[156:159], v[64:67]
    ds_read_b64_tr_b16 v[214:215], v52 offset:6912
    s_waitcnt lgkmcnt(10)
    v_mfma_f32_16x16x32_bf16 v[76:79], v[188:191], v[156:159], v[76:79]
    ds_read_b64_tr_b16 v[224:225], v52 offset:18432
    s_waitcnt lgkmcnt(9)
    v_mfma_f32_16x16x32_bf16 v[68:71], v[180:183], v[156:159], v[68:71]
    ds_read_b64_tr_b16 v[226:227], v52 offset:19200
    s_waitcnt lgkmcnt(8)
    v_mfma_f32_16x16x32_bf16 v[80:83], v[192:195], v[156:159], v[80:83]
    ds_read_b64_tr_b16 v[216:217], v53 offset:6144
    s_waitcnt lgkmcnt(8)
    v_mfma_f32_16x16x32_bf16 v[104:107], v[192:195], v[160:163], v[104:107]
    ds_read_b64_tr_b16 v[218:219], v53 offset:6912
    v_mfma_f32_16x16x32_bf16 v[92:95], v[180:183], v[160:163], v[92:95]
    ds_read_b64_tr_b16 v[228:229], v53 offset:18432
    v_mfma_f32_16x16x32_bf16 v[100:103], v[188:191], v[160:163], v[100:103]
    ds_read_b64_tr_b16 v[230:231], v53 offset:19200
    v_mfma_f32_16x16x32_bf16 v[88:91], v[176:179], v[160:163], v[88:91]
    ds_read_b64_tr_b16 v[220:221], v52 offset:6208
    v_mfma_f32_16x16x32_bf16 v[96:99], v[184:187], v[160:163], v[96:99]
    ds_read_b64_tr_b16 v[222:223], v52 offset:6976
    v_mfma_f32_16x16x32_bf16 v[84:87], v[172:175], v[160:163], v[84:87]
    ds_read_b64_tr_b16 v[232:233], v52 offset:18496
    s_waitcnt lgkmcnt(13)
    v_mfma_f32_16x16x32_bf16 v[108:111], v[172:175], v[164:167], v[108:111]
    ds_read_b64_tr_b16 v[234:235], v52 offset:19264
    v_mfma_f32_16x16x32_bf16 v[120:123], v[184:187], v[164:167], v[120:123]
    ds_read_b128 v[200:203], v47 offset:2048
    v_mfma_f32_16x16x32_bf16 v[112:115], v[176:179], v[164:167], v[112:115]
    ds_read_b128 v[204:207], v47 offset:4096
    v_mfma_f32_16x16x32_bf16 v[124:127], v[188:191], v[164:167], v[124:127]
    ds_read_b128 v[208:211], v47 offset:6144
    v_mfma_f32_16x16x32_bf16 v[116:119], v[180:183], v[164:167], v[116:119]
    v_mfma_f32_16x16x32_bf16 v[128:131], v[192:195], v[164:167], v[128:131]
    s_waitcnt lgkmcnt(15)
    v_mfma_f32_16x16x32_bf16 v[152:155], v[192:195], v[168:171], v[152:155]
    v_mfma_f32_16x16x32_bf16 v[140:143], v[180:183], v[168:171], v[140:143]
    v_mfma_f32_16x16x32_bf16 v[148:151], v[188:191], v[168:171], v[148:151]
    v_mfma_f32_16x16x32_bf16 v[136:139], v[176:179], v[168:171], v[136:139]
    v_mfma_f32_16x16x32_bf16 v[144:147], v[184:187], v[168:171], v[144:147]
    v_mfma_f32_16x16x32_bf16 v[132:135], v[172:175], v[168:171], v[132:135]
    s_waitcnt lgkmcnt(0)
    s_barrier
    v_mfma_f32_16x16x32_bf16 v[60:63], v[212:215], v[196:199], v[60:63]
    ds_read_b128 v[156:159], v48 offset:0
    v_mfma_f32_16x16x32_bf16 v[72:75], v[224:227], v[196:199], v[72:75]
    ds_read_b64_tr_b16 v[172:173], v54 offset:0
    v_mfma_f32_16x16x32_bf16 v[64:67], v[216:219], v[196:199], v[64:67]
    ds_read_b64_tr_b16 v[174:175], v54 offset:768
    v_mfma_f32_16x16x32_bf16 v[76:79], v[228:231], v[196:199], v[76:79]
    ds_read_b64_tr_b16 v[184:185], v54 offset:12288
    v_mfma_f32_16x16x32_bf16 v[68:71], v[220:223], v[196:199], v[68:71]
    ds_read_b64_tr_b16 v[186:187], v54 offset:13056
    v_mfma_f32_16x16x32_bf16 v[80:83], v[232:235], v[196:199], v[80:83]
    ds_read_b64_tr_b16 v[176:177], v55 offset:0
    v_mfma_f32_16x16x32_bf16 v[104:107], v[232:235], v[200:203], v[104:107]
    ds_read_b64_tr_b16 v[178:179], v55 offset:768
    v_mfma_f32_16x16x32_bf16 v[92:95], v[220:223], v[200:203], v[92:95]
    ds_read_b64_tr_b16 v[188:189], v55 offset:12288
    v_mfma_f32_16x16x32_bf16 v[100:103], v[228:231], v[200:203], v[100:103]
    ds_read_b64_tr_b16 v[190:191], v55 offset:13056
    v_mfma_f32_16x16x32_bf16 v[88:91], v[216:219], v[200:203], v[88:91]
    ds_read_b64_tr_b16 v[180:181], v54 offset:64
    v_mfma_f32_16x16x32_bf16 v[96:99], v[224:227], v[200:203], v[96:99]
    ds_read_b64_tr_b16 v[182:183], v54 offset:832
    v_mfma_f32_16x16x32_bf16 v[84:87], v[212:215], v[200:203], v[84:87]
    ds_read_b64_tr_b16 v[192:193], v54 offset:12352
    v_mfma_f32_16x16x32_bf16 v[108:111], v[212:215], v[204:207], v[108:111]
    ds_read_b64_tr_b16 v[194:195], v54 offset:13120
    v_mfma_f32_16x16x32_bf16 v[120:123], v[224:227], v[204:207], v[120:123]
    ds_read_b128 v[160:163], v48 offset:2048
    v_mfma_f32_16x16x32_bf16 v[112:115], v[216:219], v[204:207], v[112:115]
    ds_read_b128 v[164:167], v48 offset:4096
    v_mfma_f32_16x16x32_bf16 v[124:127], v[228:231], v[204:207], v[124:127]
    ds_read_b128 v[168:171], v48 offset:6144
    v_mfma_f32_16x16x32_bf16 v[116:119], v[220:223], v[204:207], v[116:119]
    v_mfma_f32_16x16x32_bf16 v[128:131], v[232:235], v[204:207], v[128:131]
    v_mfma_f32_16x16x32_bf16 v[152:155], v[232:235], v[208:211], v[152:155]
    v_mfma_f32_16x16x32_bf16 v[140:143], v[220:223], v[208:211], v[140:143]
    v_mfma_f32_16x16x32_bf16 v[148:151], v[228:231], v[208:211], v[148:151]
    v_mfma_f32_16x16x32_bf16 v[136:139], v[216:219], v[208:211], v[136:139]
    v_mfma_f32_16x16x32_bf16 v[144:147], v[224:227], v[208:211], v[144:147]
    v_mfma_f32_16x16x32_bf16 v[132:135], v[212:215], v[208:211], v[132:135]
    s_waitcnt lgkmcnt(13)
    v_mfma_f32_16x16x32_bf16 v[60:63], v[172:175], v[156:159], v[60:63]
    ds_read_b128 v[196:199], v49 offset:0
    s_waitcnt lgkmcnt(12)
    v_mfma_f32_16x16x32_bf16 v[72:75], v[184:187], v[156:159], v[72:75]
    ds_read_b64_tr_b16 v[212:213], v54 offset:6144
    s_waitcnt lgkmcnt(11)
    v_mfma_f32_16x16x32_bf16 v[64:67], v[176:179], v[156:159], v[64:67]
    ds_read_b64_tr_b16 v[214:215], v54 offset:6912
    s_waitcnt lgkmcnt(10)
    v_mfma_f32_16x16x32_bf16 v[76:79], v[188:191], v[156:159], v[76:79]
    ds_read_b64_tr_b16 v[224:225], v54 offset:18432
    s_waitcnt lgkmcnt(9)
    v_mfma_f32_16x16x32_bf16 v[68:71], v[180:183], v[156:159], v[68:71]
    ds_read_b64_tr_b16 v[226:227], v54 offset:19200
    s_waitcnt lgkmcnt(8)
    v_mfma_f32_16x16x32_bf16 v[80:83], v[192:195], v[156:159], v[80:83]
    ds_read_b64_tr_b16 v[216:217], v55 offset:6144
    s_waitcnt lgkmcnt(8)
    v_mfma_f32_16x16x32_bf16 v[104:107], v[192:195], v[160:163], v[104:107]
    ds_read_b64_tr_b16 v[218:219], v55 offset:6912
    v_mfma_f32_16x16x32_bf16 v[92:95], v[180:183], v[160:163], v[92:95]
    ds_read_b64_tr_b16 v[228:229], v55 offset:18432
    v_mfma_f32_16x16x32_bf16 v[100:103], v[188:191], v[160:163], v[100:103]
    ds_read_b64_tr_b16 v[230:231], v55 offset:19200
    v_mfma_f32_16x16x32_bf16 v[88:91], v[176:179], v[160:163], v[88:91]
    ds_read_b64_tr_b16 v[220:221], v54 offset:6208
    v_mfma_f32_16x16x32_bf16 v[96:99], v[184:187], v[160:163], v[96:99]
    ds_read_b64_tr_b16 v[222:223], v54 offset:6976
    v_mfma_f32_16x16x32_bf16 v[84:87], v[172:175], v[160:163], v[84:87]
    ds_read_b64_tr_b16 v[232:233], v54 offset:18496
    s_waitcnt lgkmcnt(13)
    v_mfma_f32_16x16x32_bf16 v[108:111], v[172:175], v[164:167], v[108:111]
    ds_read_b64_tr_b16 v[234:235], v54 offset:19264
    v_mfma_f32_16x16x32_bf16 v[120:123], v[184:187], v[164:167], v[120:123]
    ds_read_b128 v[200:203], v49 offset:2048
    v_mfma_f32_16x16x32_bf16 v[112:115], v[176:179], v[164:167], v[112:115]
    ds_read_b128 v[204:207], v49 offset:4096
    v_mfma_f32_16x16x32_bf16 v[124:127], v[188:191], v[164:167], v[124:127]
    ds_read_b128 v[208:211], v49 offset:6144
    v_mfma_f32_16x16x32_bf16 v[116:119], v[180:183], v[164:167], v[116:119]
    buffer_load_dwordx4 v[12:15], v6, s[64:67], s28 offen offset:0 sc1
    v_mfma_f32_16x16x32_bf16 v[128:131], v[192:195], v[164:167], v[128:131]
    s_waitcnt lgkmcnt(15)
    v_mfma_f32_16x16x32_bf16 v[152:155], v[192:195], v[168:171], v[152:155]
    v_and_b32 v7, 3, v1
    v_lshlrev_b32 v7, 2, v7
    v_mfma_f32_16x16x32_bf16 v[140:143], v[180:183], v[168:171], v[140:143]
    v_add_u32 v7, 145120, v7
    v_mfma_f32_16x16x32_bf16 v[148:151], v[188:191], v[168:171], v[148:151]
    buffer_load_dwordx4 v[16:19], v6, s[64:67], s28 offen offset:1024 sc1
    v_mfma_f32_16x16x32_bf16 v[136:139], v[176:179], v[168:171], v[136:139]
    v_mfma_f32_16x16x32_bf16 v[144:147], v[184:187], v[168:171], v[144:147]
    buffer_load_dwordx4 v[32:35], v6, s[64:67], s28 offen offset:2048 sc1
    v_mfma_f32_16x16x32_bf16 v[132:135], v[172:175], v[168:171], v[132:135]
    s_waitcnt lgkmcnt(13)
    v_mfma_f32_16x16x32_bf16 v[60:63], v[212:215], v[196:199], v[60:63]
    ds_read_b32 v8, v7
    s_waitcnt lgkmcnt(12)
    v_mfma_f32_16x16x32_bf16 v[72:75], v[224:227], v[196:199], v[72:75]
    v_lshrrev_b32 v3, 4, v1
    v_cmp_gt_u32 s[10:11], 2, v3
    v_cmp_ne_u32 s[6:7], 2, v3
    s_waitcnt lgkmcnt(10)
    v_mfma_f32_16x16x32_bf16 v[64:67], v[216:219], v[196:199], v[64:67]
    s_waitcnt vmcnt(6)
    v_cndmask_b32 v156, 0, v20, s[10:11]
    v_cndmask_b32 v157, 0, v20, s[10:11]
    v_cndmask_b32 v158, 0, v20, s[6:7]
    s_waitcnt lgkmcnt(8)
    v_mfma_f32_16x16x32_bf16 v[76:79], v[228:231], v[196:199], v[76:79]
    v_cndmask_b32 v159, 0, v20, s[6:7]
    s_waitcnt vmcnt(5)
    v_cndmask_b32 v160, 0, v22, s[10:11]
    v_cndmask_b32 v161, 0, v22, s[10:11]
    s_waitcnt lgkmcnt(6)
    v_mfma_f32_16x16x32_bf16 v[68:71], v[220:223], v[196:199], v[68:71]
    v_cndmask_b32 v162, 0, v22, s[6:7]
    v_cndmask_b32 v163, 0, v22, s[6:7]
    s_waitcnt vmcnt(4)
    v_cndmask_b32 v164, 0, v24, s[10:11]
    s_waitcnt lgkmcnt(4)
    v_mfma_f32_16x16x32_bf16 v[80:83], v[232:235], v[196:199], v[80:83]
    v_cndmask_b32 v165, 0, v24, s[10:11]
    v_cndmask_b32 v166, 0, v24, s[6:7]
    v_cndmask_b32 v167, 0, v24, s[6:7]
    s_waitcnt lgkmcnt(3)
    v_mfma_f32_16x16x32_bf16 v[104:107], v[232:235], v[200:203], v[104:107]
    s_waitcnt lgkmcnt(0)
    v_cmp_eq_u32 vcc, 0, v8
    s_nop 1
    s_cbranch_vccnz FC_11
FCB_12:
    v_mfma_f32_16x16x32_bf16 v[92:95], v[220:223], v[200:203], v[92:95]
    ds_read_b64_tr_b16 v[172:173], v58 offset:0
    v_mfma_f32_16x16x32_bf16 v[100:103], v[228:231], v[200:203], v[100:103]
    ds_read_b64_tr_b16 v[174:175], v58 offset:768
    v_mfma_f32_16x16x32_bf16 v[88:91], v[216:219], v[200:203], v[88:91]
    ds_read_b64_tr_b16 v[184:185], v58 offset:6144
    v_mfma_f32_16x16x32_bf16 v[96:99], v[224:227], v[200:203], v[96:99]
    ds_read_b64_tr_b16 v[186:187], v58 offset:6912
    v_mfma_f32_16x16x32_bf16 v[84:87], v[212:215], v[200:203], v[84:87]
    ds_read_b64_tr_b16 v[176:177], v59 offset:0
    v_mfma_f32_16x16x32_bf16 v[108:111], v[212:215], v[204:207], v[108:111]
    ds_read_b64_tr_b16 v[178:179], v59 offset:768
    v_mfma_f32_16x16x32_bf16 v[120:123], v[224:227], v[204:207], v[120:123]
    ds_read_b64_tr_b16 v[188:189], v59 offset:6144
    v_mfma_f32_16x16x32_bf16 v[112:115], v[216:219], v[204:207], v[112:115]
    ds_read_b64_tr_b16 v[190:191], v59 offset:6912
    v_mfma_f32_16x16x32_bf16 v[124:127], v[228:231], v[204:207], v[124:127]
    ds_read_b64_tr_b16 v[180:181], v58 offset:64
    v_mfma_f32_16x16x32_bf16 v[116:119], v[220:223], v[204:207], v[116:119]
    ds_read_b64_tr_b16 v[182:183], v58 offset:832
    v_mfma_f32_16x16x32_bf16 v[128:131], v[232:235], v[204:207], v[128:131]
    ds_read_b64_tr_b16 v[192:193], v58 offset:6208
    v_mfma_f32_16x16x32_bf16 v[152:155], v[232:235], v[208:211], v[152:155]
    ds_read_b64_tr_b16 v[194:195], v58 offset:6976
    v_mfma_f32_16x16x32_bf16 v[140:143], v[220:223], v[208:211], v[140:143]
    s_waitcnt vmcnt(3)
    v_cndmask_b32 v168, 0, v26, s[10:11]
    v_cndmask_b32 v169, 0, v26, s[10:11]
    v_cndmask_b32 v170, 0, v26, s[6:7]
    v_mfma_f32_16x16x32_bf16 v[148:151], v[228:231], v[208:211], v[148:151]
    v_cndmask_b32 v171, 0, v26, s[6:7]
    v_mfma_f32_16x16x32_bf16 v[136:139], v[216:219], v[208:211], v[136:139]
    v_mfma_f32_16x16x32_bf16 v[144:147], v[224:227], v[208:211], v[144:147]
    v_mfma_f32_16x16x32_bf16 v[132:135], v[212:215], v[208:211], v[132:135]
    buffer_load_dwordx4 v[36:39], v6, s[64:67], s28 offen offset:3072 sc1
    buffer_load_dwordx4 v[40:43], v9, s[64:67], s28 offen offset:0 sc1
    buffer_load_dwordx4 v[236:239], v6, s[64:67], s29 offen offset:0 sc1
    buffer_load_dwordx4 v[240:243], v6, s[64:67], s29 offen offset:1024 sc1
    buffer_load_dwordx4 v[244:247], v6, s[64:67], s29 offen offset:2048 sc1
    buffer_load_dwordx4 v[248:251], v6, s[64:67], s29 offen offset:3072 sc1
    buffer_load_dwordx4 v[252:255], v9, s[64:67], s29 offen offset:0 sc1
    ds_write_b32 v10, v10 offset:64
    s_waitcnt lgkmcnt(11)
    v_mfma_f32_16x16x32_bf16 v[60:63], v[172:175], v[156:159], v[60:63]
    v_rcp_f32 v3, v21
    v_mul_f32 v208, v21, v21
    s_waitcnt lgkmcnt(9)
    v_mfma_f32_16x16x32_bf16 v[72:75], v[184:187], v[156:159], v[72:75]
    v_mul_f32 v196, 0xc0135761, v3
    v_mul_f32 v4, v3, v3
    s_waitcnt lgkmcnt(7)
    v_mfma_f32_16x16x32_bf16 v[64:67], v[176:179], v[156:159], v[64:67]
    v_mul_f32 v4, 0x3d372713, v4
    v_mul_f32 v197, v4, v196
    s_waitcnt lgkmcnt(5)
    v_mfma_f32_16x16x32_bf16 v[76:79], v[188:191], v[156:159], v[76:79]
    v_rcp_f32 v3, v23
    v_mul_f32 v209, v23, v23
    s_waitcnt lgkmcnt(3)
    v_mfma_f32_16x16x32_bf16 v[68:71], v[180:183], v[156:159], v[68:71]
    v_mul_f32 v198, 0xc0135761, v3
    v_mul_f32 v4, v3, v3
    s_waitcnt lgkmcnt(1)
    v_mfma_f32_16x16x32_bf16 v[80:83], v[192:195], v[156:159], v[80:83]
    v_mul_f32 v4, 0x3d372713, v4
    v_mul_f32 v199, v4, v198
    v_mfma_f32_16x16x32_bf16 v[104:107], v[192:195], v[160:163], v[104:107]
    v_rcp_f32 v3, v25
    v_mul_f32 v210, v25, v25
    v_mfma_f32_16x16x32_bf16 v[92:95], v[180:183], v[160:163], v[92:95]
    v_mul_f32 v200, 0xc0135761, v3
    v_mul_f32 v4, v3, v3
    v_mfma_f32_16x16x32_bf16 v[100:103], v[188:191], v[160:163], v[100:103]
    v_mul_f32 v4, 0x3d372713, v4
    v_mul_f32 v201, v4, v200
    v_mfma_f32_16x16x32_bf16 v[88:91], v[176:179], v[160:163], v[88:91]
    v_rcp_f32 v3, v27
    v_mul_f32 v211, v27, v27
    v_mfma_f32_16x16x32_bf16 v[96:99], v[184:187], v[160:163], v[96:99]
    v_mul_f32 v202, 0xc0135761, v3
    v_mul_f32 v4, v3, v3
    v_mfma_f32_16x16x32_bf16 v[84:87], v[172:175], v[160:163], v[84:87]
    v_mul_f32 v4, 0x3d372713, v4
    v_mul_f32 v203, v4, v202
    v_mfma_f32_16x16x32_bf16 v[108:111], v[172:175], v[164:167], v[108:111]
    v_mfma_f32_16x16x32_bf16 v[120:123], v[184:187], v[164:167], v[120:123]
    v_mfma_f32_16x16x32_bf16 v[112:115], v[176:179], v[164:167], v[112:115]
    v_mfma_f32_16x16x32_bf16 v[124:127], v[188:191], v[164:167], v[124:127]
    v_mfma_f32_16x16x32_bf16 v[116:119], v[180:183], v[164:167], v[116:119]
    v_mfma_f32_16x16x32_bf16 v[128:131], v[192:195], v[164:167], v[128:131]
    v_mfma_f32_16x16x32_bf16 v[152:155], v[192:195], v[168:171], v[152:155]
    v_mfma_f32_16x16x32_bf16 v[140:143], v[180:183], v[168:171], v[140:143]
    v_mfma_f32_16x16x32_bf16 v[148:151], v[188:191], v[168:171], v[148:151]
    v_mfma_f32_16x16x32_bf16 v[136:139], v[176:179], v[168:171], v[136:139]
    v_mfma_f32_16x16x32_bf16 v[144:147], v[184:187], v[168:171], v[144:147]
    v_mfma_f32_16x16x32_bf16 v[132:135], v[172:175], v[168:171], v[132:135]
.p2align 3
    v_pk_mul_f32 v[216:217], v[60:61], v[60:61]
    v_pk_mul_f32 v[218:219], v[62:63], v[62:63]
    v_pk_mul_f32 v[220:221], v[84:85], v[84:85]
    v_pk_mul_f32 v[222:223], v[86:87], v[86:87]
    v_pk_fma_f32 v[216:217], v[216:217], v[196:197], v[196:197] op_sel:[0,1,0] op_sel_hi:[1,1,0]
    v_pk_fma_f32 v[218:219], v[218:219], v[196:197], v[196:197] op_sel:[0,1,0] op_sel_hi:[1,1,0]
    v_pk_fma_f32 v[220:221], v[220:221], v[198:199], v[198:199] op_sel:[0,1,0] op_sel_hi:[1,1,0]
    v_pk_fma_f32 v[222:223], v[222:223], v[198:199], v[198:199] op_sel:[0,1,0] op_sel_hi:[1,1,0]
    v_pk_mul_f32 v[216:217], v[216:217], v[60:61]
    v_pk_mul_f32 v[218:219], v[218:219], v[62:63]
    v_pk_mul_f32 v[220:221], v[220:221], v[84:85]
    v_pk_mul_f32 v[222:223], v[222:223], v[86:87]
    v_exp_f32 v216, v216
    v_exp_f32 v217, v217
    v_exp_f32 v218, v218
    v_exp_f32 v219, v219
    v_exp_f32 v220, v220
    v_exp_f32 v221, v221
    v_exp_f32 v222, v222
    v_exp_f32 v223, v223
    v_pk_mul_f32 v[60:61], v[60:61], v[72:73]
    v_pk_mul_f32 v[62:63], v[62:63], v[74:75]
    v_pk_mul_f32 v[84:85], v[84:85], v[96:97]
    v_pk_mul_f32 v[86:87], v[86:87], v[98:99]
    v_pk_fma_f32 v[216:217], v[216:217], v[208:209], v[208:209] op_sel:[0,0,0] op_sel_hi:[1,0,0]
    v_pk_fma_f32 v[218:219], v[218:219], v[208:209], v[208:209] op_sel:[0,0,0] op_sel_hi:[1,0,0]
    v_pk_fma_f32 v[220:221], v[220:221], v[208:209], v[208:209] op_sel:[0,1,1] op_sel_hi:[1,1,1]
    v_pk_fma_f32 v[222:223], v[222:223], v[208:209], v[208:209] op_sel:[0,1,1] op_sel_hi:[1,1,1]
    v_rcp_f32 v216, v216
    v_rcp_f32 v217, v217
    v_rcp_f32 v218, v218
    v_rcp_f32 v219, v219
    v_rcp_f32 v220, v220
    v_rcp_f32 v221, v221
    v_rcp_f32 v222, v222
    v_rcp_f32 v223, v223
    v_pk_mul_f32 v[60:61], v[60:61], v[216:217]
    v_pk_mul_f32 v[62:63], v[62:63], v[218:219]
    v_pk_mul_f32 v[84:85], v[84:85], v[220:221]
    v_pk_mul_f32 v[86:87], v[86:87], v[222:223]
    v_cvt_pk_bf16_f32 v224, v60, v61
    v_cvt_pk_bf16_f32 v226, v84, v85
    v_cvt_pk_bf16_f32 v225, v62, v63
    v_cvt_pk_bf16_f32 v227, v86, v87
    v_permlane16_swap_b32 v224, v226
    s_nop 0
    v_permlane16_swap_b32 v225, v227
    buffer_store_dwordx4 v[224:227], v0, s[64:67], s52 offen sc1
.p2align 3
    v_pk_mul_f32 v[216:217], v[64:65], v[64:65]
    v_pk_mul_f32 v[218:219], v[66:67], v[66:67]
    v_pk_mul_f32 v[220:221], v[88:89], v[88:89]
    v_pk_mul_f32 v[222:223], v[90:91], v[90:91]
    v_pk_fma_f32 v[216:217], v[216:217], v[196:197], v[196:197] op_sel:[0,1,0] op_sel_hi:[1,1,0]
    v_pk_fma_f32 v[218:219], v[218:219], v[196:197], v[196:197] op_sel:[0,1,0] op_sel_hi:[1,1,0]
    v_pk_fma_f32 v[220:221], v[220:221], v[198:199], v[198:199] op_sel:[0,1,0] op_sel_hi:[1,1,0]
    v_pk_fma_f32 v[222:223], v[222:223], v[198:199], v[198:199] op_sel:[0,1,0] op_sel_hi:[1,1,0]
    v_pk_mul_f32 v[216:217], v[216:217], v[64:65]
    v_pk_mul_f32 v[218:219], v[218:219], v[66:67]
    v_pk_mul_f32 v[220:221], v[220:221], v[88:89]
    v_pk_mul_f32 v[222:223], v[222:223], v[90:91]
    v_exp_f32 v216, v216
    v_exp_f32 v217, v217
    v_exp_f32 v218, v218
    v_exp_f32 v219, v219
    v_exp_f32 v220, v220
    v_exp_f32 v221, v221
    v_exp_f32 v222, v222
    v_exp_f32 v223, v223
    v_pk_mul_f32 v[64:65], v[64:65], v[76:77]
    v_pk_mul_f32 v[66:67], v[66:67], v[78:79]
    v_pk_mul_f32 v[88:89], v[88:89], v[100:101]
    v_pk_mul_f32 v[90:91], v[90:91], v[102:103]
    v_pk_fma_f32 v[216:217], v[216:217], v[208:209], v[208:209] op_sel:[0,0,0] op_sel_hi:[1,0,0]
    v_pk_fma_f32 v[218:219], v[218:219], v[208:209], v[208:209] op_sel:[0,0,0] op_sel_hi:[1,0,0]
    v_pk_fma_f32 v[220:221], v[220:221], v[208:209], v[208:209] op_sel:[0,1,1] op_sel_hi:[1,1,1]
    v_pk_fma_f32 v[222:223], v[222:223], v[208:209], v[208:209] op_sel:[0,1,1] op_sel_hi:[1,1,1]
    v_rcp_f32 v216, v216
    v_rcp_f32 v217, v217
    v_rcp_f32 v218, v218
    v_rcp_f32 v219, v219
    v_rcp_f32 v220, v220
    v_rcp_f32 v221, v221
    v_rcp_f32 v222, v222
    v_rcp_f32 v223, v223
    v_pk_mul_f32 v[64:65], v[64:65], v[216:217]
    v_pk_mul_f32 v[66:67], v[66:67], v[218:219]
    v_pk_mul_f32 v[88:89], v[88:89], v[220:221]
    v_pk_mul_f32 v[90:91], v[90:91], v[222:223]
    v_cvt_pk_bf16_f32 v228, v64, v65
    v_cvt_pk_bf16_f32 v230, v88, v89
    v_cvt_pk_bf16_f32 v229, v66, v67
    v_cvt_pk_bf16_f32 v231, v90, v91
    v_permlane16_swap_b32 v228, v230
    s_nop 0
    v_permlane16_swap_b32 v229, v231
    buffer_store_dwordx4 v[228:231], v0, s[64:67], s53 offen sc1
.p2align 3
    v_pk_mul_f32 v[216:217], v[68:69], v[68:69]
    v_pk_mul_f32 v[218:219], v[70:71], v[70:71]
    v_pk_mul_f32 v[220:221], v[92:93], v[92:93]
    v_pk_mul_f32 v[222:223], v[94:95], v[94:95]
    v_pk_fma_f32 v[216:217], v[216:217], v[196:197], v[196:197] op_sel:[0,1,0] op_sel_hi:[1,1,0]
    v_pk_fma_f32 v[218:219], v[218:219], v[196:197], v[196:197] op_sel:[0,1,0] op_sel_hi:[1,1,0]
    v_pk_fma_f32 v[220:221], v[220:221], v[198:199], v[198:199] op_sel:[0,1,0] op_sel_hi:[1,1,0]
    v_pk_fma_f32 v[222:223], v[222:223], v[198:199], v[198:199] op_sel:[0,1,0] op_sel_hi:[1,1,0]
    v_pk_mul_f32 v[216:217], v[216:217], v[68:69]
    v_pk_mul_f32 v[218:219], v[218:219], v[70:71]
    v_pk_mul_f32 v[220:221], v[220:221], v[92:93]
    v_pk_mul_f32 v[222:223], v[222:223], v[94:95]
    v_exp_f32 v216, v216
    v_exp_f32 v217, v217
    v_exp_f32 v218, v218
    v_exp_f32 v219, v219
    v_exp_f32 v220, v220
    v_exp_f32 v221, v221
    v_exp_f32 v222, v222
    v_exp_f32 v223, v223
    v_pk_mul_f32 v[68:69], v[68:69], v[80:81]
    v_pk_mul_f32 v[70:71], v[70:71], v[82:83]
    v_pk_mul_f32 v[92:93], v[92:93], v[104:105]
    v_pk_mul_f32 v[94:95], v[94:95], v[106:107]
    v_pk_fma_f32 v[216:217], v[216:217], v[208:209], v[208:209] op_sel:[0,0,0] op_sel_hi:[1,0,0]
    v_pk_fma_f32 v[218:219], v[218:219], v[208:209], v[208:209] op_sel:[0,0,0] op_sel_hi:[1,0,0]
    v_pk_fma_f32 v[220:221], v[220:221], v[208:209], v[208:209] op_sel:[0,1,1] op_sel_hi:[1,1,1]
    v_pk_fma_f32 v[222:223], v[222:223], v[208:209], v[208:209] op_sel:[0,1,1] op_sel_hi:[1,1,1]
    v_rcp_f32 v216, v216
    v_rcp_f32 v217, v217
    v_rcp_f32 v218, v218
    v_rcp_f32 v219, v219
    v_rcp_f32 v220, v220
    v_rcp_f32 v221, v221
    v_rcp_f32 v222, v222
    v_rcp_f32 v223, v223
    v_pk_mul_f32 v[68:69], v[68:69], v[216:217]
    v_pk_mul_f32 v[70:71], v[70:71], v[218:219]
    v_pk_mul_f32 v[92:93], v[92:93], v[220:221]
    v_pk_mul_f32 v[94:95], v[94:95], v[222:223]
    v_cvt_pk_bf16_f32 v224, v68, v69
    v_cvt_pk_bf16_f32 v226, v92, v93
    v_cvt_pk_bf16_f32 v225, v70, v71
    v_cvt_pk_bf16_f32 v227, v94, v95
    v_permlane16_swap_b32 v224, v226
    s_nop 0
    v_permlane16_swap_b32 v225, v227
    buffer_store_dwordx4 v[224:227], v0, s[64:67], s54 offen sc1
.p2align 3
    v_pk_mul_f32 v[216:217], v[108:109], v[108:109]
    v_pk_mul_f32 v[218:219], v[110:111], v[110:111]
    v_pk_mul_f32 v[220:221], v[132:133], v[132:133]
    v_pk_mul_f32 v[222:223], v[134:135], v[134:135]
    v_pk_fma_f32 v[216:217], v[216:217], v[200:201], v[200:201] op_sel:[0,1,0] op_sel_hi:[1,1,0]
    v_pk_fma_f32 v[218:219], v[218:219], v[200:201], v[200:201] op_sel:[0,1,0] op_sel_hi:[1,1,0]
    v_pk_fma_f32 v[220:221], v[220:221], v[202:203], v[202:203] op_sel:[0,1,0] op_sel_hi:[1,1,0]
    v_pk_fma_f32 v[222:223], v[222:223], v[202:203], v[202:203] op_sel:[0,1,0] op_sel_hi:[1,1,0]
    v_pk_mul_f32 v[216:217], v[216:217], v[108:109]
    v_pk_mul_f32 v[218:219], v[218:219], v[110:111]
    v_pk_mul_f32 v[220:221], v[220:221], v[132:133]
    v_pk_mul_f32 v[222:223], v[222:223], v[134:135]
    v_exp_f32 v216, v216
    v_exp_f32 v217, v217
    v_exp_f32 v218, v218
    v_exp_f32 v219, v219
    v_exp_f32 v220, v220
    v_exp_f32 v221, v221
    v_exp_f32 v222, v222
    v_exp_f32 v223, v223
    v_pk_mul_f32 v[108:109], v[108:109], v[120:121]
    v_pk_mul_f32 v[110:111], v[110:111], v[122:123]
    v_pk_mul_f32 v[132:133], v[132:133], v[144:145]
    v_pk_mul_f32 v[134:135], v[134:135], v[146:147]
    v_pk_fma_f32 v[216:217], v[216:217], v[210:211], v[210:211] op_sel:[0,0,0] op_sel_hi:[1,0,0]
    v_pk_fma_f32 v[218:219], v[218:219], v[210:211], v[210:211] op_sel:[0,0,0] op_sel_hi:[1,0,0]
    v_pk_fma_f32 v[220:221], v[220:221], v[210:211], v[210:211] op_sel:[0,1,1] op_sel_hi:[1,1,1]
    v_pk_fma_f32 v[222:223], v[222:223], v[210:211], v[210:211] op_sel:[0,1,1] op_sel_hi:[1,1,1]
    v_rcp_f32 v216, v216
    v_rcp_f32 v217, v217
    v_rcp_f32 v218, v218
    v_rcp_f32 v219, v219
    v_rcp_f32 v220, v220
    v_rcp_f32 v221, v221
    v_rcp_f32 v222, v222
    v_rcp_f32 v223, v223
    v_pk_mul_f32 v[108:109], v[108:109], v[216:217]
    v_pk_mul_f32 v[110:111], v[110:111], v[218:219]
    v_pk_mul_f32 v[132:133], v[132:133], v[220:221]
    v_pk_mul_f32 v[134:135], v[134:135], v[222:223]
    v_cvt_pk_bf16_f32 v228, v108, v109
    v_cvt_pk_bf16_f32 v230, v132, v133
    v_cvt_pk_bf16_f32 v229, v110, v111
    v_cvt_pk_bf16_f32 v231, v134, v135
    v_permlane16_swap_b32 v228, v230
    s_nop 0
    v_permlane16_swap_b32 v229, v231
    buffer_store_dwordx4 v[228:231], v0, s[64:67], s55 offen sc1
.p2align 3
    v_pk_mul_f32 v[216:217], v[112:113], v[112:113]
    v_pk_mul_f32 v[218:219], v[114:115], v[114:115]
    v_pk_mul_f32 v[220:221], v[136:137], v[136:137]
    v_pk_mul_f32 v[222:223], v[138:139], v[138:139]
    v_pk_fma_f32 v[216:217], v[216:217], v[200:201], v[200:201] op_sel:[0,1,0] op_sel_hi:[1,1,0]
    v_pk_fma_f32 v[218:219], v[218:219], v[200:201], v[200:201] op_sel:[0,1,0] op_sel_hi:[1,1,0]
    v_pk_fma_f32 v[220:221], v[220:221], v[202:203], v[202:203] op_sel:[0,1,0] op_sel_hi:[1,1,0]
    v_pk_fma_f32 v[222:223], v[222:223], v[202:203], v[202:203] op_sel:[0,1,0] op_sel_hi:[1,1,0]
    v_pk_mul_f32 v[216:217], v[216:217], v[112:113]
    v_pk_mul_f32 v[218:219], v[218:219], v[114:115]
    v_pk_mul_f32 v[220:221], v[220:221], v[136:137]
    v_pk_mul_f32 v[222:223], v[222:223], v[138:139]
    v_exp_f32 v216, v216
    v_exp_f32 v217, v217
    v_exp_f32 v218, v218
    v_exp_f32 v219, v219
    v_exp_f32 v220, v220
    v_exp_f32 v221, v221
    v_exp_f32 v222, v222
    v_exp_f32 v223, v223
    v_pk_mul_f32 v[112:113], v[112:113], v[124:125]
    v_pk_mul_f32 v[114:115], v[114:115], v[126:127]
    v_pk_mul_f32 v[136:137], v[136:137], v[148:149]
    v_pk_mul_f32 v[138:139], v[138:139], v[150:151]
    v_pk_fma_f32 v[216:217], v[216:217], v[210:211], v[210:211] op_sel:[0,0,0] op_sel_hi:[1,0,0]
    v_pk_fma_f32 v[218:219], v[218:219], v[210:211], v[210:211] op_sel:[0,0,0] op_sel_hi:[1,0,0]
    v_pk_fma_f32 v[220:221], v[220:221], v[210:211], v[210:211] op_sel:[0,1,1] op_sel_hi:[1,1,1]
    v_pk_fma_f32 v[222:223], v[222:223], v[210:211], v[210:211] op_sel:[0,1,1] op_sel_hi:[1,1,1]
    v_rcp_f32 v216, v216
    v_rcp_f32 v217, v217
    v_rcp_f32 v218, v218
    v_rcp_f32 v219, v219
    v_rcp_f32 v220, v220
    v_rcp_f32 v221, v221
    v_rcp_f32 v222, v222
    v_rcp_f32 v223, v223
    v_pk_mul_f32 v[112:113], v[112:113], v[216:217]
    v_pk_mul_f32 v[114:115], v[114:115], v[218:219]
    v_pk_mul_f32 v[136:137], v[136:137], v[220:221]
    v_pk_mul_f32 v[138:139], v[138:139], v[222:223]
    v_cvt_pk_bf16_f32 v224, v112, v113
    v_cvt_pk_bf16_f32 v226, v136, v137
    v_cvt_pk_bf16_f32 v225, v114, v115
    v_cvt_pk_bf16_f32 v227, v138, v139
    v_permlane16_swap_b32 v224, v226
    s_nop 0
    v_permlane16_swap_b32 v225, v227
    buffer_store_dwordx4 v[224:227], v0, s[64:67], s56 offen sc1
.p2align 3
    v_pk_mul_f32 v[216:217], v[116:117], v[116:117]
    v_pk_mul_f32 v[218:219], v[118:119], v[118:119]
    v_pk_mul_f32 v[220:221], v[140:141], v[140:141]
    v_pk_mul_f32 v[222:223], v[142:143], v[142:143]
    v_pk_fma_f32 v[216:217], v[216:217], v[200:201], v[200:201] op_sel:[0,1,0] op_sel_hi:[1,1,0]
    v_pk_fma_f32 v[218:219], v[218:219], v[200:201], v[200:201] op_sel:[0,1,0] op_sel_hi:[1,1,0]
    v_pk_fma_f32 v[220:221], v[220:221], v[202:203], v[202:203] op_sel:[0,1,0] op_sel_hi:[1,1,0]
    v_pk_fma_f32 v[222:223], v[222:223], v[202:203], v[202:203] op_sel:[0,1,0] op_sel_hi:[1,1,0]
    v_pk_mul_f32 v[216:217], v[216:217], v[116:117]
    v_pk_mul_f32 v[218:219], v[218:219], v[118:119]
    v_pk_mul_f32 v[220:221], v[220:221], v[140:141]
    v_pk_mul_f32 v[222:223], v[222:223], v[142:143]
    v_exp_f32 v216, v216
    v_exp_f32 v217, v217
    v_exp_f32 v218, v218
    v_exp_f32 v219, v219
    v_exp_f32 v220, v220
    v_exp_f32 v221, v221
    v_exp_f32 v222, v222
    v_exp_f32 v223, v223
    v_pk_mul_f32 v[116:117], v[116:117], v[128:129]
    v_pk_mul_f32 v[118:119], v[118:119], v[130:131]
    v_pk_mul_f32 v[140:141], v[140:141], v[152:153]
    v_pk_mul_f32 v[142:143], v[142:143], v[154:155]
    v_pk_fma_f32 v[216:217], v[216:217], v[210:211], v[210:211] op_sel:[0,0,0] op_sel_hi:[1,0,0]
    v_pk_fma_f32 v[218:219], v[218:219], v[210:211], v[210:211] op_sel:[0,0,0] op_sel_hi:[1,0,0]
    v_pk_fma_f32 v[220:221], v[220:221], v[210:211], v[210:211] op_sel:[0,1,1] op_sel_hi:[1,1,1]
    v_pk_fma_f32 v[222:223], v[222:223], v[210:211], v[210:211] op_sel:[0,1,1] op_sel_hi:[1,1,1]
    v_rcp_f32 v216, v216
    v_rcp_f32 v217, v217
    v_rcp_f32 v218, v218
    v_rcp_f32 v219, v219
    v_rcp_f32 v220, v220
    v_rcp_f32 v221, v221
    v_rcp_f32 v222, v222
    v_rcp_f32 v223, v223
    v_pk_mul_f32 v[116:117], v[116:117], v[216:217]
    v_pk_mul_f32 v[118:119], v[118:119], v[218:219]
    v_pk_mul_f32 v[140:141], v[140:141], v[220:221]
    v_pk_mul_f32 v[142:143], v[142:143], v[222:223]
    v_cvt_pk_bf16_f32 v228, v116, v117
    v_cvt_pk_bf16_f32 v230, v140, v141
    v_cvt_pk_bf16_f32 v229, v118, v119
    v_cvt_pk_bf16_f32 v231, v142, v143
    v_permlane16_swap_b32 v228, v230
    s_nop 0
    v_permlane16_swap_b32 v229, v231
    buffer_store_dwordx4 v[228:231], v0, s[64:67], s57 offen sc1
.p2align 3
    s_branch L_G1J
L_LDB:
    v_mov_b32 v14, 0
    s_add_u32 m0, s62, 81920
    s_add_u32 s4, s60, 0
    buffer_load_dwordx4 v7, s[48:51], s4 offen lds
    s_add_u32 m0, s63, 98304
    s_add_u32 s4, s61, 0
    buffer_load_dwordx4 v9, s[52:55], s4 offen lds
    s_add_u32 m0, s63, 99328
    s_add_u32 s4, s61, 0
    buffer_load_dwordx4 v10, s[52:55], s4 offen lds
    s_add_u32 m0, s62, 82944
    s_add_u32 s4, s60, 10240
    buffer_load_dwordx4 v8, s[48:51], s4 offen lds
    s_add_u32 m0, s63, 100352
    s_add_u32 s4, s61, 0
    buffer_load_dwordx4 v11, s[52:55], s4 offen lds
    s_add_u32 m0, s62, 83968
    s_add_u32 s4, s60, 20480
    buffer_load_dwordx4 v7, s[48:51], s4 offen lds
    s_add_u32 m0, s63, 101376
    s_add_u32 s4, s61, 49152
    buffer_load_dwordx4 v9, s[52:55], s4 offen lds
    s_add_u32 m0, s63, 102400
    s_add_u32 s4, s61, 49152
    buffer_load_dwordx4 v10, s[52:55], s4 offen lds
    s_add_u32 m0, s62, 84992
    s_add_u32 s4, s60, 30720
    buffer_load_dwordx4 v8, s[48:51], s4 offen lds
    s_add_u32 m0, s63, 103424
    s_add_u32 s4, s61, 49152
    buffer_load_dwordx4 v11, s[52:55], s4 offen lds
    s_add_u32 m0, s62, 122880
    s_add_u32 s4, s90, 128
    buffer_load_dwordx4 v7, s[48:51], s4 offen lds
    s_add_u32 m0, s63, 139264
    s_add_u32 s4, s91, 196608
    buffer_load_dwordx4 v9, s[52:55], s4 offen lds
    s_add_u32 m0, s63, 140288
    s_add_u32 s4, s91, 196608
    buffer_load_dwordx4 v10, s[52:55], s4 offen lds
    s_add_u32 m0, s62, 123904
    s_add_u32 s4, s90, 10368
    buffer_load_dwordx4 v8, s[48:51], s4 offen lds
    s_add_u32 m0, s63, 141312
    s_add_u32 s4, s91, 196608
    buffer_load_dwordx4 v11, s[52:55], s4 offen lds
    s_add_u32 m0, s62, 124928
    s_add_u32 s4, s90, 20608
    buffer_load_dwordx4 v7, s[48:51], s4 offen lds
    s_add_u32 m0, s63, 142336
    s_add_u32 s4, s91, 245760
    buffer_load_dwordx4 v9, s[52:55], s4 offen lds
    s_add_u32 m0, s63, 143360
    s_add_u32 s4, s91, 245760
    buffer_load_dwordx4 v10, s[52:55], s4 offen lds
    s_add_u32 m0, s62, 125952
    s_add_u32 s4, s90, 30848
    buffer_load_dwordx4 v8, s[48:51], s4 offen lds
    s_add_u32 m0, s63, 144384
    s_add_u32 s4, s91, 245760
    buffer_load_dwordx4 v11, s[52:55], s4 offen lds
    global_load_dword v13, v14, s[44:45] sc1
    s_add_u32 m0, s63, 57344
    s_add_u32 s4, s61, 393216
    buffer_load_dwordx4 v9, s[52:55], s4 offen lds
    s_add_u32 m0, s63, 58368
    s_add_u32 s4, s61, 393216
    buffer_load_dwordx4 v10, s[52:55], s4 offen lds
    s_add_u32 m0, s63, 59392
    s_add_u32 s4, s61, 393216
    buffer_load_dwordx4 v11, s[52:55], s4 offen lds
    s_add_u32 m0, s63, 60416
    s_add_u32 s4, s61, 442368
    buffer_load_dwordx4 v9, s[52:55], s4 offen lds
    s_add_u32 m0, s63, 61440
    s_add_u32 s4, s61, 442368
    buffer_load_dwordx4 v10, s[52:55], s4 offen lds
    s_waitcnt vmcnt(16)
    s_setprio 1
    s_barrier
    s_add_u32 m0, s63, 62464
    s_add_u32 s4, s61, 442368
    buffer_load_dwordx4 v11, s[52:55], s4 offen lds
    v_and_b32 v4, 3, v1
    v_mul_u32_u24 v5, 2592, v4
    v_lshrrev_b32 v3, 2, v1
    v_lshl_add_u32 v5, v3, 3, v5
    v_lshlrev_b32 v3, 14, v3
    s_add_u32 m0, s62, 40960
    s_add_u32 s4, s60, 256
    buffer_load_dwordx4 v7, s[48:51], s4 offen lds
    v_lshl_add_u32 v160, v4, 4, v3
    s_lshl_b32 s8, s83, 7
    s_add_u32 s8, s8, 18432
    v_add_u32 v5, s8, v5
    ds_read2_b64 v[32:35], v5 offset0:0 offset1:162
    s_add_u32 m0, s62, 41984
    s_add_u32 s4, s60, 10496
    buffer_load_dwordx4 v8, s[48:51], s4 offen lds
    v_add_u32 v5, 512, v5
    ds_read2_b64 v[36:39], v5 offset0:0 offset1:162
    v_add_u32 v5, 512, v5
    ds_read2_b64 v[40:43], v5 offset0:0 offset1:162
    s_lshl_b32 s8, s83, 18
    s_add_u32 m0, s62, 43008
    s_add_u32 s4, s60, 20736
    buffer_load_dwordx4 v7, s[48:51], s4 offen lds
    s_lshl_b32 s5, s76, 3
    s_add_u32 s8, s8, s5
    s_add_u32 s8, s8, 1048576
    s_add_u32 s9, s8, 1048576
    s_add_u32 s10, s8, 2097152
    s_cmp_ge_u32 s83, 2
    s_cselect_b32 s10, 2130706432, s10
    ds_read_b128 v[54:57], v6 offset:0
    s_add_u32 m0, s62, 44032
    s_add_u32 s4, s60, 30976
    buffer_load_dwordx4 v8, s[48:51], s4 offen lds
    ds_read_b128 v[58:61], v6 offset:4608
    ds_read_b128 v[62:65], v6 offset:9216
    ds_read_b128 v[66:69], v6 offset:13824
    s_waitcnt lgkmcnt(6)
    buffer_store_dwordx4 v[32:35], v160, s[64:67], s8 offen sc1
    s_waitcnt vmcnt(12)
    s_barrier
    s_add_u32 m0, s62, 81920
    s_add_u32 s4, s90, 384
    buffer_load_dwordx4 v7, s[48:51], s4 offen lds
    s_waitcnt lgkmcnt(2)
    v_add_f32 v54, v54, v58
    s_waitcnt lgkmcnt(0)
    v_add_f32 v62, v62, v66
    v_add_f32 v54, v54, v62
    v_add_f32 v55, v55, v59
    s_add_u32 m0, s63, 98304
    s_add_u32 s4, s91, 589824
    buffer_load_dwordx4 v9, s[52:55], s4 offen lds
    v_add_f32 v63, v63, v67
    v_add_f32 v55, v55, v63
    v_add_f32 v56, v56, v60
    v_add_f32 v64, v64, v68
    v_add_f32 v56, v56, v64
    s_add_u32 m0, s63, 99328
    s_add_u32 s4, s91, 589824
    buffer_load_dwordx4 v10, s[52:55], s4 offen lds
    v_add_f32 v57, v57, v61
    v_add_f32 v65, v65, v69
    v_add_f32 v57, v57, v65
    v_cvt_pk_bf16_f32 v58, v54, v55
    v_lshlrev_b32 v3, 16, v58
    s_add_u32 m0, s62, 82944
    s_add_u32 s4, s90, 10624
    buffer_load_dwordx4 v8, s[48:51], s4 offen lds
    v_and_b32 v4, 0xffff0000, v58
    v_sub_f32 v3, v54, v3
    v_sub_f32 v4, v55, v4
    v_cvt_pk_bf16_f32 v60, v3, v4
    s_add_u32 m0, s63, 100352
    s_add_u32 s4, s91, 589824
    buffer_load_dwordx4 v11, s[52:55], s4 offen lds
    v_cvt_pk_bf16_f32 v59, v56, v57
    v_lshlrev_b32 v3, 16, v59
    v_and_b32 v4, 0xffff0000, v59
    v_sub_f32 v3, v56, v3
    v_sub_f32 v4, v57, v4
    s_add_u32 m0, s62, 83968
    s_add_u32 s4, s90, 20864
    buffer_load_dwordx4 v7, s[48:51], s4 offen lds
    v_cvt_pk_bf16_f32 v61, v3, v4
    v_and_b32 v3, 15, v1
    v_lshlrev_b32 v3, 4, v3
    v_lshrrev_b32 v4, 4, v1
    v_lshl_add_u32 v162, v4, 3, v3
    s_add_u32 m0, s63, 101376
    s_add_u32 s4, s91, 638976
    buffer_load_dwordx4 v9, s[52:55], s4 offen lds
    v_min_u32 v165, 31, v1
    v_lshlrev_b32 v165, 2, v165
    v_add_u32 v165, 145024, v165
    v_mov_b32 v80, 0
    s_add_u32 m0, s63, 102400
    s_add_u32 s4, s91, 638976
    buffer_load_dwordx4 v10, s[52:55], s4 offen lds
    s_and_b32 s14, s79, 1
    s_lshl_b32 s14, s14, 2
    s_bitcmp1_b32 s79, 2
    s_cselect_b32 s14, 8, s14
    s_add_u32 s14, s14, 6
    s_mul_i32 s5, s80, 48
    s_add_u32 m0, s62, 84992
    s_add_u32 s4, s90, 31104
    buffer_load_dwordx4 v8, s[48:51], s4 offen lds
    s_mul_i32 s6, s83, 12
    s_add_u32 s5, s5, s6
    s_mul_i32 s5, s5, 5120
    s_add_u32 s15, s5, 10485760
    s_cmp_ge_u32 s14, 12
    s_cselect_b32 s5, 12, 0
    s_sub_u32 s14, s14, s5
    s_add_u32 m0, s63, 103424
    s_add_u32 s4, s91, 638976
    buffer_load_dwordx4 v11, s[52:55], s4 offen lds
    buffer_store_dwordx4 v[36:39], v160, s[64:67], s9 offen sc1
    s_waitcnt vmcnt(12)
    s_barrier
    v_readfirstlane_b32 s78, v13
    s_nop 1
    s_cmp_lg_u32 s78, 0
    s_cbranch_scc1 NOND_31
    s_mov_b32 s4, 0
NON_30:
    global_load_dword v13, v14, s[44:45] sc1
    s_waitcnt vmcnt(0)
    v_readfirstlane_b32 s78, v13
    s_add_u32 s4, s4, 1
    s_cmp_ge_u32 s4, 0x20000
    s_cbranch_scc1 NOND_31
    s_cmp_eq_u32 s78, 0
    s_cbranch_scc1 NON_30
NOND_31:
    s_add_u32 m0, s62, 122880
    s_add_u32 s4, s60, 512
    buffer_load_dwordx4 v7, s[48:51], s4 offen lds
    s_cmp_ge_u32 s14, 12
    s_cselect_b32 s5, 12, 0
    s_sub_u32 s14, s14, s5
    s_mul_i32 s5, s14, 5120
    s_add_u32 s34, s5, s15
    s_add_u32 s14, s14, 1
    s_add_u32 m0, s63, 139264
    s_add_u32 s4, s61, 786432
    buffer_load_dwordx4 v9, s[52:55], s4 offen lds
    s_cmp_ge_u32 s14, 12
    s_cselect_b32 s5, 12, 0
    s_sub_u32 s14, s14, s5
    s_mul_i32 s5, s14, 5120
    s_add_u32 s35, s5, s15
    s_add_u32 s14, s14, 1
    s_add_u32 m0, s63, 140288
    s_add_u32 s4, s61, 786432
    buffer_load_dwordx4 v10, s[52:55], s4 offen lds
    s_cmp_ge_u32 s14, 12
    s_cselect_b32 s5, 12, 0
    s_sub_u32 s14, s14, s5
    s_mul_i32 s5, s14, 5120
    s_add_u32 s36, s5, s15
    s_add_u32 s14, s14, 1
    s_cmp_ge_u32 s14, 12
    s_cselect_b32 s5, 12, 0
    s_sub_u32 s14, s14, s5
    s_add_u32 m0, s62, 123904
    s_add_u32 s4, s60, 10752
    buffer_load_dwordx4 v8, s[48:51], s4 offen lds
    s_mul_i32 s5, s14, 5120
    s_add_u32 s37, s5, s15
    s_add_u32 s14, s14, 1
    s_cmp_ge_u32 s14, 12
    s_cselect_b32 s5, 12, 0
    s_sub_u32 s14, s14, s5
    s_add_u32 m0, s63, 141312
    s_add_u32 s4, s61, 786432
    buffer_load_dwordx4 v11, s[52:55], s4 offen lds
    s_mul_i32 s5, s14, 5120
    s_add_u32 s38, s5, s15
    s_add_u32 s14, s14, 1
    s_mul_i32 s14, s83, 5120
    s_add_u32 s14, s14, 123904
    s_add_u32 m0, s62, 124928
    s_add_u32 s4, s60, 20992
    buffer_load_dwordx4 v7, s[48:51], s4 offen lds
    s_mul_i32 s19, s83, 10240
    s_lshl_b32 s5, s83, 2
    s_add_u32 s5, s5, 145024
    v_mov_b32 v17, s5
    s_add_u32 m0, s63, 142336
    s_add_u32 s4, s61, 835584
    buffer_load_dwordx4 v9, s[52:55], s4 offen lds
    v_add_u32 v19, 4096, v6
    s_add_u32 m0, s63, 143360
    s_add_u32 s4, s61, 835584
    buffer_load_dwordx4 v10, s[52:55], s4 offen lds
    s_add_u32 m0, s62, 125952
    s_add_u32 s4, s60, 31232
    buffer_load_dwordx4 v8, s[48:51], s4 offen lds
    s_add_u32 m0, s63, 144384
    s_add_u32 s4, s61, 835584
    buffer_load_dwordx4 v11, s[52:55], s4 offen lds
    buffer_store_dwordx4 v[40:43], v160, s[64:67], s10 offen sc1
    s_mov_b64 exec, 0xffffffff
    buffer_store_dwordx2 v[58:59], v162, s[64:67], s58 offen sc1
    buffer_store_dwordx2 v[60:61], v162, s[64:67], s58 offen offset:3072 sc1
    s_mov_b64 exec, -1
    s_waitcnt vmcnt(14)
    s_barrier
    s_add_u32 m0, s62, 40960
    s_add_u32 s4, s90, 640
    buffer_load_dwordx4 v7, s[48:51], s4 offen lds
    s_add_u32 m0, s63, 57344
    s_add_u32 s4, s91, 983040
    buffer_load_dwordx4 v9, s[52:55], s4 offen lds
    s_add_u32 m0, s63, 58368
    s_add_u32 s4, s91, 983040
    buffer_load_dwordx4 v10, s[52:55], s4 offen lds
    s_add_u32 m0, s62, 41984
    s_add_u32 s4, s90, 10880
    buffer_load_dwordx4 v8, s[48:51], s4 offen lds
    s_add_u32 m0, s63, 59392
    s_add_u32 s4, s91, 983040
    buffer_load_dwordx4 v11, s[52:55], s4 offen lds
    s_add_u32 m0, s62, 43008
    s_add_u32 s4, s90, 21120
    buffer_load_dwordx4 v7, s[48:51], s4 offen lds
    s_add_u32 m0, s63, 60416
    s_add_u32 s4, s91, 1032192
    buffer_load_dwordx4 v9, s[52:55], s4 offen lds
    s_add_u32 m0, s63, 61440
    s_add_u32 s4, s91, 1032192
    buffer_load_dwordx4 v10, s[52:55], s4 offen lds
    s_add_u32 m0, s62, 44032
    s_add_u32 s4, s90, 31360
    buffer_load_dwordx4 v8, s[48:51], s4 offen lds
    s_add_u32 m0, s63, 62464
    s_add_u32 s4, s91, 1032192
    buffer_load_dwordx4 v11, s[52:55], s4 offen lds
    s_waitcnt vmcnt(10)
    s_barrier
    s_lshl_b32 s4, s2, 3
    s_add_u32 s4, s4, 0
    s_cmp_lg_u32 s83, 0
    s_cselect_b32 s4, 2130706432, s4
    v_mov_b32 v158, s78
    v_mov_b32 v159, 0
    s_mov_b64 exec, 1
    buffer_store_dword v158, v159, s[64:67], s4 offen sc1
    s_mov_b64 exec, -1
    s_add_u32 m0, s62, 81920
    s_add_u32 s4, s60, 768
    buffer_load_dwordx4 v7, s[48:51], s4 offen lds
    s_add_u32 m0, s63, 98304
    s_add_u32 s4, s61, 1179648
    buffer_load_dwordx4 v9, s[52:55], s4 offen lds
    s_add_u32 m0, s63, 99328
    s_add_u32 s4, s61, 1179648
    buffer_load_dwordx4 v10, s[52:55], s4 offen lds
    s_add_u32 m0, s62, 82944
    s_add_u32 s4, s60, 11008
    buffer_load_dwordx4 v8, s[48:51], s4 offen lds
    s_add_u32 m0, s63, 100352
    s_add_u32 s4, s61, 1179648
    buffer_load_dwordx4 v11, s[52:55], s4 offen lds
    s_add_u32 m0, s62, 83968
    s_add_u32 s4, s60, 21248
    buffer_load_dwordx4 v7, s[48:51], s4 offen lds
    s_add_u32 m0, s63, 101376
    s_add_u32 s4, s61, 1228800
    buffer_load_dwordx4 v9, s[52:55], s4 offen lds
    s_add_u32 m0, s63, 102400
    s_add_u32 s4, s61, 1228800
    buffer_load_dwordx4 v10, s[52:55], s4 offen lds
    s_add_u32 m0, s62, 84992
    s_add_u32 s4, s60, 31488
    buffer_load_dwordx4 v8, s[48:51], s4 offen lds
    s_add_u32 m0, s63, 103424
    s_add_u32 s4, s61, 1228800
    buffer_load_dwordx4 v11, s[52:55], s4 offen lds
    s_waitcnt vmcnt(11)
    s_barrier
    s_add_u32 m0, s62, 122880
    s_add_u32 s4, s90, 896
    buffer_load_dwordx4 v7, s[48:51], s4 offen lds
    s_add_u32 m0, s63, 139264
    s_add_u32 s4, s91, 1376256
    buffer_load_dwordx4 v9, s[52:55], s4 offen lds
    s_add_u32 m0, s63, 140288
    s_add_u32 s4, s91, 1376256
    buffer_load_dwordx4 v10, s[52:55], s4 offen lds
    s_add_u32 m0, s62, 123904
    s_add_u32 s4, s90, 11136
    buffer_load_dwordx4 v8, s[48:51], s4 offen lds
    s_add_u32 m0, s63, 141312
    s_add_u32 s4, s91, 1376256
    buffer_load_dwordx4 v11, s[52:55], s4 offen lds
    s_add_u32 m0, s62, 124928
    s_add_u32 s4, s90, 21376
    buffer_load_dwordx4 v7, s[48:51], s4 offen lds
    s_add_u32 m0, s63, 142336
    s_add_u32 s4, s91, 1425408
    buffer_load_dwordx4 v9, s[52:55], s4 offen lds
    s_add_u32 m0, s63, 143360
    s_add_u32 s4, s91, 1425408
    buffer_load_dwordx4 v10, s[52:55], s4 offen lds
    s_add_u32 m0, s62, 125952
    s_add_u32 s4, s90, 31616
    buffer_load_dwordx4 v8, s[48:51], s4 offen lds
    s_add_u32 m0, s63, 144384
    s_add_u32 s4, s91, 1425408
    buffer_load_dwordx4 v11, s[52:55], s4 offen lds
    s_waitcnt vmcnt(10)
    s_barrier
    s_add_u32 m0, s62, 40960
    s_add_u32 s4, s60, 1024
    buffer_load_dwordx4 v7, s[48:51], s4 offen lds
    s_add_u32 m0, s63, 57344
    s_add_u32 s4, s61, 1572864
    buffer_load_dwordx4 v9, s[52:55], s4 offen lds
    s_add_u32 m0, s63, 58368
    s_add_u32 s4, s61, 1572864
    buffer_load_dwordx4 v10, s[52:55], s4 offen lds
    s_add_u32 m0, s62, 41984
    s_add_u32 s4, s60, 11264
    buffer_load_dwordx4 v8, s[48:51], s4 offen lds
    s_add_u32 m0, s63, 59392
    s_add_u32 s4, s61, 1572864
    buffer_load_dwordx4 v11, s[52:55], s4 offen lds
    s_add_u32 m0, s62, 43008
    s_add_u32 s4, s60, 21504
    buffer_load_dwordx4 v7, s[48:51], s4 offen lds
    s_add_u32 m0, s63, 60416
    s_add_u32 s4, s61, 1622016
    buffer_load_dwordx4 v9, s[52:55], s4 offen lds
    s_add_u32 m0, s63, 61440
    s_add_u32 s4, s61, 1622016
    buffer_load_dwordx4 v10, s[52:55], s4 offen lds
    s_add_u32 m0, s62, 44032
    s_add_u32 s4, s60, 31744
    buffer_load_dwordx4 v8, s[48:51], s4 offen lds
    s_add_u32 m0, s63, 62464
    s_add_u32 s4, s61, 1622016
    buffer_load_dwordx4 v11, s[52:55], s4 offen lds
    s_waitcnt vmcnt(10)
    s_barrier
    v_lshlrev_b32 v159, 3, v1
    s_lshl_b32 s7, s83, 9
    s_add_u32 s7, s7, 0
    buffer_load_dword v158, v159, s[64:67], s7 offen sc1
    s_add_u32 m0, s62, 81920
    s_add_u32 s4, s90, 1152
    buffer_load_dwordx4 v7, s[48:51], s4 offen lds
    s_add_u32 m0, s63, 98304
    s_add_u32 s4, s91, 1769472
    buffer_load_dwordx4 v9, s[52:55], s4 offen lds
    s_add_u32 m0, s63, 99328
    s_add_u32 s4, s91, 1769472
    buffer_load_dwordx4 v10, s[52:55], s4 offen lds
    s_add_u32 m0, s62, 82944
    s_add_u32 s4, s90, 11392
    buffer_load_dwordx4 v8, s[48:51], s4 offen lds
    s_add_u32 m0, s63, 100352
    s_add_u32 s4, s91, 1769472
    buffer_load_dwordx4 v11, s[52:55], s4 offen lds
    s_add_u32 m0, s62, 83968
    s_add_u32 s4, s90, 21632
    buffer_load_dwordx4 v7, s[48:51], s4 offen lds
    s_add_u32 m0, s63, 101376
    s_add_u32 s4, s91, 1818624
    buffer_load_dwordx4 v9, s[52:55], s4 offen lds
    s_add_u32 m0, s63, 102400
    s_add_u32 s4, s91, 1818624
    buffer_load_dwordx4 v10, s[52:55], s4 offen lds
    s_add_u32 m0, s62, 84992
    s_add_u32 s4, s90, 31872
    buffer_load_dwordx4 v8, s[48:51], s4 offen lds
    s_add_u32 m0, s63, 103424
    s_add_u32 s4, s91, 1818624
    buffer_load_dwordx4 v11, s[52:55], s4 offen lds
    s_waitcnt vmcnt(11)
    s_waitcnt vmcnt(10)
    v_cmp_ne_u32 vcc, s78, v158
    s_nop 1
    s_cbranch_vccz PDONE_33
    s_mov_b32 s4, 0
POLL_32:
    buffer_load_dword v158, v159, s[64:67], s7 offen sc1
    s_waitcnt vmcnt(0)
    v_cmp_ne_u32 vcc, s78, v158
    s_add_u32 s4, s4, 1
    s_nop 0
    s_cbranch_vccz PDONE_33
    s_cmp_lt_u32 s4, 0x20000
    s_cbranch_scc1 POLL_32
PDONE_33:
    s_barrier
    s_add_u32 m0, s59, 0
    s_add_u32 s4, s82, 0
    buffer_load_dwordx4 v9, s[64:67], s4 offen sc1 lds
    s_add_u32 m0, s59, 1024
    s_add_u32 s4, s82, 0
    buffer_load_dwordx4 v10, s[64:67], s4 offen sc1 lds
    s_add_u32 m0, s59, 2048
    s_add_u32 s4, s82, 0
    buffer_load_dwordx4 v11, s[64:67], s4 offen sc1 lds
    s_branch L_LDJ
L_END:
    s_endpgm
.section .rodata,"a"
.p2align 6
.amdhsa_kernel recurrent_scan__ssm_conv_s4__geglu_ffn__prompt_kernel
  .amdhsa_next_free_vgpr 256
  .amdhsa_next_free_sgpr 102
  .amdhsa_accum_offset 256
  .amdhsa_group_segment_fixed_size 0
  .amdhsa_kernarg_size 128
  .amdhsa_user_sgpr_count 2
  .amdhsa_user_sgpr_kernarg_segment_ptr 1
  .amdhsa_system_sgpr_workgroup_id_x 1
.end_amdhsa_kernel
```
